```python
import torch

def _softmax(x, axis=-1):
    return torch.softmax(x, dim=axis)
def _gelu(x):
    return torch.nn.functional.gelu(x, approximate="tanh")
def _silu(x):
    return torch.nn.functional.silu(x)
def _sigmoid(x):
    return torch.sigmoid(x)
def _layernorm(x, axis=-1, eps=1e-5):
    m = x.mean(dim=axis, keepdim=True)
    v = x.var(dim=axis, keepdim=True, unbiased=False)
    return (x - m) / torch.sqrt(v + eps)
def _scatter_add(tgt, idx, src, axis=0):
    return tgt.clone().index_add_(axis, idx, src)
def _segment_sum(src, seg, n):
    out = torch.zeros((n,) + src.shape[1:], dtype=src.dtype)
    return out.index_add_(0, seg, src)
def _pad(x, pw):
    flat = tuple(v for pair in reversed(pw) for v in pair)
    return torch.nn.functional.pad(x, flat)

kernel_name = 'concat_heads__mha_block_cached__mha_block_cached__near_ridge'

def setup_inputs():

    _w = (lambda a: (lambda t: t.to(torch.bfloat16) if t.is_floating_point() else t)(torch.as_tensor(a)))
    def _A_setup():
        B, Sq, D = 16, 96, 576
        H, Sk, Dh = 32, 512, 128
        return {
            "x": _w((lambda *s: torch.randn(*s, dtype=torch.bfloat16) * 0.8)(B, Sq, D)),
            "k_cache": _w((lambda *s: torch.randn(*s, dtype=torch.bfloat16) * 0.8)(B, H, Sk, Dh)),
            "v_cache": _w((lambda *s: torch.randn(*s, dtype=torch.bfloat16) * 0.05)(B, H, Sk, Dh)),
            "wq": _w((lambda *s: torch.randn(*s, dtype=torch.bfloat16) * 0.8)(D, H * Dh) * (D ** -0.5)),
            "wo": _w((lambda *s: torch.randn(*s, dtype=torch.bfloat16) * 0.05)(H * Dh, D) * ((H * Dh) ** -0.5)),
        }
    _A_in = _A_setup()

    def _B_setup():
        B, Sq, D = 16, 96, 576
        H, Sk, Dh = 32, 512, 128
        return {
            "x": _w((lambda *s: torch.randn(*s, dtype=torch.bfloat16) * 0.8)(B, Sq, D)),
            "k_cache": _w((lambda *s: torch.randn(*s, dtype=torch.bfloat16) * 0.8)(B, H, Sk, Dh)),
            "v_cache": _w((lambda *s: torch.randn(*s, dtype=torch.bfloat16) * 0.05)(B, H, Sk, Dh)),
            "wq": _w((lambda *s: torch.randn(*s, dtype=torch.bfloat16) * 0.8)(D, H * Dh) * (D ** -0.5)),
            "wo": _w((lambda *s: torch.randn(*s, dtype=torch.bfloat16) * 0.05)(H * Dh, D) * ((H * Dh) ** -0.5)),
        }
    _B_in = _B_setup()

    return {
        "A_x": _A_in["x"],
        "A_k_cache": _A_in["k_cache"],
        "A_v_cache": _A_in["v_cache"],
        "A_wq": _A_in["wq"],
        "A_wo": _A_in["wo"],
        "B_x": _B_in["x"],
        "B_k_cache": _B_in["k_cache"],
        "B_v_cache": _B_in["v_cache"],
        "B_wq": _B_in["wq"],
        "B_wo": _B_in["wo"],
    }

def reference(A_x, A_k_cache, A_v_cache, A_wq, A_wo, B_x, B_k_cache, B_v_cache, B_wq, B_wo):
    def _A_ref(x, k_cache, v_cache, wq, wo):
        B, Sq, D = x.shape
        H, Dh = 32, 128
        q = (lambda x, *d: x.permute(*d))((x @ wq).reshape(B, Sq, H, Dh), 0, 2, 1, 3)
        scores = torch.einsum("bhqd,bhkd->bhqk", q, k_cache) * (Dh ** -0.5)
        p = _softmax(scores, axis=-1)
        o = torch.einsum("bhqk,bhkd->bhqd", p, v_cache)
        return (lambda x, *d: x.permute(*d))(o, 0, 2, 1, 3).reshape(B, Sq, H * Dh) @ wo

    def _B_ref(x, k_cache, v_cache, wq, wo):
        B, Sq, D = x.shape
        H, Dh = 32, 128
        q = (lambda x, *d: x.permute(*d))((x @ wq).reshape(B, Sq, H, Dh), 0, 2, 1, 3)
        scores = torch.einsum("bhqd,bhkd->bhqk", q, k_cache) * (Dh ** -0.5)
        p = _softmax(scores, axis=-1)
        o = torch.einsum("bhqk,bhkd->bhqd", p, v_cache)
        return (lambda x, *d: x.permute(*d))(o, 0, 2, 1, 3).reshape(B, Sq, H * Dh) @ wo

    a = _A_ref(A_x, A_k_cache, A_v_cache, A_wq, A_wo)
    b = _B_ref(B_x, B_k_cache, B_v_cache, B_wq, B_wo)
    return torch.concatenate([a, b], axis=-1)
```

```asm
; @launch grid=(256,1,1) block=(512,1,1) lds=163840
.amdgcn_target "amdgcn-amd-amdhsa--gfx950"
.text
.globl concat_heads__mha_block_cached__mha_block_cached__near_ridge_kernel
.p2align 8
.type concat_heads__mha_block_cached__mha_block_cached__near_ridge_kernel,@function
concat_heads__mha_block_cached__mha_block_cached__near_ridge_kernel:
  s_cmp_ge_u32 s2, 256
  s_cbranch_scc1 L_end
  s_and_b32 s4, s2, 7
  s_lshr_b32 s5, s2, 3
  s_lshr_b32 s48, s4, 2
  s_and_b32 s49, s5, 15
  s_and_b32 s4, s4, 3
  s_lshl_b32 s4, s4, 1
  s_lshr_b32 s5, s5, 4
  s_add_u32 s50, s4, s5
  s_load_dwordx2 s[14:15], s[0:1], 96
  s_load_dwordx4 s[44:47], s[0:1], 80
  s_mul_i32 s3, s48, 40
  s_add_u32 s0, s0, s3
  s_addc_u32 s1, s1, 0
  s_load_dwordx8 s[4:11], s[0:1], 0
  s_load_dwordx2 s[12:13], s[0:1], 32
  v_lshrrev_b32 v1, 6, v0
  v_and_b32 v30, 63, v0
  v_readfirstlane_b32 s51, v1
  s_mov_b32 s52, 0x3e0293ee
  s_mov_b32 s53, 0x40e00000
  s_mov_b32 s100, 0x40004000
  s_lshl_b32 s60, s51, 2
  s_lshr_b32 s57, 0x22111000, s60
  s_and_b32 s57, s57, 15
  s_lshr_b32 s58, 0x10102210, s60
  s_and_b32 s58, s58, 15
  v_lshrrev_b32 v20, 4, v30
  v_and_b32 v21, 15, v30
  v_xor_b32 v22, v21, v20
  v_xor_b32 v22, 0, v22
  v_lshlrev_b32 v22, 4, v22
  v_lshl_add_u32 v2, v20, 8, v22
  v_xor_b32 v22, v21, v20
  v_xor_b32 v22, 4, v22
  v_lshlrev_b32 v22, 4, v22
  v_lshl_add_u32 v3, v20, 8, v22
  v_xor_b32 v22, v21, v20
  v_xor_b32 v22, 8, v22
  v_lshlrev_b32 v22, 4, v22
  v_lshl_add_u32 v4, v20, 8, v22
  v_xor_b32 v22, v21, v20
  v_xor_b32 v22, 12, v22
  v_lshlrev_b32 v22, 4, v22
  v_lshl_add_u32 v5, v20, 8, v22
  v_lshlrev_b32 v22, 2, v20
  v_xor_b32 v22, v22, v21
  v_lshlrev_b32 v22, 4, v22
  v_lshl_add_u32 v6, v20, 8, v22
  v_lshl_add_u32 v23, v20, 13, v22
  v_add_u32 v7, 0, v23
  v_add_u32 v8, 31744, v23
  v_add_u32 v9, 63488, v23
  v_add_u32 v10, 95232, v23
  v_lshrrev_b32 v22, 3, v30
  v_mul_u32_u24 v22, 1152, v22
  v_and_b32 v21, 7, v30
  v_xor_b32 v21, v21, v20
  v_xor_b32 v23, 0, v21
  v_lshl_add_u32 v23, v23, 4, v22
  v_add_u32 v11, 0, v23
  v_xor_b32 v23, 4, v21
  v_lshl_add_u32 v23, v23, 4, v22
  v_add_u32 v12, 8192, v23
  v_xor_b32 v23, 0, v21
  v_lshl_add_u32 v23, v23, 4, v22
  v_add_u32 v13, 16384, v23
  v_xor_b32 v23, 4, v21
  v_lshl_add_u32 v23, v23, 4, v22
  v_add_u32 v14, 24576, v23
  v_xor_b32 v23, 0, v21
  v_lshl_add_u32 v23, v23, 4, v22
  v_add_u32 v15, 36864, v23
  v_xor_b32 v23, 4, v21
  v_lshl_add_u32 v23, v23, 4, v22
  v_add_u32 v16, 45056, v23
  s_waitcnt lgkmcnt(0)
  s_mov_b32 s24, s4
  s_mov_b32 s25, s5
  s_mov_b32 s26, 1769472
  s_mov_b32 s27, 0x00020000
  s_mov_b32 s28, s10
  s_mov_b32 s29, s11
  s_mov_b32 s30, 4718592
  s_mov_b32 s31, 0x00020000
  s_mov_b32 s16, s6
  s_mov_b32 s17, s7
  s_mov_b32 s18, 67108864
  s_mov_b32 s19, 0x00020000
  s_mov_b32 s20, s8
  s_mov_b32 s21, s9
  s_mov_b32 s22, 67108864
  s_mov_b32 s23, 0x00020000
  s_mov_b32 s32, s12
  s_mov_b32 s33, s13
  s_mov_b32 s34, 4718592
  s_mov_b32 s35, 0x00020000
  s_mov_b32 s36, s14
  s_mov_b32 s37, s15
  s_mov_b32 s38, 50331648
  s_mov_b32 s39, 0x00020000
  s_mov_b32 s40, s44
  s_mov_b32 s41, s45
  s_mov_b32 s42, 3538944
  s_mov_b32 s43, 0x00020000
  s_and_b32 s60, s50, 1
  s_lshl_b32 s61, s60, 3
  s_add_u32 s8, s50, s61
  s_cmp_eq_u32 s60, 0
  s_cselect_b32 s61, 16, -16
  s_mul_i32 s9, s61, 131072
  s_mul_i32 s10, s61, 256
  s_mul_i32 s11, s61, 147456
  s_and_b32 s61, s49, 1
  s_mul_i32 s0, s61, 131072
  s_mul_i32 s1, s61, 256
  s_mul_i32 s3, s61, 147456
  s_cmp_eq_u32 s57, 2
  s_cbranch_scc0 L_role_a
L_role_l:
  s_setprio 3
  v_min_u32 v20, 35, v30
  s_mul_i32 s60, s49, 36
  v_add_u32 v20, s60, v20
  v_lshlrev_b32 v20, 13, v20
  s_lshl_b32 s60, s8, 9
  s_lshl_b32 s61, s58, 7
  s_add_u32 s60, s60, s61
  v_mov_b32 v24, v20
  s_mov_b32 s12, s60
  s_add_u32 s60, s60, s1
  buffer_load_dword v27, v24, s[28:31], s60 offen nt
  buffer_load_dword v27, v24, s[28:31], s60 offen sc1
  s_lshl_b32 s67, s58, 12
  s_mul_i32 s68, s58, 6144
  s_add_u32 s60, s68, 114688
  v_lshlrev_b32 v17, 4, v30
  v_add_u32 v17, s60, v17
  s_lshl_b32 s60, s49, 5
  s_lshl_b32 s61, s8, 1
  s_add_u32 s60, s60, s61
  s_lshl_b32 s64, s60, 17
  s_add_u32 s64, s64, s67
  s_mul_i32 s13, s49, 9
  s_lshr_b32 s13, s13, 4
  s_lshr_b32 s74, s2, 4
  s_xor_b32 s74, s74, s2
  s_and_b32 s74, s74, 15
  s_lshl_b32 s74, s74, 13
  s_lshl_b32 s65, s8, 9
  s_lshl_b32 s60, s58, 17
  s_add_u32 s65, s65, s60
  s_mul_i32 s66, s49, 110592
  s_mul_i32 s60, s58, 55296
  s_add_u32 s66, s66, s60
  s_add_u32 s60, s12, 0
  s_sub_u32 s60, s60, s1
  s_add_u32 s60, s60, 256
  buffer_load_dword v27, v24, s[28:31], s60 offen nt
  buffer_load_dword v27, v24, s[28:31], s60 offen sc1
  s_add_u32 m0, s68, 114688
  s_add_u32 s61, s13, 0
  s_sub_u32 s62, s61, 9
  s_cmp_ge_u32 s61, 9
  s_cselect_b32 s61, s62, s61
  s_lshl_b32 s61, s61, 7
  s_add_u32 s60, s61, s66
  buffer_load_dwordx4 v11, s[24:27], s60 offen offset:0 lds
  buffer_load_dwordx4 v12, s[24:27], s60 offen offset:1024 lds
  buffer_load_dwordx4 v13, s[24:27], s60 offen offset:2048 lds
  buffer_load_dwordx4 v14, s[24:27], s60 offen offset:3072 lds
  s_add_u32 m0, s68, 118784
  s_nop 0
  buffer_load_dwordx4 v15, s[24:27], s60 offen offset:0 lds
  buffer_load_dwordx4 v16, s[24:27], s60 offen offset:1024 lds
  s_add_u32 m0, s67, 65536
  s_add_u32 s61, s13, 0
  s_sub_u32 s62, s61, 9
  s_cmp_ge_u32 s61, 9
  s_cselect_b32 s61, s62, s61
  s_lshl_b32 s61, s61, 19
  s_add_u32 s61, s61, s65
  s_add_u32 s60, s61, 0
  s_add_u32 s60, s60, s1
  buffer_load_dwordx4 v7, s[28:31], s60 offen offset:0 lds
  buffer_load_dwordx4 v8, s[28:31], s60 offen offset:1024 lds
  buffer_load_dwordx4 v9, s[28:31], s60 offen offset:2048 lds
  buffer_load_dwordx4 v10, s[28:31], s60 offen offset:3072 lds
  s_add_u32 m0, s67, 73728
  s_add_u32 s61, s13, 0
  s_sub_u32 s62, s61, 9
  s_cmp_ge_u32 s61, 9
  s_cselect_b32 s61, s62, s61
  s_lshl_b32 s61, s61, 19
  s_add_u32 s61, s61, s65
  s_add_u32 s60, s61, 262144
  s_add_u32 s60, s60, s1
  buffer_load_dwordx4 v7, s[28:31], s60 offen offset:0 lds
  buffer_load_dwordx4 v8, s[28:31], s60 offen offset:1024 lds
  buffer_load_dwordx4 v9, s[28:31], s60 offen offset:2048 lds
  buffer_load_dwordx4 v10, s[28:31], s60 offen offset:3072 lds
  s_add_u32 m0, s68, 126976
  s_add_u32 s61, s13, 1
  s_sub_u32 s62, s61, 9
  s_cmp_ge_u32 s61, 9
  s_cselect_b32 s61, s62, s61
  s_lshl_b32 s61, s61, 7
  s_add_u32 s60, s61, s66
  buffer_load_dwordx4 v11, s[24:27], s60 offen offset:0 lds
  buffer_load_dwordx4 v12, s[24:27], s60 offen offset:1024 lds
  buffer_load_dwordx4 v13, s[24:27], s60 offen offset:2048 lds
  buffer_load_dwordx4 v14, s[24:27], s60 offen offset:3072 lds
  s_add_u32 m0, s68, 131072
  s_nop 0
  buffer_load_dwordx4 v15, s[24:27], s60 offen offset:0 lds
  buffer_load_dwordx4 v16, s[24:27], s60 offen offset:1024 lds
  s_add_u32 m0, s67, 81920
  s_add_u32 s61, s13, 1
  s_sub_u32 s62, s61, 9
  s_cmp_ge_u32 s61, 9
  s_cselect_b32 s61, s62, s61
  s_lshl_b32 s61, s61, 19
  s_add_u32 s61, s61, s65
  s_add_u32 s60, s61, 0
  s_add_u32 s60, s60, s1
  buffer_load_dwordx4 v7, s[28:31], s60 offen offset:0 lds
  buffer_load_dwordx4 v8, s[28:31], s60 offen offset:1024 lds
  buffer_load_dwordx4 v9, s[28:31], s60 offen offset:2048 lds
  buffer_load_dwordx4 v10, s[28:31], s60 offen offset:3072 lds
  s_add_u32 m0, s67, 90112
  s_add_u32 s61, s13, 1
  s_sub_u32 s62, s61, 9
  s_cmp_ge_u32 s61, 9
  s_cselect_b32 s61, s62, s61
  s_lshl_b32 s61, s61, 19
  s_add_u32 s61, s61, s65
  s_add_u32 s60, s61, 262144
  s_add_u32 s60, s60, s1
  buffer_load_dwordx4 v7, s[28:31], s60 offen offset:0 lds
  buffer_load_dwordx4 v8, s[28:31], s60 offen offset:1024 lds
  buffer_load_dwordx4 v9, s[28:31], s60 offen offset:2048 lds
  buffer_load_dwordx4 v10, s[28:31], s60 offen offset:3072 lds
  v_min_u32 v20, 47, v30
  v_mul_u32_u24 v21, 21846, v20
  v_lshrrev_b32 v21, 16, v21
  v_mul_u32_u24 v22, 3, v21
  v_sub_u32 v20, v20, v22
  v_mul_u32_u24 v21, 1152, v21
  v_lshl_add_u32 v20, v20, 7, v21
  s_lshl_b32 s60, s8, 8
  s_lshl_b32 s61, s49, 5
  s_add_u32 s60, s60, s61
  s_lshl_b32 s61, s58, 4
  s_add_u32 s60, s60, s61
  s_mul_i32 s60, s60, 1152
  s_sub_u32 s61, s11, 294912
  s_cmp_ge_u32 s49, 8
  s_cselect_b32 s61, s61, 0
  s_add_u32 s60, s60, s61
  v_add_u32 v25, s60, v20
  v_lshrrev_b32 v224, 5, v30
  v_and_b32 v225, 31, v30
  v_bfe_u32 v226, v30, 4, 1
  v_bfe_u32 v227, v30, 2, 2
  v_and_b32 v228, 3, v30
  v_add_u32 v229, 0, v30
  v_mul_u32_u24 v230, 2731, v229
  v_lshrrev_b32 v230, 16, v230
  v_mul_u32_u24 v231, 24, v230
  v_sub_u32 v229, v229, v231
  v_bfe_u32 v231, v230, 1, 1
  v_lshlrev_b32 v231, 2, v231
  v_xor_b32 v229, v229, v231
  v_mul_u32_u24 v230, 1152, v230
  v_lshl_add_u32 v229, v229, 4, v230
  v_subrev_u32 v246, 0, v229
  v_add_u32 v229, 64, v30
  v_mul_u32_u24 v230, 2731, v229
  v_lshrrev_b32 v230, 16, v230
  v_mul_u32_u24 v231, 24, v230
  v_sub_u32 v229, v229, v231
  v_bfe_u32 v231, v230, 1, 1
  v_lshlrev_b32 v231, 2, v231
  v_xor_b32 v229, v229, v231
  v_mul_u32_u24 v230, 1152, v230
  v_lshl_add_u32 v229, v229, 4, v230
  v_subrev_u32 v247, 1024, v229
  v_add_u32 v229, 128, v30
  v_mul_u32_u24 v230, 2731, v229
  v_lshrrev_b32 v230, 16, v230
  v_mul_u32_u24 v231, 24, v230
  v_sub_u32 v229, v229, v231
  v_bfe_u32 v231, v230, 1, 1
  v_lshlrev_b32 v231, 2, v231
  v_xor_b32 v229, v229, v231
  v_mul_u32_u24 v230, 1152, v230
  v_lshl_add_u32 v229, v229, 4, v230
  v_subrev_u32 v248, 2048, v229
  s_mul_i32 s70, s51, 3072
  s_lshl_b32 s60, s8, 8
  s_lshl_b32 s61, s51, 3
  s_add_u32 s60, s60, s61
  s_mul_i32 s69, s60, 1152
  s_lshl_b32 s59, s57, 1
  s_mul_i32 s63, s57, 3
  s_cmp_eq_u32 s58, 2
  s_cselect_b32 s59, s63, s59
  v_lshl_add_u32 v229, v224, 2, v227
  v_mul_u32_u24 v229, 384, v229
  v_lshl_add_u32 v229, v226, 5, v229
  v_lshl_add_u32 v229, v228, 3, v229
  v_lshrrev_b32 v230, 1, v227
  s_add_u32 s63, s59, 0
  v_xor_b32 v231, s63, v230
  v_lshl_add_u32 v240, v231, 6, v229
  v_add_u32 v243, 49152, v240
  s_add_u32 s63, s59, 1
  v_xor_b32 v231, s63, v230
  v_lshl_add_u32 v241, v231, 6, v229
  v_add_u32 v244, 49152, v241
  s_add_u32 s63, s59, 2
  v_xor_b32 v231, s63, v230
  v_lshl_add_u32 v242, v231, 6, v229
  v_add_u32 v245, 49152, v242
  s_lshl_b32 s72, s48, 4
  s_add_u32 s72, s72, s49
  s_lshl_b32 s60, s72, 3
  v_mov_b32 v255, s60
  s_lshl_b32 s61, s72, 8
  s_add_u32 s61, s61, 0x2000000
  v_and_b32 v231, 7, v30
  v_lshlrev_b32 v231, 2, v231
  v_add_u32 v254, s61, v231
  s_add_u32 s60, s60, s50
  s_mul_i32 s75, s60, 49152
  s_lshl_b32 s61, s58, 13
  s_add_u32 s75, s75, s61
  s_add_u32 s75, s75, 0x2100000
  s_mul_i32 s71, s60, 110592
  s_mul_i32 s60, s59, 3
  s_add_u32 s60, s60, s58
  s_lshl_b32 s60, s60, 11
  s_add_u32 s71, s71, s60
  v_lshlrev_b32 v249, 4, v30
  s_lshl_b32 s60, s58, 13
  s_add_u32 s60, s60, 65536
  v_add_u32 v250, s60, v249
  v_add_u32 v251, 49152, v250
  v_add_u32 v28, s50, v255
  v_mov_b32 v29, 1
  v_mov_b32 v252, 0
  v_mov_b32 v253, 0
  s_lshr_b32 s4, s2, 3
  s_cmp_eq_u32 s51, 6
  s_cselect_b32 s4, s4, 255
  s_and_b32 s5, s4, 0x8f
  v_lshlrev_b32 v26, 4, v30
  v_add_u32 v26, s67, v26
  s_waitcnt vmcnt(18)
  s_barrier
  s_add_u32 m0, s68, 139264
  s_add_u32 s61, s13, 2
  s_sub_u32 s62, s61, 9
  s_cmp_ge_u32 s61, 9
  s_cselect_b32 s61, s62, s61
  s_lshl_b32 s61, s61, 7
  s_add_u32 s60, s61, s66
  buffer_load_dwordx4 v11, s[24:27], s60 offen offset:0 lds
  buffer_load_dwordx4 v12, s[24:27], s60 offen offset:1024 lds
  buffer_load_dwordx4 v13, s[24:27], s60 offen offset:2048 lds
  buffer_load_dwordx4 v14, s[24:27], s60 offen offset:3072 lds
  s_add_u32 m0, s68, 143360
  s_nop 0
  buffer_load_dwordx4 v15, s[24:27], s60 offen offset:0 lds
  buffer_load_dwordx4 v16, s[24:27], s60 offen offset:1024 lds
  s_add_u32 m0, s67, 98304
  s_add_u32 s61, s13, 2
  s_sub_u32 s62, s61, 9
  s_cmp_ge_u32 s61, 9
  s_cselect_b32 s61, s62, s61
  s_lshl_b32 s61, s61, 19
  s_add_u32 s61, s61, s65
  s_add_u32 s60, s61, 0
  s_add_u32 s60, s60, s1
  buffer_load_dwordx4 v7, s[28:31], s60 offen offset:0 lds
  buffer_load_dwordx4 v8, s[28:31], s60 offen offset:1024 lds
  buffer_load_dwordx4 v9, s[28:31], s60 offen offset:2048 lds
  buffer_load_dwordx4 v10, s[28:31], s60 offen offset:3072 lds
  s_add_u32 m0, s67, 0
  s_add_u32 s60, s74, 0
  s_and_b32 s60, s60, 0x1ffff
  s_add_u32 s60, s60, s64
  s_add_u32 s60, s60, s0
  buffer_load_dwordx4 v2, s[16:19], s60 offen offset:0 nt lds
  buffer_load_dwordx4 v3, s[16:19], s60 offen offset:1024 nt lds
  buffer_load_dwordx4 v4, s[16:19], s60 offen offset:2048 nt lds
  buffer_load_dwordx4 v5, s[16:19], s60 offen offset:3072 nt lds
  s_waitcnt vmcnt(28)
  s_barrier
  s_add_u32 m0, s67, 106496
  s_add_u32 s61, s13, 2
  s_sub_u32 s62, s61, 9
  s_cmp_ge_u32 s61, 9
  s_cselect_b32 s61, s62, s61
  s_lshl_b32 s61, s61, 19
  s_add_u32 s61, s61, s65
  s_add_u32 s60, s61, 262144
  s_add_u32 s60, s60, s1
  buffer_load_dwordx4 v7, s[28:31], s60 offen offset:0 lds
  buffer_load_dwordx4 v8, s[28:31], s60 offen offset:1024 lds
  buffer_load_dwordx4 v9, s[28:31], s60 offen offset:2048 lds
  buffer_load_dwordx4 v10, s[28:31], s60 offen offset:3072 lds
  s_add_u32 m0, s67, 32768
  s_add_u32 s60, s74, 0
  s_and_b32 s60, s60, 0x1ffff
  s_add_u32 s60, s60, s64
  s_add_u32 s60, s60, s0
  buffer_load_dwordx4 v6, s[20:23], s60 offen offset:0 nt lds
  buffer_load_dwordx4 v6, s[20:23], s60 offen offset:1024 nt lds
  buffer_load_dwordx4 v6, s[20:23], s60 offen offset:2048 nt lds
  buffer_load_dwordx4 v6, s[20:23], s60 offen offset:3072 nt lds
  s_waitcnt vmcnt(26)
  s_barrier
  s_add_u32 m0, s68, 114688
  s_add_u32 s61, s13, 3
  s_sub_u32 s62, s61, 9
  s_cmp_ge_u32 s61, 9
  s_cselect_b32 s61, s62, s61
  s_lshl_b32 s61, s61, 7
  s_add_u32 s60, s61, s66
  buffer_load_dwordx4 v11, s[24:27], s60 offen offset:0 lds
  buffer_load_dwordx4 v12, s[24:27], s60 offen offset:1024 lds
  buffer_load_dwordx4 v13, s[24:27], s60 offen offset:2048 lds
  buffer_load_dwordx4 v14, s[24:27], s60 offen offset:3072 lds
  s_add_u32 m0, s68, 118784
  s_nop 0
  buffer_load_dwordx4 v15, s[24:27], s60 offen offset:0 lds
  buffer_load_dwordx4 v16, s[24:27], s60 offen offset:1024 lds
  s_add_u32 m0, s67, 65536
  s_add_u32 s61, s13, 3
  s_sub_u32 s62, s61, 9
  s_cmp_ge_u32 s61, 9
  s_cselect_b32 s61, s62, s61
  s_lshl_b32 s61, s61, 19
  s_add_u32 s61, s61, s65
  s_add_u32 s60, s61, 0
  s_add_u32 s60, s60, s1
  buffer_load_dwordx4 v7, s[28:31], s60 offen offset:0 lds
  buffer_load_dwordx4 v8, s[28:31], s60 offen offset:1024 lds
  buffer_load_dwordx4 v9, s[28:31], s60 offen offset:2048 lds
  buffer_load_dwordx4 v10, s[28:31], s60 offen offset:3072 lds
  s_add_u32 m0, s67, 8192
  s_add_u32 s60, s74, 8192
  s_and_b32 s60, s60, 0x1ffff
  s_add_u32 s60, s60, s64
  s_add_u32 s60, s60, s0
  buffer_load_dwordx4 v2, s[16:19], s60 offen offset:0 nt lds
  buffer_load_dwordx4 v3, s[16:19], s60 offen offset:1024 nt lds
  buffer_load_dwordx4 v4, s[16:19], s60 offen offset:2048 nt lds
  buffer_load_dwordx4 v5, s[16:19], s60 offen offset:3072 nt lds
  s_waitcnt vmcnt(36)
  s_barrier
  s_add_u32 m0, s67, 73728
  s_add_u32 s61, s13, 3
  s_sub_u32 s62, s61, 9
  s_cmp_ge_u32 s61, 9
  s_cselect_b32 s61, s62, s61
  s_lshl_b32 s61, s61, 19
  s_add_u32 s61, s61, s65
  s_add_u32 s60, s61, 262144
  s_add_u32 s60, s60, s1
  buffer_load_dwordx4 v7, s[28:31], s60 offen offset:0 lds
  buffer_load_dwordx4 v8, s[28:31], s60 offen offset:1024 lds
  buffer_load_dwordx4 v9, s[28:31], s60 offen offset:2048 lds
  buffer_load_dwordx4 v10, s[28:31], s60 offen offset:3072 lds
  s_add_u32 m0, s67, 40960
  s_add_u32 s60, s74, 8192
  s_and_b32 s60, s60, 0x1ffff
  s_add_u32 s60, s60, s64
  s_add_u32 s60, s60, s0
  buffer_load_dwordx4 v6, s[20:23], s60 offen offset:0 nt lds
  buffer_load_dwordx4 v6, s[20:23], s60 offen offset:1024 nt lds
  buffer_load_dwordx4 v6, s[20:23], s60 offen offset:2048 nt lds
  buffer_load_dwordx4 v6, s[20:23], s60 offen offset:3072 nt lds
  s_waitcnt vmcnt(34)
  s_barrier
  s_add_u32 m0, s68, 126976
  s_add_u32 s61, s13, 4
  s_sub_u32 s62, s61, 9
  s_cmp_ge_u32 s61, 9
  s_cselect_b32 s61, s62, s61
  s_lshl_b32 s61, s61, 7
  s_add_u32 s60, s61, s66
  buffer_load_dwordx4 v11, s[24:27], s60 offen offset:0 lds
  buffer_load_dwordx4 v12, s[24:27], s60 offen offset:1024 lds
  buffer_load_dwordx4 v13, s[24:27], s60 offen offset:2048 lds
  buffer_load_dwordx4 v14, s[24:27], s60 offen offset:3072 lds
  s_add_u32 m0, s68, 131072
  s_nop 0
  buffer_load_dwordx4 v15, s[24:27], s60 offen offset:0 lds
  buffer_load_dwordx4 v16, s[24:27], s60 offen offset:1024 lds
  s_add_u32 m0, s67, 81920
  s_add_u32 s61, s13, 4
  s_sub_u32 s62, s61, 9
  s_cmp_ge_u32 s61, 9
  s_cselect_b32 s61, s62, s61
  s_lshl_b32 s61, s61, 19
  s_add_u32 s61, s61, s65
  s_add_u32 s60, s61, 0
  s_add_u32 s60, s60, s1
  buffer_load_dwordx4 v7, s[28:31], s60 offen offset:0 lds
  buffer_load_dwordx4 v8, s[28:31], s60 offen offset:1024 lds
  buffer_load_dwordx4 v9, s[28:31], s60 offen offset:2048 lds
  buffer_load_dwordx4 v10, s[28:31], s60 offen offset:3072 lds
  s_add_u32 m0, s67, 16384
  s_add_u32 s60, s74, 16384
  s_and_b32 s60, s60, 0x1ffff
  s_add_u32 s60, s60, s64
  s_add_u32 s60, s60, s0
  buffer_load_dwordx4 v2, s[16:19], s60 offen offset:0 nt lds
  buffer_load_dwordx4 v3, s[16:19], s60 offen offset:1024 nt lds
  buffer_load_dwordx4 v4, s[16:19], s60 offen offset:2048 nt lds
  buffer_load_dwordx4 v5, s[16:19], s60 offen offset:3072 nt lds
  s_waitcnt vmcnt(40)
  s_barrier
  s_add_u32 m0, s67, 90112
  s_add_u32 s61, s13, 4
  s_sub_u32 s62, s61, 9
  s_cmp_ge_u32 s61, 9
  s_cselect_b32 s61, s62, s61
  s_lshl_b32 s61, s61, 19
  s_add_u32 s61, s61, s65
  s_add_u32 s60, s61, 262144
  s_add_u32 s60, s60, s1
  buffer_load_dwordx4 v7, s[28:31], s60 offen offset:0 lds
  buffer_load_dwordx4 v8, s[28:31], s60 offen offset:1024 lds
  buffer_load_dwordx4 v9, s[28:31], s60 offen offset:2048 lds
  buffer_load_dwordx4 v10, s[28:31], s60 offen offset:3072 lds
  s_add_u32 m0, s67, 49152
  s_add_u32 s60, s74, 16384
  s_and_b32 s60, s60, 0x1ffff
  s_add_u32 s60, s60, s64
  s_add_u32 s60, s60, s0
  buffer_load_dwordx4 v6, s[20:23], s60 offen offset:0 nt lds
  buffer_load_dwordx4 v6, s[20:23], s60 offen offset:1024 nt lds
  buffer_load_dwordx4 v6, s[20:23], s60 offen offset:2048 nt lds
  buffer_load_dwordx4 v6, s[20:23], s60 offen offset:3072 nt lds
  s_waitcnt vmcnt(34)
  s_barrier
  s_add_u32 m0, s68, 139264
  s_add_u32 s61, s13, 5
  s_sub_u32 s62, s61, 9
  s_cmp_ge_u32 s61, 9
  s_cselect_b32 s61, s62, s61
  s_lshl_b32 s61, s61, 7
  s_add_u32 s60, s61, s66
  buffer_load_dwordx4 v11, s[24:27], s60 offen offset:0 lds
  buffer_load_dwordx4 v12, s[24:27], s60 offen offset:1024 lds
  buffer_load_dwordx4 v13, s[24:27], s60 offen offset:2048 lds
  buffer_load_dwordx4 v14, s[24:27], s60 offen offset:3072 lds
  s_add_u32 m0, s68, 143360
  s_nop 0
  buffer_load_dwordx4 v15, s[24:27], s60 offen offset:0 lds
  buffer_load_dwordx4 v16, s[24:27], s60 offen offset:1024 lds
  s_add_u32 m0, s67, 98304
  s_add_u32 s61, s13, 5
  s_sub_u32 s62, s61, 9
  s_cmp_ge_u32 s61, 9
  s_cselect_b32 s61, s62, s61
  s_lshl_b32 s61, s61, 19
  s_add_u32 s61, s61, s65
  s_add_u32 s60, s61, 0
  s_add_u32 s60, s60, s1
  buffer_load_dwordx4 v7, s[28:31], s60 offen offset:0 lds
  buffer_load_dwordx4 v8, s[28:31], s60 offen offset:1024 lds
  buffer_load_dwordx4 v9, s[28:31], s60 offen offset:2048 lds
  buffer_load_dwordx4 v10, s[28:31], s60 offen offset:3072 lds
  s_add_u32 m0, s67, 24576
  s_add_u32 s60, s74, 24576
  s_and_b32 s60, s60, 0x1ffff
  s_add_u32 s60, s60, s64
  s_add_u32 s60, s60, s0
  buffer_load_dwordx4 v2, s[16:19], s60 offen offset:0 nt lds
  buffer_load_dwordx4 v3, s[16:19], s60 offen offset:1024 nt lds
  buffer_load_dwordx4 v4, s[16:19], s60 offen offset:2048 nt lds
  buffer_load_dwordx4 v5, s[16:19], s60 offen offset:3072 nt lds
  s_waitcnt vmcnt(40)
  s_barrier
  s_add_u32 m0, s67, 106496
  s_add_u32 s61, s13, 5
  s_sub_u32 s62, s61, 9
  s_cmp_ge_u32 s61, 9
  s_cselect_b32 s61, s62, s61
  s_lshl_b32 s61, s61, 19
  s_add_u32 s61, s61, s65
  s_add_u32 s60, s61, 262144
  s_add_u32 s60, s60, s1
  buffer_load_dwordx4 v7, s[28:31], s60 offen offset:0 lds
  buffer_load_dwordx4 v8, s[28:31], s60 offen offset:1024 lds
  buffer_load_dwordx4 v9, s[28:31], s60 offen offset:2048 lds
  buffer_load_dwordx4 v10, s[28:31], s60 offen offset:3072 lds
  s_add_u32 m0, s67, 57344
  s_add_u32 s60, s74, 24576
  s_and_b32 s60, s60, 0x1ffff
  s_add_u32 s60, s60, s64
  s_add_u32 s60, s60, s0
  buffer_load_dwordx4 v6, s[20:23], s60 offen offset:0 nt lds
  buffer_load_dwordx4 v6, s[20:23], s60 offen offset:1024 nt lds
  buffer_load_dwordx4 v6, s[20:23], s60 offen offset:2048 nt lds
  buffer_load_dwordx4 v6, s[20:23], s60 offen offset:3072 nt lds
  s_waitcnt vmcnt(34)
  s_barrier
  s_add_u32 m0, s68, 114688
  s_add_u32 s61, s13, 6
  s_sub_u32 s62, s61, 9
  s_cmp_ge_u32 s61, 9
  s_cselect_b32 s61, s62, s61
  s_lshl_b32 s61, s61, 7
  s_add_u32 s60, s61, s66
  buffer_load_dwordx4 v11, s[24:27], s60 offen offset:0 lds
  buffer_load_dwordx4 v12, s[24:27], s60 offen offset:1024 lds
  buffer_load_dwordx4 v13, s[24:27], s60 offen offset:2048 lds
  buffer_load_dwordx4 v14, s[24:27], s60 offen offset:3072 lds
  s_add_u32 m0, s68, 118784
  s_nop 0
  buffer_load_dwordx4 v15, s[24:27], s60 offen offset:0 lds
  buffer_load_dwordx4 v16, s[24:27], s60 offen offset:1024 lds
  s_add_u32 m0, s67, 65536
  s_add_u32 s61, s13, 6
  s_sub_u32 s62, s61, 9
  s_cmp_ge_u32 s61, 9
  s_cselect_b32 s61, s62, s61
  s_lshl_b32 s61, s61, 19
  s_add_u32 s61, s61, s65
  s_add_u32 s60, s61, 0
  s_add_u32 s60, s60, s1
  buffer_load_dwordx4 v7, s[28:31], s60 offen offset:0 lds
  buffer_load_dwordx4 v8, s[28:31], s60 offen offset:1024 lds
  buffer_load_dwordx4 v9, s[28:31], s60 offen offset:2048 lds
  buffer_load_dwordx4 v10, s[28:31], s60 offen offset:3072 lds
  s_waitcnt vmcnt(36)
  s_barrier
  s_add_u32 m0, s67, 73728
  s_add_u32 s61, s13, 6
  s_sub_u32 s62, s61, 9
  s_cmp_ge_u32 s61, 9
  s_cselect_b32 s61, s62, s61
  s_lshl_b32 s61, s61, 19
  s_add_u32 s61, s61, s65
  s_add_u32 s60, s61, 262144
  s_add_u32 s60, s60, s1
  buffer_load_dwordx4 v7, s[28:31], s60 offen offset:0 lds
  buffer_load_dwordx4 v8, s[28:31], s60 offen offset:1024 lds
  buffer_load_dwordx4 v9, s[28:31], s60 offen offset:2048 lds
  buffer_load_dwordx4 v10, s[28:31], s60 offen offset:3072 lds
  s_waitcnt vmcnt(26)
  s_barrier
  s_add_u32 m0, s68, 126976
  s_add_u32 s61, s13, 7
  s_sub_u32 s62, s61, 9
  s_cmp_ge_u32 s61, 9
  s_cselect_b32 s61, s62, s61
  s_lshl_b32 s61, s61, 7
  s_add_u32 s60, s61, s66
  buffer_load_dwordx4 v11, s[24:27], s60 offen offset:0 lds
  buffer_load_dwordx4 v12, s[24:27], s60 offen offset:1024 lds
  buffer_load_dwordx4 v13, s[24:27], s60 offen offset:2048 lds
  buffer_load_dwordx4 v14, s[24:27], s60 offen offset:3072 lds
  s_add_u32 m0, s68, 131072
  s_nop 0
  buffer_load_dwordx4 v15, s[24:27], s60 offen offset:0 lds
  buffer_load_dwordx4 v16, s[24:27], s60 offen offset:1024 lds
  s_add_u32 m0, s67, 81920
  s_add_u32 s61, s13, 7
  s_sub_u32 s62, s61, 9
  s_cmp_ge_u32 s61, 9
  s_cselect_b32 s61, s62, s61
  s_lshl_b32 s61, s61, 19
  s_add_u32 s61, s61, s65
  s_add_u32 s60, s61, 0
  s_add_u32 s60, s60, s1
  buffer_load_dwordx4 v7, s[28:31], s60 offen offset:0 lds
  buffer_load_dwordx4 v8, s[28:31], s60 offen offset:1024 lds
  buffer_load_dwordx4 v9, s[28:31], s60 offen offset:2048 lds
  buffer_load_dwordx4 v10, s[28:31], s60 offen offset:3072 lds
  s_waitcnt vmcnt(28)
  s_barrier
  s_add_u32 m0, s67, 90112
  s_add_u32 s61, s13, 7
  s_sub_u32 s62, s61, 9
  s_cmp_ge_u32 s61, 9
  s_cselect_b32 s61, s62, s61
  s_lshl_b32 s61, s61, 19
  s_add_u32 s61, s61, s65
  s_add_u32 s60, s61, 262144
  s_add_u32 s60, s60, s1
  buffer_load_dwordx4 v7, s[28:31], s60 offen offset:0 lds
  buffer_load_dwordx4 v8, s[28:31], s60 offen offset:1024 lds
  buffer_load_dwordx4 v9, s[28:31], s60 offen offset:2048 lds
  buffer_load_dwordx4 v10, s[28:31], s60 offen offset:3072 lds
  s_waitcnt vmcnt(18)
  s_barrier
  s_add_u32 m0, s68, 139264
  s_add_u32 s61, s13, 8
  s_sub_u32 s62, s61, 9
  s_cmp_ge_u32 s61, 9
  s_cselect_b32 s61, s62, s61
  s_lshl_b32 s61, s61, 7
  s_add_u32 s60, s61, s66
  buffer_load_dwordx4 v11, s[24:27], s60 offen offset:0 lds
  buffer_load_dwordx4 v12, s[24:27], s60 offen offset:1024 lds
  buffer_load_dwordx4 v13, s[24:27], s60 offen offset:2048 lds
  buffer_load_dwordx4 v14, s[24:27], s60 offen offset:3072 lds
  s_add_u32 m0, s68, 143360
  s_nop 0
  buffer_load_dwordx4 v15, s[24:27], s60 offen offset:0 lds
  buffer_load_dwordx4 v16, s[24:27], s60 offen offset:1024 lds
  s_add_u32 m0, s67, 98304
  s_add_u32 s61, s13, 8
  s_sub_u32 s62, s61, 9
  s_cmp_ge_u32 s61, 9
  s_cselect_b32 s61, s62, s61
  s_lshl_b32 s61, s61, 19
  s_add_u32 s61, s61, s65
  s_add_u32 s60, s61, 0
  s_add_u32 s60, s60, s1
  buffer_load_dwordx4 v7, s[28:31], s60 offen offset:0 lds
  buffer_load_dwordx4 v8, s[28:31], s60 offen offset:1024 lds
  buffer_load_dwordx4 v9, s[28:31], s60 offen offset:2048 lds
  buffer_load_dwordx4 v10, s[28:31], s60 offen offset:3072 lds
  s_waitcnt vmcnt(24)
  s_barrier
  s_add_u32 m0, s67, 106496
  s_add_u32 s61, s13, 8
  s_sub_u32 s62, s61, 9
  s_cmp_ge_u32 s61, 9
  s_cselect_b32 s61, s62, s61
  s_lshl_b32 s61, s61, 19
  s_add_u32 s61, s61, s65
  s_add_u32 s60, s61, 262144
  s_add_u32 s60, s60, s1
  buffer_load_dwordx4 v7, s[28:31], s60 offen offset:0 lds
  buffer_load_dwordx4 v8, s[28:31], s60 offen offset:1024 lds
  buffer_load_dwordx4 v9, s[28:31], s60 offen offset:2048 lds
  buffer_load_dwordx4 v10, s[28:31], s60 offen offset:3072 lds
  s_waitcnt vmcnt(18)
  s_barrier
  s_add_u32 m0, s68, 114688
  s_add_u32 s61, s13, 0
  s_sub_u32 s62, s61, 9
  s_cmp_ge_u32 s61, 9
  s_cselect_b32 s61, s62, s61
  s_lshl_b32 s61, s61, 7
  s_add_u32 s60, s61, s66
  buffer_load_dwordx4 v11, s[24:27], s60 offen offset:0 lds
  buffer_load_dwordx4 v12, s[24:27], s60 offen offset:1024 lds
  buffer_load_dwordx4 v13, s[24:27], s60 offen offset:2048 lds
  buffer_load_dwordx4 v14, s[24:27], s60 offen offset:3072 lds
  s_add_u32 m0, s68, 118784
  s_nop 0
  buffer_load_dwordx4 v15, s[24:27], s60 offen offset:0 lds
  buffer_load_dwordx4 v16, s[24:27], s60 offen offset:1024 lds
  s_add_u32 m0, s67, 65536
  s_add_u32 s61, s13, 0
  s_sub_u32 s62, s61, 9
  s_cmp_ge_u32 s61, 9
  s_cselect_b32 s61, s62, s61
  s_lshl_b32 s61, s61, 19
  s_add_u32 s61, s61, s65
  s_add_u32 s60, s61, 0
  s_sub_u32 s60, s60, s1
  s_add_u32 s60, s60, 256
  buffer_load_dwordx4 v7, s[28:31], s60 offen offset:0 lds
  buffer_load_dwordx4 v8, s[28:31], s60 offen offset:1024 lds
  buffer_load_dwordx4 v9, s[28:31], s60 offen offset:2048 lds
  buffer_load_dwordx4 v10, s[28:31], s60 offen offset:3072 lds
  s_waitcnt vmcnt(24)
  s_barrier
  s_add_u32 m0, s67, 73728
  s_add_u32 s61, s13, 0
  s_sub_u32 s62, s61, 9
  s_cmp_ge_u32 s61, 9
  s_cselect_b32 s61, s62, s61
  s_lshl_b32 s61, s61, 19
  s_add_u32 s61, s61, s65
  s_add_u32 s60, s61, 262144
  s_sub_u32 s60, s60, s1
  s_add_u32 s60, s60, 256
  buffer_load_dwordx4 v7, s[28:31], s60 offen offset:0 lds
  buffer_load_dwordx4 v8, s[28:31], s60 offen offset:1024 lds
  buffer_load_dwordx4 v9, s[28:31], s60 offen offset:2048 lds
  buffer_load_dwordx4 v10, s[28:31], s60 offen offset:3072 lds
  s_waitcnt vmcnt(18)
  s_barrier
  s_add_u32 m0, s68, 126976
  s_add_u32 s61, s13, 1
  s_sub_u32 s62, s61, 9
  s_cmp_ge_u32 s61, 9
  s_cselect_b32 s61, s62, s61
  s_lshl_b32 s61, s61, 7
  s_add_u32 s60, s61, s66
  buffer_load_dwordx4 v11, s[24:27], s60 offen offset:0 lds
  buffer_load_dwordx4 v12, s[24:27], s60 offen offset:1024 lds
  buffer_load_dwordx4 v13, s[24:27], s60 offen offset:2048 lds
  buffer_load_dwordx4 v14, s[24:27], s60 offen offset:3072 lds
  s_add_u32 m0, s68, 131072
  s_nop 0
  buffer_load_dwordx4 v15, s[24:27], s60 offen offset:0 lds
  buffer_load_dwordx4 v16, s[24:27], s60 offen offset:1024 lds
  s_add_u32 m0, s67, 81920
  s_add_u32 s61, s13, 1
  s_sub_u32 s62, s61, 9
  s_cmp_ge_u32 s61, 9
  s_cselect_b32 s61, s62, s61
  s_lshl_b32 s61, s61, 19
  s_add_u32 s61, s61, s65
  s_add_u32 s60, s61, 0
  s_sub_u32 s60, s60, s1
  s_add_u32 s60, s60, 256
  buffer_load_dwordx4 v7, s[28:31], s60 offen offset:0 lds
  buffer_load_dwordx4 v8, s[28:31], s60 offen offset:1024 lds
  buffer_load_dwordx4 v9, s[28:31], s60 offen offset:2048 lds
  buffer_load_dwordx4 v10, s[28:31], s60 offen offset:3072 lds
  s_waitcnt vmcnt(24)
  s_barrier
  s_add_u32 m0, s67, 90112
  s_add_u32 s61, s13, 1
  s_sub_u32 s62, s61, 9
  s_cmp_ge_u32 s61, 9
  s_cselect_b32 s61, s62, s61
  s_lshl_b32 s61, s61, 19
  s_add_u32 s61, s61, s65
  s_add_u32 s60, s61, 262144
  s_sub_u32 s60, s60, s1
  s_add_u32 s60, s60, 256
  buffer_load_dwordx4 v7, s[28:31], s60 offen offset:0 lds
  buffer_load_dwordx4 v8, s[28:31], s60 offen offset:1024 lds
  buffer_load_dwordx4 v9, s[28:31], s60 offen offset:2048 lds
  buffer_load_dwordx4 v10, s[28:31], s60 offen offset:3072 lds
  s_waitcnt vmcnt(18)
  s_barrier
  s_add_u32 m0, s68, 139264
  s_add_u32 s61, s13, 2
  s_sub_u32 s62, s61, 9
  s_cmp_ge_u32 s61, 9
  s_cselect_b32 s61, s62, s61
  s_lshl_b32 s61, s61, 7
  s_add_u32 s60, s61, s66
  buffer_load_dwordx4 v11, s[24:27], s60 offen offset:0 lds
  buffer_load_dwordx4 v12, s[24:27], s60 offen offset:1024 lds
  buffer_load_dwordx4 v13, s[24:27], s60 offen offset:2048 lds
  buffer_load_dwordx4 v14, s[24:27], s60 offen offset:3072 lds
  s_add_u32 m0, s68, 143360
  s_nop 0
  buffer_load_dwordx4 v15, s[24:27], s60 offen offset:0 lds
  buffer_load_dwordx4 v16, s[24:27], s60 offen offset:1024 lds
  s_add_u32 m0, s67, 98304
  s_add_u32 s61, s13, 2
  s_sub_u32 s62, s61, 9
  s_cmp_ge_u32 s61, 9
  s_cselect_b32 s61, s62, s61
  s_lshl_b32 s61, s61, 19
  s_add_u32 s61, s61, s65
  s_add_u32 s60, s61, 0
  s_sub_u32 s60, s60, s1
  s_add_u32 s60, s60, 256
  buffer_load_dwordx4 v7, s[28:31], s60 offen offset:0 lds
  buffer_load_dwordx4 v8, s[28:31], s60 offen offset:1024 lds
  buffer_load_dwordx4 v9, s[28:31], s60 offen offset:2048 lds
  buffer_load_dwordx4 v10, s[28:31], s60 offen offset:3072 lds
  s_waitcnt vmcnt(24)
  s_barrier
  s_add_u32 m0, s67, 106496
  s_add_u32 s61, s13, 2
  s_sub_u32 s62, s61, 9
  s_cmp_ge_u32 s61, 9
  s_cselect_b32 s61, s62, s61
  s_lshl_b32 s61, s61, 19
  s_add_u32 s61, s61, s65
  s_add_u32 s60, s61, 262144
  s_sub_u32 s60, s60, s1
  s_add_u32 s60, s60, 256
  buffer_load_dwordx4 v7, s[28:31], s60 offen offset:0 lds
  buffer_load_dwordx4 v8, s[28:31], s60 offen offset:1024 lds
  buffer_load_dwordx4 v9, s[28:31], s60 offen offset:2048 lds
  buffer_load_dwordx4 v10, s[28:31], s60 offen offset:3072 lds
  s_waitcnt vmcnt(18)
  s_barrier
  s_cmp_lg_u32 s4, 0
  s_cbranch_scc1 L_hs1_20
  s_mov_b64 exec, 1
  global_store_byte v28, v29, s[46:47] sc1
  s_mov_b64 exec, -1
L_hs1_20:
  s_add_u32 s60, s12, 0
  s_add_u32 s60, s60, s10
  s_add_u32 s60, s60, s1
  buffer_load_dword v27, v24, s[28:31], s60 offen nt
  buffer_load_dword v27, v24, s[28:31], s60 offen sc1
  s_add_u32 m0, s67, 0
  s_add_u32 s60, s74, 32768
  s_and_b32 s60, s60, 0x1ffff
  s_add_u32 s60, s60, s64
  s_add_u32 s60, s60, s0
  buffer_load_dwordx4 v2, s[16:19], s60 offen offset:0 nt lds
  buffer_load_dwordx4 v3, s[16:19], s60 offen offset:1024 nt lds
  buffer_load_dwordx4 v4, s[16:19], s60 offen offset:2048 nt lds
  buffer_load_dwordx4 v5, s[16:19], s60 offen offset:3072 nt lds
  s_add_u32 m0, s68, 114688
  s_add_u32 s61, s13, 3
  s_sub_u32 s62, s61, 9
  s_cmp_ge_u32 s61, 9
  s_cselect_b32 s61, s62, s61
  s_lshl_b32 s61, s61, 7
  s_add_u32 s60, s61, s66
  buffer_load_dwordx4 v11, s[24:27], s60 offen offset:0 lds
  buffer_load_dwordx4 v12, s[24:27], s60 offen offset:1024 lds
  buffer_load_dwordx4 v13, s[24:27], s60 offen offset:2048 lds
  buffer_load_dwordx4 v14, s[24:27], s60 offen offset:3072 lds
  s_add_u32 m0, s68, 118784
  s_nop 0
  buffer_load_dwordx4 v15, s[24:27], s60 offen offset:0 lds
  buffer_load_dwordx4 v16, s[24:27], s60 offen offset:1024 lds
  s_add_u32 m0, s67, 65536
  s_add_u32 s61, s13, 3
  s_sub_u32 s62, s61, 9
  s_cmp_ge_u32 s61, 9
  s_cselect_b32 s61, s62, s61
  s_lshl_b32 s61, s61, 19
  s_add_u32 s61, s61, s65
  s_add_u32 s60, s61, 0
  s_sub_u32 s60, s60, s1
  s_add_u32 s60, s60, 256
  buffer_load_dwordx4 v7, s[28:31], s60 offen offset:0 lds
  buffer_load_dwordx4 v8, s[28:31], s60 offen offset:1024 lds
  buffer_load_dwordx4 v9, s[28:31], s60 offen offset:2048 lds
  buffer_load_dwordx4 v10, s[28:31], s60 offen offset:3072 lds
  s_waitcnt vmcnt(30)
  s_barrier
  s_cmp_lg_u32 s4, 1
  s_cbranch_scc1 L_hs1_21
  s_mov_b64 exec, 1
  global_store_byte v28, v29, s[46:47] sc1
  s_mov_b64 exec, -1
L_hs1_21:
  s_add_u32 s60, s12, 0
  s_add_u32 s60, s60, s10
  s_sub_u32 s60, s60, s1
  s_add_u32 s60, s60, 256
  buffer_load_dword v27, v24, s[28:31], s60 offen nt
  buffer_load_dword v27, v24, s[28:31], s60 offen sc1
  s_add_u32 m0, s67, 8192
  s_add_u32 s60, s74, 40960
  s_and_b32 s60, s60, 0x1ffff
  s_add_u32 s60, s60, s64
  s_add_u32 s60, s60, s0
  buffer_load_dwordx4 v2, s[16:19], s60 offen offset:0 nt lds
  buffer_load_dwordx4 v3, s[16:19], s60 offen offset:1024 nt lds
  buffer_load_dwordx4 v4, s[16:19], s60 offen offset:2048 nt lds
  buffer_load_dwordx4 v5, s[16:19], s60 offen offset:3072 nt lds
  s_add_u32 m0, s67, 73728
  s_add_u32 s61, s13, 3
  s_sub_u32 s62, s61, 9
  s_cmp_ge_u32 s61, 9
  s_cselect_b32 s61, s62, s61
  s_lshl_b32 s61, s61, 19
  s_add_u32 s61, s61, s65
  s_add_u32 s60, s61, 262144
  s_sub_u32 s60, s60, s1
  s_add_u32 s60, s60, 256
  buffer_load_dwordx4 v7, s[28:31], s60 offen offset:0 lds
  buffer_load_dwordx4 v8, s[28:31], s60 offen offset:1024 lds
  buffer_load_dwordx4 v9, s[28:31], s60 offen offset:2048 lds
  buffer_load_dwordx4 v10, s[28:31], s60 offen offset:3072 lds
  s_waitcnt vmcnt(20)
  s_barrier
  s_cmp_lg_u32 s4, 2
  s_cbranch_scc1 L_hs1_22
  s_mov_b64 exec, 1
  global_store_byte v28, v29, s[46:47] sc1
  s_mov_b64 exec, -1
L_hs1_22:
  s_add_u32 m0, s67, 16384
  s_add_u32 s60, s74, 49152
  s_and_b32 s60, s60, 0x1ffff
  s_add_u32 s60, s60, s64
  s_add_u32 s60, s60, s0
  buffer_load_dwordx4 v2, s[16:19], s60 offen offset:0 nt lds
  buffer_load_dwordx4 v3, s[16:19], s60 offen offset:1024 nt lds
  buffer_load_dwordx4 v4, s[16:19], s60 offen offset:2048 nt lds
  buffer_load_dwordx4 v5, s[16:19], s60 offen offset:3072 nt lds
  s_add_u32 m0, s67, 32768
  s_add_u32 s60, s74, 32768
  s_and_b32 s60, s60, 0x1ffff
  s_add_u32 s60, s60, s64
  s_add_u32 s60, s60, s0
  buffer_load_dwordx4 v6, s[20:23], s60 offen offset:0 nt lds
  buffer_load_dwordx4 v6, s[20:23], s60 offen offset:1024 nt lds
  buffer_load_dwordx4 v6, s[20:23], s60 offen offset:2048 nt lds
  buffer_load_dwordx4 v6, s[20:23], s60 offen offset:3072 nt lds
  s_add_u32 m0, s68, 126976
  s_add_u32 s61, s13, 4
  s_sub_u32 s62, s61, 9
  s_cmp_ge_u32 s61, 9
  s_cselect_b32 s61, s62, s61
  s_lshl_b32 s61, s61, 7
  s_add_u32 s60, s61, s66
  buffer_load_dwordx4 v11, s[24:27], s60 offen offset:0 lds
  buffer_load_dwordx4 v12, s[24:27], s60 offen offset:1024 lds
  buffer_load_dwordx4 v13, s[24:27], s60 offen offset:2048 lds
  buffer_load_dwordx4 v14, s[24:27], s60 offen offset:3072 lds
  s_add_u32 m0, s68, 131072
  s_nop 0
  buffer_load_dwordx4 v15, s[24:27], s60 offen offset:0 lds
  buffer_load_dwordx4 v16, s[24:27], s60 offen offset:1024 lds
  s_add_u32 m0, s67, 81920
  s_add_u32 s61, s13, 4
  s_sub_u32 s62, s61, 9
  s_cmp_ge_u32 s61, 9
  s_cselect_b32 s61, s62, s61
  s_lshl_b32 s61, s61, 19
  s_add_u32 s61, s61, s65
  s_add_u32 s60, s61, 0
  s_sub_u32 s60, s60, s1
  s_add_u32 s60, s60, 256
  buffer_load_dwordx4 v7, s[28:31], s60 offen offset:0 lds
  buffer_load_dwordx4 v8, s[28:31], s60 offen offset:1024 lds
  buffer_load_dwordx4 v9, s[28:31], s60 offen offset:2048 lds
  buffer_load_dwordx4 v10, s[28:31], s60 offen offset:3072 lds
  s_waitcnt vmcnt(22)
  s_barrier
  s_cmp_lg_u32 s4, 3
  s_cbranch_scc1 L_hs1_23
  s_mov_b64 exec, 1
  global_store_byte v28, v29, s[46:47] sc1
  s_mov_b64 exec, -1
L_hs1_23:
  s_add_u32 m0, s67, 24576
  s_add_u32 s60, s74, 57344
  s_and_b32 s60, s60, 0x1ffff
  s_add_u32 s60, s60, s64
  s_add_u32 s60, s60, s0
  buffer_load_dwordx4 v2, s[16:19], s60 offen offset:0 nt lds
  buffer_load_dwordx4 v3, s[16:19], s60 offen offset:1024 nt lds
  buffer_load_dwordx4 v4, s[16:19], s60 offen offset:2048 nt lds
  buffer_load_dwordx4 v5, s[16:19], s60 offen offset:3072 nt lds
  s_add_u32 m0, s67, 40960
  s_add_u32 s60, s74, 40960
  s_and_b32 s60, s60, 0x1ffff
  s_add_u32 s60, s60, s64
  s_add_u32 s60, s60, s0
  buffer_load_dwordx4 v6, s[20:23], s60 offen offset:0 nt lds
  buffer_load_dwordx4 v6, s[20:23], s60 offen offset:1024 nt lds
  buffer_load_dwordx4 v6, s[20:23], s60 offen offset:2048 nt lds
  buffer_load_dwordx4 v6, s[20:23], s60 offen offset:3072 nt lds
  s_add_u32 m0, s67, 90112
  s_add_u32 s61, s13, 4
  s_sub_u32 s62, s61, 9
  s_cmp_ge_u32 s61, 9
  s_cselect_b32 s61, s62, s61
  s_lshl_b32 s61, s61, 19
  s_add_u32 s61, s61, s65
  s_add_u32 s60, s61, 262144
  s_sub_u32 s60, s60, s1
  s_add_u32 s60, s60, 256
  buffer_load_dwordx4 v7, s[28:31], s60 offen offset:0 lds
  buffer_load_dwordx4 v8, s[28:31], s60 offen offset:1024 lds
  buffer_load_dwordx4 v9, s[28:31], s60 offen offset:2048 lds
  buffer_load_dwordx4 v10, s[28:31], s60 offen offset:3072 lds
  s_waitcnt vmcnt(22)
  s_barrier
  s_cmp_lg_u32 s4, 4
  s_cbranch_scc1 L_hs1_24
  s_mov_b64 exec, 1
  global_store_byte v28, v29, s[46:47] sc1
  s_mov_b64 exec, -1
L_hs1_24:
  s_add_u32 m0, s67, 0
  s_add_u32 s60, s74, 65536
  s_and_b32 s60, s60, 0x1ffff
  s_add_u32 s60, s60, s64
  s_add_u32 s60, s60, s0
  buffer_load_dwordx4 v2, s[16:19], s60 offen offset:0 nt lds
  buffer_load_dwordx4 v3, s[16:19], s60 offen offset:1024 nt lds
  buffer_load_dwordx4 v4, s[16:19], s60 offen offset:2048 nt lds
  buffer_load_dwordx4 v5, s[16:19], s60 offen offset:3072 nt lds
  s_add_u32 m0, s67, 49152
  s_add_u32 s60, s74, 49152
  s_and_b32 s60, s60, 0x1ffff
  s_add_u32 s60, s60, s64
  s_add_u32 s60, s60, s0
  buffer_load_dwordx4 v6, s[20:23], s60 offen offset:0 nt lds
  buffer_load_dwordx4 v6, s[20:23], s60 offen offset:1024 nt lds
  buffer_load_dwordx4 v6, s[20:23], s60 offen offset:2048 nt lds
  buffer_load_dwordx4 v6, s[20:23], s60 offen offset:3072 nt lds
  s_add_u32 m0, s68, 139264
  s_add_u32 s61, s13, 5
  s_sub_u32 s62, s61, 9
  s_cmp_ge_u32 s61, 9
  s_cselect_b32 s61, s62, s61
  s_lshl_b32 s61, s61, 7
  s_add_u32 s60, s61, s66
  buffer_load_dwordx4 v11, s[24:27], s60 offen offset:0 lds
  buffer_load_dwordx4 v12, s[24:27], s60 offen offset:1024 lds
  buffer_load_dwordx4 v13, s[24:27], s60 offen offset:2048 lds
  buffer_load_dwordx4 v14, s[24:27], s60 offen offset:3072 lds
  s_add_u32 m0, s68, 143360
  s_nop 0
  buffer_load_dwordx4 v15, s[24:27], s60 offen offset:0 lds
  buffer_load_dwordx4 v16, s[24:27], s60 offen offset:1024 lds
  s_add_u32 m0, s67, 98304
  s_add_u32 s61, s13, 5
  s_sub_u32 s62, s61, 9
  s_cmp_ge_u32 s61, 9
  s_cselect_b32 s61, s62, s61
  s_lshl_b32 s61, s61, 19
  s_add_u32 s61, s61, s65
  s_add_u32 s60, s61, 0
  s_sub_u32 s60, s60, s1
  s_add_u32 s60, s60, 256
  buffer_load_dwordx4 v7, s[28:31], s60 offen offset:0 lds
  buffer_load_dwordx4 v8, s[28:31], s60 offen offset:1024 lds
  buffer_load_dwordx4 v9, s[28:31], s60 offen offset:2048 lds
  buffer_load_dwordx4 v10, s[28:31], s60 offen offset:3072 lds
  s_waitcnt vmcnt(22)
  s_barrier
  s_cmp_lg_u32 s4, 5
  s_cbranch_scc1 L_hs1_25
  s_mov_b64 exec, 1
  global_store_byte v28, v29, s[46:47] sc1
  s_mov_b64 exec, -1
L_hs1_25:
  s_add_u32 m0, s67, 8192
  s_add_u32 s60, s74, 73728
  s_and_b32 s60, s60, 0x1ffff
  s_add_u32 s60, s60, s64
  s_add_u32 s60, s60, s0
  buffer_load_dwordx4 v2, s[16:19], s60 offen offset:0 nt lds
  buffer_load_dwordx4 v3, s[16:19], s60 offen offset:1024 nt lds
  buffer_load_dwordx4 v4, s[16:19], s60 offen offset:2048 nt lds
  buffer_load_dwordx4 v5, s[16:19], s60 offen offset:3072 nt lds
  s_add_u32 m0, s67, 57344
  s_add_u32 s60, s74, 57344
  s_and_b32 s60, s60, 0x1ffff
  s_add_u32 s60, s60, s64
  s_add_u32 s60, s60, s0
  buffer_load_dwordx4 v6, s[20:23], s60 offen offset:0 nt lds
  buffer_load_dwordx4 v6, s[20:23], s60 offen offset:1024 nt lds
  buffer_load_dwordx4 v6, s[20:23], s60 offen offset:2048 nt lds
  buffer_load_dwordx4 v6, s[20:23], s60 offen offset:3072 nt lds
  s_add_u32 m0, s67, 106496
  s_add_u32 s61, s13, 5
  s_sub_u32 s62, s61, 9
  s_cmp_ge_u32 s61, 9
  s_cselect_b32 s61, s62, s61
  s_lshl_b32 s61, s61, 19
  s_add_u32 s61, s61, s65
  s_add_u32 s60, s61, 262144
  s_sub_u32 s60, s60, s1
  s_add_u32 s60, s60, 256
  buffer_load_dwordx4 v7, s[28:31], s60 offen offset:0 lds
  buffer_load_dwordx4 v8, s[28:31], s60 offen offset:1024 lds
  buffer_load_dwordx4 v9, s[28:31], s60 offen offset:2048 lds
  buffer_load_dwordx4 v10, s[28:31], s60 offen offset:3072 lds
  s_waitcnt vmcnt(22)
  s_barrier
  s_cmp_lg_u32 s4, 6
  s_cbranch_scc1 L_hs1_26
  s_mov_b64 exec, 1
  global_store_byte v28, v29, s[46:47] sc1
  s_mov_b64 exec, -1
L_hs1_26:
  s_add_u32 m0, s67, 16384
  s_add_u32 s60, s74, 81920
  s_and_b32 s60, s60, 0x1ffff
  s_add_u32 s60, s60, s64
  s_add_u32 s60, s60, s0
  buffer_load_dwordx4 v2, s[16:19], s60 offen offset:0 nt lds
  buffer_load_dwordx4 v3, s[16:19], s60 offen offset:1024 nt lds
  buffer_load_dwordx4 v4, s[16:19], s60 offen offset:2048 nt lds
  buffer_load_dwordx4 v5, s[16:19], s60 offen offset:3072 nt lds
  s_add_u32 m0, s67, 32768
  s_add_u32 s60, s74, 65536
  s_and_b32 s60, s60, 0x1ffff
  s_add_u32 s60, s60, s64
  s_add_u32 s60, s60, s0
  buffer_load_dwordx4 v6, s[20:23], s60 offen offset:0 nt lds
  buffer_load_dwordx4 v6, s[20:23], s60 offen offset:1024 nt lds
  buffer_load_dwordx4 v6, s[20:23], s60 offen offset:2048 nt lds
  buffer_load_dwordx4 v6, s[20:23], s60 offen offset:3072 nt lds
  s_add_u32 m0, s68, 114688
  s_add_u32 s61, s13, 6
  s_sub_u32 s62, s61, 9
  s_cmp_ge_u32 s61, 9
  s_cselect_b32 s61, s62, s61
  s_lshl_b32 s61, s61, 7
  s_add_u32 s60, s61, s66
  buffer_load_dwordx4 v11, s[24:27], s60 offen offset:0 lds
  buffer_load_dwordx4 v12, s[24:27], s60 offen offset:1024 lds
  buffer_load_dwordx4 v13, s[24:27], s60 offen offset:2048 lds
  buffer_load_dwordx4 v14, s[24:27], s60 offen offset:3072 lds
  s_add_u32 m0, s68, 118784
  s_nop 0
  buffer_load_dwordx4 v15, s[24:27], s60 offen offset:0 lds
  buffer_load_dwordx4 v16, s[24:27], s60 offen offset:1024 lds
  s_add_u32 m0, s67, 65536
  s_add_u32 s61, s13, 6
  s_sub_u32 s62, s61, 9
  s_cmp_ge_u32 s61, 9
  s_cselect_b32 s61, s62, s61
  s_lshl_b32 s61, s61, 19
  s_add_u32 s61, s61, s65
  s_add_u32 s60, s61, 0
  s_sub_u32 s60, s60, s1
  s_add_u32 s60, s60, 256
  buffer_load_dwordx4 v7, s[28:31], s60 offen offset:0 lds
  buffer_load_dwordx4 v8, s[28:31], s60 offen offset:1024 lds
  buffer_load_dwordx4 v9, s[28:31], s60 offen offset:2048 lds
  buffer_load_dwordx4 v10, s[28:31], s60 offen offset:3072 lds
  s_waitcnt vmcnt(22)
  s_barrier
  s_cmp_lg_u32 s4, 7
  s_cbranch_scc1 L_hs1_27
  s_mov_b64 exec, 1
  global_store_byte v28, v29, s[46:47] sc1
  s_mov_b64 exec, -1
L_hs1_27:
  s_add_u32 m0, s67, 24576
  s_add_u32 s60, s74, 90112
  s_and_b32 s60, s60, 0x1ffff
  s_add_u32 s60, s60, s64
  s_add_u32 s60, s60, s0
  buffer_load_dwordx4 v2, s[16:19], s60 offen offset:0 nt lds
  buffer_load_dwordx4 v3, s[16:19], s60 offen offset:1024 nt lds
  buffer_load_dwordx4 v4, s[16:19], s60 offen offset:2048 nt lds
  buffer_load_dwordx4 v5, s[16:19], s60 offen offset:3072 nt lds
  s_add_u32 m0, s67, 40960
  s_add_u32 s60, s74, 73728
  s_and_b32 s60, s60, 0x1ffff
  s_add_u32 s60, s60, s64
  s_add_u32 s60, s60, s0
  buffer_load_dwordx4 v6, s[20:23], s60 offen offset:0 nt lds
  buffer_load_dwordx4 v6, s[20:23], s60 offen offset:1024 nt lds
  buffer_load_dwordx4 v6, s[20:23], s60 offen offset:2048 nt lds
  buffer_load_dwordx4 v6, s[20:23], s60 offen offset:3072 nt lds
  s_add_u32 m0, s67, 73728
  s_add_u32 s61, s13, 6
  s_sub_u32 s62, s61, 9
  s_cmp_ge_u32 s61, 9
  s_cselect_b32 s61, s62, s61
  s_lshl_b32 s61, s61, 19
  s_add_u32 s61, s61, s65
  s_add_u32 s60, s61, 262144
  s_sub_u32 s60, s60, s1
  s_add_u32 s60, s60, 256
  buffer_load_dwordx4 v7, s[28:31], s60 offen offset:0 lds
  buffer_load_dwordx4 v8, s[28:31], s60 offen offset:1024 lds
  buffer_load_dwordx4 v9, s[28:31], s60 offen offset:2048 lds
  buffer_load_dwordx4 v10, s[28:31], s60 offen offset:3072 lds
  s_waitcnt vmcnt(22)
  s_barrier
  s_cmp_lg_u32 s4, 8
  s_cbranch_scc1 L_hs1_28
  s_mov_b64 exec, 1
  global_store_byte v28, v29, s[46:47] sc1
  s_mov_b64 exec, -1
L_hs1_28:
  s_add_u32 m0, s67, 0
  s_add_u32 s60, s74, 98304
  s_and_b32 s60, s60, 0x1ffff
  s_add_u32 s60, s60, s64
  s_add_u32 s60, s60, s0
  buffer_load_dwordx4 v2, s[16:19], s60 offen offset:0 nt lds
  buffer_load_dwordx4 v3, s[16:19], s60 offen offset:1024 nt lds
  buffer_load_dwordx4 v4, s[16:19], s60 offen offset:2048 nt lds
  buffer_load_dwordx4 v5, s[16:19], s60 offen offset:3072 nt lds
  s_add_u32 m0, s67, 49152
  s_add_u32 s60, s74, 81920
  s_and_b32 s60, s60, 0x1ffff
  s_add_u32 s60, s60, s64
  s_add_u32 s60, s60, s0
  buffer_load_dwordx4 v6, s[20:23], s60 offen offset:0 nt lds
  buffer_load_dwordx4 v6, s[20:23], s60 offen offset:1024 nt lds
  buffer_load_dwordx4 v6, s[20:23], s60 offen offset:2048 nt lds
  buffer_load_dwordx4 v6, s[20:23], s60 offen offset:3072 nt lds
  s_add_u32 m0, s68, 126976
  s_add_u32 s61, s13, 7
  s_sub_u32 s62, s61, 9
  s_cmp_ge_u32 s61, 9
  s_cselect_b32 s61, s62, s61
  s_lshl_b32 s61, s61, 7
  s_add_u32 s60, s61, s66
  buffer_load_dwordx4 v11, s[24:27], s60 offen offset:0 lds
  buffer_load_dwordx4 v12, s[24:27], s60 offen offset:1024 lds
  buffer_load_dwordx4 v13, s[24:27], s60 offen offset:2048 lds
  buffer_load_dwordx4 v14, s[24:27], s60 offen offset:3072 lds
  s_add_u32 m0, s68, 131072
  s_nop 0
  buffer_load_dwordx4 v15, s[24:27], s60 offen offset:0 lds
  buffer_load_dwordx4 v16, s[24:27], s60 offen offset:1024 lds
  s_add_u32 m0, s67, 81920
  s_add_u32 s61, s13, 7
  s_sub_u32 s62, s61, 9
  s_cmp_ge_u32 s61, 9
  s_cselect_b32 s61, s62, s61
  s_lshl_b32 s61, s61, 19
  s_add_u32 s61, s61, s65
  s_add_u32 s60, s61, 0
  s_sub_u32 s60, s60, s1
  s_add_u32 s60, s60, 256
  buffer_load_dwordx4 v7, s[28:31], s60 offen offset:0 lds
  buffer_load_dwordx4 v8, s[28:31], s60 offen offset:1024 lds
  buffer_load_dwordx4 v9, s[28:31], s60 offen offset:2048 lds
  buffer_load_dwordx4 v10, s[28:31], s60 offen offset:3072 lds
  s_waitcnt vmcnt(22)
  s_barrier
  s_cmp_lg_u32 s4, 9
  s_cbranch_scc1 L_hs1_29
  s_mov_b64 exec, 1
  global_store_byte v28, v29, s[46:47] sc1
  s_mov_b64 exec, -1
L_hs1_29:
  s_add_u32 m0, s67, 8192
  s_add_u32 s60, s74, 106496
  s_and_b32 s60, s60, 0x1ffff
  s_add_u32 s60, s60, s64
  s_add_u32 s60, s60, s0
  buffer_load_dwordx4 v2, s[16:19], s60 offen offset:0 nt lds
  buffer_load_dwordx4 v3, s[16:19], s60 offen offset:1024 nt lds
  buffer_load_dwordx4 v4, s[16:19], s60 offen offset:2048 nt lds
  buffer_load_dwordx4 v5, s[16:19], s60 offen offset:3072 nt lds
  s_add_u32 m0, s67, 57344
  s_add_u32 s60, s74, 90112
  s_and_b32 s60, s60, 0x1ffff
  s_add_u32 s60, s60, s64
  s_add_u32 s60, s60, s0
  buffer_load_dwordx4 v6, s[20:23], s60 offen offset:0 nt lds
  buffer_load_dwordx4 v6, s[20:23], s60 offen offset:1024 nt lds
  buffer_load_dwordx4 v6, s[20:23], s60 offen offset:2048 nt lds
  buffer_load_dwordx4 v6, s[20:23], s60 offen offset:3072 nt lds
  s_add_u32 m0, s67, 90112
  s_add_u32 s61, s13, 7
  s_sub_u32 s62, s61, 9
  s_cmp_ge_u32 s61, 9
  s_cselect_b32 s61, s62, s61
  s_lshl_b32 s61, s61, 19
  s_add_u32 s61, s61, s65
  s_add_u32 s60, s61, 262144
  s_sub_u32 s60, s60, s1
  s_add_u32 s60, s60, 256
  buffer_load_dwordx4 v7, s[28:31], s60 offen offset:0 lds
  buffer_load_dwordx4 v8, s[28:31], s60 offen offset:1024 lds
  buffer_load_dwordx4 v9, s[28:31], s60 offen offset:2048 lds
  buffer_load_dwordx4 v10, s[28:31], s60 offen offset:3072 lds
  s_waitcnt vmcnt(22)
  s_barrier
  s_cmp_lg_u32 s4, 10
  s_cbranch_scc1 L_hs1_30
  s_mov_b64 exec, 1
  global_store_byte v28, v29, s[46:47] sc1
  s_mov_b64 exec, -1
L_hs1_30:
  s_add_u32 m0, s67, 16384
  s_add_u32 s60, s74, 114688
  s_and_b32 s60, s60, 0x1ffff
  s_add_u32 s60, s60, s64
  s_add_u32 s60, s60, s0
  buffer_load_dwordx4 v2, s[16:19], s60 offen offset:0 nt lds
  buffer_load_dwordx4 v3, s[16:19], s60 offen offset:1024 nt lds
  buffer_load_dwordx4 v4, s[16:19], s60 offen offset:2048 nt lds
  buffer_load_dwordx4 v5, s[16:19], s60 offen offset:3072 nt lds
  s_add_u32 m0, s67, 32768
  s_add_u32 s60, s74, 98304
  s_and_b32 s60, s60, 0x1ffff
  s_add_u32 s60, s60, s64
  s_add_u32 s60, s60, s0
  buffer_load_dwordx4 v6, s[20:23], s60 offen offset:0 nt lds
  buffer_load_dwordx4 v6, s[20:23], s60 offen offset:1024 nt lds
  buffer_load_dwordx4 v6, s[20:23], s60 offen offset:2048 nt lds
  buffer_load_dwordx4 v6, s[20:23], s60 offen offset:3072 nt lds
  s_add_u32 m0, s68, 139264
  s_add_u32 s61, s13, 8
  s_sub_u32 s62, s61, 9
  s_cmp_ge_u32 s61, 9
  s_cselect_b32 s61, s62, s61
  s_lshl_b32 s61, s61, 7
  s_add_u32 s60, s61, s66
  buffer_load_dwordx4 v11, s[24:27], s60 offen offset:0 lds
  buffer_load_dwordx4 v12, s[24:27], s60 offen offset:1024 lds
  buffer_load_dwordx4 v13, s[24:27], s60 offen offset:2048 lds
  buffer_load_dwordx4 v14, s[24:27], s60 offen offset:3072 lds
  s_add_u32 m0, s68, 143360
  s_nop 0
  buffer_load_dwordx4 v15, s[24:27], s60 offen offset:0 lds
  buffer_load_dwordx4 v16, s[24:27], s60 offen offset:1024 lds
  s_add_u32 m0, s67, 98304
  s_add_u32 s61, s13, 8
  s_sub_u32 s62, s61, 9
  s_cmp_ge_u32 s61, 9
  s_cselect_b32 s61, s62, s61
  s_lshl_b32 s61, s61, 19
  s_add_u32 s61, s61, s65
  s_add_u32 s60, s61, 0
  s_sub_u32 s60, s60, s1
  s_add_u32 s60, s60, 256
  buffer_load_dwordx4 v7, s[28:31], s60 offen offset:0 lds
  buffer_load_dwordx4 v8, s[28:31], s60 offen offset:1024 lds
  buffer_load_dwordx4 v9, s[28:31], s60 offen offset:2048 lds
  buffer_load_dwordx4 v10, s[28:31], s60 offen offset:3072 lds
  s_waitcnt vmcnt(22)
  s_barrier
  s_cmp_lg_u32 s4, 11
  s_cbranch_scc1 L_hs1_31
  s_mov_b64 exec, 1
  global_store_byte v28, v29, s[46:47] sc1
  s_mov_b64 exec, -1
L_hs1_31:
  s_add_u32 m0, s67, 24576
  s_add_u32 s60, s74, 122880
  s_and_b32 s60, s60, 0x1ffff
  s_add_u32 s60, s60, s64
  s_add_u32 s60, s60, s0
  buffer_load_dwordx4 v2, s[16:19], s60 offen offset:0 nt lds
  buffer_load_dwordx4 v3, s[16:19], s60 offen offset:1024 nt lds
  buffer_load_dwordx4 v4, s[16:19], s60 offen offset:2048 nt lds
  buffer_load_dwordx4 v5, s[16:19], s60 offen offset:3072 nt lds
  s_add_u32 m0, s67, 40960
  s_add_u32 s60, s74, 106496
  s_and_b32 s60, s60, 0x1ffff
  s_add_u32 s60, s60, s64
  s_add_u32 s60, s60, s0
  buffer_load_dwordx4 v6, s[20:23], s60 offen offset:0 nt lds
  buffer_load_dwordx4 v6, s[20:23], s60 offen offset:1024 nt lds
  buffer_load_dwordx4 v6, s[20:23], s60 offen offset:2048 nt lds
  buffer_load_dwordx4 v6, s[20:23], s60 offen offset:3072 nt lds
  s_add_u32 m0, s67, 106496
  s_add_u32 s61, s13, 8
  s_sub_u32 s62, s61, 9
  s_cmp_ge_u32 s61, 9
  s_cselect_b32 s61, s62, s61
  s_lshl_b32 s61, s61, 19
  s_add_u32 s61, s61, s65
  s_add_u32 s60, s61, 262144
  s_sub_u32 s60, s60, s1
  s_add_u32 s60, s60, 256
  buffer_load_dwordx4 v7, s[28:31], s60 offen offset:0 lds
  buffer_load_dwordx4 v8, s[28:31], s60 offen offset:1024 lds
  buffer_load_dwordx4 v9, s[28:31], s60 offen offset:2048 lds
  buffer_load_dwordx4 v10, s[28:31], s60 offen offset:3072 lds
  s_waitcnt vmcnt(22)
  s_barrier
  s_cmp_lg_u32 s4, 12
  s_cbranch_scc1 L_hs1_32
  s_mov_b64 exec, 1
  global_store_byte v28, v29, s[46:47] sc1
  s_mov_b64 exec, -1
L_hs1_32:
  s_add_u32 m0, s67, 49152
  s_add_u32 s60, s74, 114688
  s_and_b32 s60, s60, 0x1ffff
  s_add_u32 s60, s60, s64
  s_add_u32 s60, s60, s0
  buffer_load_dwordx4 v6, s[20:23], s60 offen offset:0 nt lds
  buffer_load_dwordx4 v6, s[20:23], s60 offen offset:1024 nt lds
  buffer_load_dwordx4 v6, s[20:23], s60 offen offset:2048 nt lds
  buffer_load_dwordx4 v6, s[20:23], s60 offen offset:3072 nt lds
  s_add_u32 m0, s68, 114688
  s_add_u32 s61, s13, 0
  s_sub_u32 s62, s61, 9
  s_cmp_ge_u32 s61, 9
  s_cselect_b32 s61, s62, s61
  s_lshl_b32 s61, s61, 7
  s_add_u32 s60, s61, s66
  buffer_load_dwordx4 v11, s[24:27], s60 offen offset:0 lds
  buffer_load_dwordx4 v12, s[24:27], s60 offen offset:1024 lds
  buffer_load_dwordx4 v13, s[24:27], s60 offen offset:2048 lds
  buffer_load_dwordx4 v14, s[24:27], s60 offen offset:3072 lds
  s_add_u32 m0, s68, 118784
  s_nop 0
  buffer_load_dwordx4 v15, s[24:27], s60 offen offset:0 lds
  buffer_load_dwordx4 v16, s[24:27], s60 offen offset:1024 lds
  s_add_u32 m0, s67, 65536
  s_add_u32 s61, s13, 0
  s_sub_u32 s62, s61, 9
  s_cmp_ge_u32 s61, 9
  s_cselect_b32 s61, s62, s61
  s_lshl_b32 s61, s61, 19
  s_add_u32 s61, s61, s65
  s_add_u32 s60, s61, 0
  s_add_u32 s60, s60, s10
  s_add_u32 s60, s60, s1
  buffer_load_dwordx4 v7, s[28:31], s60 offen offset:0 lds
  buffer_load_dwordx4 v8, s[28:31], s60 offen offset:1024 lds
  buffer_load_dwordx4 v9, s[28:31], s60 offen offset:2048 lds
  buffer_load_dwordx4 v10, s[28:31], s60 offen offset:3072 lds
  s_waitcnt vmcnt(18)
  s_barrier
  s_cmp_lg_u32 s4, 13
  s_cbranch_scc1 L_hs1_33
  s_mov_b64 exec, 1
  global_store_byte v28, v29, s[46:47] sc1
  s_mov_b64 exec, -1
L_hs1_33:
  s_add_u32 m0, s67, 57344
  s_add_u32 s60, s74, 122880
  s_and_b32 s60, s60, 0x1ffff
  s_add_u32 s60, s60, s64
  s_add_u32 s60, s60, s0
  buffer_load_dwordx4 v6, s[20:23], s60 offen offset:0 nt lds
  buffer_load_dwordx4 v6, s[20:23], s60 offen offset:1024 nt lds
  buffer_load_dwordx4 v6, s[20:23], s60 offen offset:2048 nt lds
  buffer_load_dwordx4 v6, s[20:23], s60 offen offset:3072 nt lds
  s_add_u32 m0, s67, 73728
  s_add_u32 s61, s13, 0
  s_sub_u32 s62, s61, 9
  s_cmp_ge_u32 s61, 9
  s_cselect_b32 s61, s62, s61
  s_lshl_b32 s61, s61, 19
  s_add_u32 s61, s61, s65
  s_add_u32 s60, s61, 262144
  s_add_u32 s60, s60, s10
  s_add_u32 s60, s60, s1
  buffer_load_dwordx4 v7, s[28:31], s60 offen offset:0 lds
  buffer_load_dwordx4 v8, s[28:31], s60 offen offset:1024 lds
  buffer_load_dwordx4 v9, s[28:31], s60 offen offset:2048 lds
  buffer_load_dwordx4 v10, s[28:31], s60 offen offset:3072 lds
  s_waitcnt vmcnt(18)
  s_barrier
  s_cmp_lg_u32 s4, 14
  s_cbranch_scc1 L_hs1_34
  s_mov_b64 exec, 1
  global_store_byte v28, v29, s[46:47] sc1
  s_mov_b64 exec, -1
L_hs1_34:
  s_add_u32 m0, s67, 0
  s_add_u32 s60, s74, 0
  s_and_b32 s60, s60, 0x1ffff
  s_add_u32 s60, s60, s64
  s_sub_u32 s60, s60, s0
  s_add_u32 s60, s60, 131072
  buffer_load_dwordx4 v2, s[16:19], s60 offen offset:0 nt lds
  buffer_load_dwordx4 v3, s[16:19], s60 offen offset:1024 nt lds
  buffer_load_dwordx4 v4, s[16:19], s60 offen offset:2048 nt lds
  buffer_load_dwordx4 v5, s[16:19], s60 offen offset:3072 nt lds
  s_add_u32 m0, s68, 126976
  s_add_u32 s61, s13, 1
  s_sub_u32 s62, s61, 9
  s_cmp_ge_u32 s61, 9
  s_cselect_b32 s61, s62, s61
  s_lshl_b32 s61, s61, 7
  s_add_u32 s60, s61, s66
  buffer_load_dwordx4 v11, s[24:27], s60 offen offset:0 lds
  buffer_load_dwordx4 v12, s[24:27], s60 offen offset:1024 lds
  buffer_load_dwordx4 v13, s[24:27], s60 offen offset:2048 lds
  buffer_load_dwordx4 v14, s[24:27], s60 offen offset:3072 lds
  s_add_u32 m0, s68, 131072
  s_nop 0
  buffer_load_dwordx4 v15, s[24:27], s60 offen offset:0 lds
  buffer_load_dwordx4 v16, s[24:27], s60 offen offset:1024 lds
  s_add_u32 m0, s67, 81920
  s_add_u32 s61, s13, 1
  s_sub_u32 s62, s61, 9
  s_cmp_ge_u32 s61, 9
  s_cselect_b32 s61, s62, s61
  s_lshl_b32 s61, s61, 19
  s_add_u32 s61, s61, s65
  s_add_u32 s60, s61, 0
  s_add_u32 s60, s60, s10
  s_add_u32 s60, s60, s1
  buffer_load_dwordx4 v7, s[28:31], s60 offen offset:0 lds
  buffer_load_dwordx4 v8, s[28:31], s60 offen offset:1024 lds
  buffer_load_dwordx4 v9, s[28:31], s60 offen offset:2048 lds
  buffer_load_dwordx4 v10, s[28:31], s60 offen offset:3072 lds
  s_waitcnt vmcnt(18)
  s_barrier
  s_cmp_lg_u32 s4, 15
  s_cbranch_scc1 L_hs1_35
  s_mov_b64 exec, 1
  global_store_byte v28, v29, s[46:47] sc1
  s_mov_b64 exec, -1
L_hs1_35:
  s_add_u32 m0, s67, 8192
  s_add_u32 s60, s74, 8192
  s_and_b32 s60, s60, 0x1ffff
  s_add_u32 s60, s60, s64
  s_sub_u32 s60, s60, s0
  s_add_u32 s60, s60, 131072
  buffer_load_dwordx4 v2, s[16:19], s60 offen offset:0 nt lds
  buffer_load_dwordx4 v3, s[16:19], s60 offen offset:1024 nt lds
  buffer_load_dwordx4 v4, s[16:19], s60 offen offset:2048 nt lds
  buffer_load_dwordx4 v5, s[16:19], s60 offen offset:3072 nt lds
  s_add_u32 m0, s67, 90112
  s_add_u32 s61, s13, 1
  s_sub_u32 s62, s61, 9
  s_cmp_ge_u32 s61, 9
  s_cselect_b32 s61, s62, s61
  s_lshl_b32 s61, s61, 19
  s_add_u32 s61, s61, s65
  s_add_u32 s60, s61, 262144
  s_add_u32 s60, s60, s10
  s_add_u32 s60, s60, s1
  buffer_load_dwordx4 v7, s[28:31], s60 offen offset:0 lds
  buffer_load_dwordx4 v8, s[28:31], s60 offen offset:1024 lds
  buffer_load_dwordx4 v9, s[28:31], s60 offen offset:2048 lds
  buffer_load_dwordx4 v10, s[28:31], s60 offen offset:3072 lds
  s_waitcnt vmcnt(18)
  s_barrier
  s_cmp_lg_u32 s4, 16
  s_cbranch_scc1 L_hs1_36
  s_mov_b64 exec, 1
  global_store_byte v28, v29, s[46:47] sc1
  s_mov_b64 exec, -1
L_hs1_36:
  s_add_u32 m0, s67, 16384
  s_add_u32 s60, s74, 16384
  s_and_b32 s60, s60, 0x1ffff
  s_add_u32 s60, s60, s64
  s_sub_u32 s60, s60, s0
  s_add_u32 s60, s60, 131072
  buffer_load_dwordx4 v2, s[16:19], s60 offen offset:0 nt lds
  buffer_load_dwordx4 v3, s[16:19], s60 offen offset:1024 nt lds
  buffer_load_dwordx4 v4, s[16:19], s60 offen offset:2048 nt lds
  buffer_load_dwordx4 v5, s[16:19], s60 offen offset:3072 nt lds
  s_add_u32 m0, s67, 32768
  s_add_u32 s60, s74, 0
  s_and_b32 s60, s60, 0x1ffff
  s_add_u32 s60, s60, s64
  s_sub_u32 s60, s60, s0
  s_add_u32 s60, s60, 131072
  buffer_load_dwordx4 v6, s[20:23], s60 offen offset:0 nt lds
  buffer_load_dwordx4 v6, s[20:23], s60 offen offset:1024 nt lds
  buffer_load_dwordx4 v6, s[20:23], s60 offen offset:2048 nt lds
  buffer_load_dwordx4 v6, s[20:23], s60 offen offset:3072 nt lds
  s_add_u32 m0, s68, 139264
  s_add_u32 s61, s13, 2
  s_sub_u32 s62, s61, 9
  s_cmp_ge_u32 s61, 9
  s_cselect_b32 s61, s62, s61
  s_lshl_b32 s61, s61, 7
  s_add_u32 s60, s61, s66
  buffer_load_dwordx4 v11, s[24:27], s60 offen offset:0 lds
  buffer_load_dwordx4 v12, s[24:27], s60 offen offset:1024 lds
  buffer_load_dwordx4 v13, s[24:27], s60 offen offset:2048 lds
  buffer_load_dwordx4 v14, s[24:27], s60 offen offset:3072 lds
  s_add_u32 m0, s68, 143360
  s_nop 0
  buffer_load_dwordx4 v15, s[24:27], s60 offen offset:0 lds
  buffer_load_dwordx4 v16, s[24:27], s60 offen offset:1024 lds
  s_add_u32 m0, s67, 98304
  s_add_u32 s61, s13, 2
  s_sub_u32 s62, s61, 9
  s_cmp_ge_u32 s61, 9
  s_cselect_b32 s61, s62, s61
  s_lshl_b32 s61, s61, 19
  s_add_u32 s61, s61, s65
  s_add_u32 s60, s61, 0
  s_add_u32 s60, s60, s10
  s_add_u32 s60, s60, s1
  buffer_load_dwordx4 v7, s[28:31], s60 offen offset:0 lds
  buffer_load_dwordx4 v8, s[28:31], s60 offen offset:1024 lds
  buffer_load_dwordx4 v9, s[28:31], s60 offen offset:2048 lds
  buffer_load_dwordx4 v10, s[28:31], s60 offen offset:3072 lds
  s_waitcnt vmcnt(22)
  s_barrier
  s_cmp_lg_u32 s4, 17
  s_cbranch_scc1 L_hs1_37
  s_mov_b64 exec, 1
  global_store_byte v28, v29, s[46:47] sc1
  s_mov_b64 exec, -1
L_hs1_37:
  s_add_u32 m0, s67, 24576
  s_add_u32 s60, s74, 24576
  s_and_b32 s60, s60, 0x1ffff
  s_add_u32 s60, s60, s64
  s_sub_u32 s60, s60, s0
  s_add_u32 s60, s60, 131072
  buffer_load_dwordx4 v2, s[16:19], s60 offen offset:0 nt lds
  buffer_load_dwordx4 v3, s[16:19], s60 offen offset:1024 nt lds
  buffer_load_dwordx4 v4, s[16:19], s60 offen offset:2048 nt lds
  buffer_load_dwordx4 v5, s[16:19], s60 offen offset:3072 nt lds
  s_add_u32 m0, s67, 40960
  s_add_u32 s60, s74, 8192
  s_and_b32 s60, s60, 0x1ffff
  s_add_u32 s60, s60, s64
  s_sub_u32 s60, s60, s0
  s_add_u32 s60, s60, 131072
  buffer_load_dwordx4 v6, s[20:23], s60 offen offset:0 nt lds
  buffer_load_dwordx4 v6, s[20:23], s60 offen offset:1024 nt lds
  buffer_load_dwordx4 v6, s[20:23], s60 offen offset:2048 nt lds
  buffer_load_dwordx4 v6, s[20:23], s60 offen offset:3072 nt lds
  s_add_u32 m0, s67, 106496
  s_add_u32 s61, s13, 2
  s_sub_u32 s62, s61, 9
  s_cmp_ge_u32 s61, 9
  s_cselect_b32 s61, s62, s61
  s_lshl_b32 s61, s61, 19
  s_add_u32 s61, s61, s65
  s_add_u32 s60, s61, 262144
  s_add_u32 s60, s60, s10
  s_add_u32 s60, s60, s1
  buffer_load_dwordx4 v7, s[28:31], s60 offen offset:0 lds
  buffer_load_dwordx4 v8, s[28:31], s60 offen offset:1024 lds
  buffer_load_dwordx4 v9, s[28:31], s60 offen offset:2048 lds
  buffer_load_dwordx4 v10, s[28:31], s60 offen offset:3072 lds
  s_waitcnt vmcnt(22)
  s_barrier
  s_cmp_lg_u32 s4, 18
  s_cbranch_scc1 L_hs1_38
  s_mov_b64 exec, 1
  global_store_byte v28, v29, s[46:47] sc1
  s_mov_b64 exec, -1
L_hs1_38:
  s_add_u32 m0, s67, 0
  s_add_u32 s60, s74, 32768
  s_and_b32 s60, s60, 0x1ffff
  s_add_u32 s60, s60, s64
  s_sub_u32 s60, s60, s0
  s_add_u32 s60, s60, 131072
  buffer_load_dwordx4 v2, s[16:19], s60 offen offset:0 nt lds
  buffer_load_dwordx4 v3, s[16:19], s60 offen offset:1024 nt lds
  buffer_load_dwordx4 v4, s[16:19], s60 offen offset:2048 nt lds
  buffer_load_dwordx4 v5, s[16:19], s60 offen offset:3072 nt lds
  s_add_u32 m0, s67, 49152
  s_add_u32 s60, s74, 16384
  s_and_b32 s60, s60, 0x1ffff
  s_add_u32 s60, s60, s64
  s_sub_u32 s60, s60, s0
  s_add_u32 s60, s60, 131072
  buffer_load_dwordx4 v6, s[20:23], s60 offen offset:0 nt lds
  buffer_load_dwordx4 v6, s[20:23], s60 offen offset:1024 nt lds
  buffer_load_dwordx4 v6, s[20:23], s60 offen offset:2048 nt lds
  buffer_load_dwordx4 v6, s[20:23], s60 offen offset:3072 nt lds
  s_add_u32 m0, s68, 114688
  s_add_u32 s61, s13, 3
  s_sub_u32 s62, s61, 9
  s_cmp_ge_u32 s61, 9
  s_cselect_b32 s61, s62, s61
  s_lshl_b32 s61, s61, 7
  s_add_u32 s60, s61, s66
  buffer_load_dwordx4 v11, s[24:27], s60 offen offset:0 lds
  buffer_load_dwordx4 v12, s[24:27], s60 offen offset:1024 lds
  buffer_load_dwordx4 v13, s[24:27], s60 offen offset:2048 lds
  buffer_load_dwordx4 v14, s[24:27], s60 offen offset:3072 lds
  s_add_u32 m0, s68, 118784
  s_nop 0
  buffer_load_dwordx4 v15, s[24:27], s60 offen offset:0 lds
  buffer_load_dwordx4 v16, s[24:27], s60 offen offset:1024 lds
  s_add_u32 m0, s67, 65536
  s_add_u32 s61, s13, 3
  s_sub_u32 s62, s61, 9
  s_cmp_ge_u32 s61, 9
  s_cselect_b32 s61, s62, s61
  s_lshl_b32 s61, s61, 19
  s_add_u32 s61, s61, s65
  s_add_u32 s60, s61, 0
  s_add_u32 s60, s60, s10
  s_add_u32 s60, s60, s1
  buffer_load_dwordx4 v7, s[28:31], s60 offen offset:0 lds
  buffer_load_dwordx4 v8, s[28:31], s60 offen offset:1024 lds
  buffer_load_dwordx4 v9, s[28:31], s60 offen offset:2048 lds
  buffer_load_dwordx4 v10, s[28:31], s60 offen offset:3072 lds
  s_waitcnt vmcnt(22)
  s_barrier
  s_cmp_lg_u32 s4, 19
  s_cbranch_scc1 L_hs1_39
  s_mov_b64 exec, 1
  global_store_byte v28, v29, s[46:47] sc1
  s_mov_b64 exec, -1
L_hs1_39:
  s_add_u32 m0, s67, 8192
  s_add_u32 s60, s74, 40960
  s_and_b32 s60, s60, 0x1ffff
  s_add_u32 s60, s60, s64
  s_sub_u32 s60, s60, s0
  s_add_u32 s60, s60, 131072
  buffer_load_dwordx4 v2, s[16:19], s60 offen offset:0 nt lds
  buffer_load_dwordx4 v3, s[16:19], s60 offen offset:1024 nt lds
  buffer_load_dwordx4 v4, s[16:19], s60 offen offset:2048 nt lds
  buffer_load_dwordx4 v5, s[16:19], s60 offen offset:3072 nt lds
  s_add_u32 m0, s67, 57344
  s_add_u32 s60, s74, 24576
  s_and_b32 s60, s60, 0x1ffff
  s_add_u32 s60, s60, s64
  s_sub_u32 s60, s60, s0
  s_add_u32 s60, s60, 131072
  buffer_load_dwordx4 v6, s[20:23], s60 offen offset:0 nt lds
  buffer_load_dwordx4 v6, s[20:23], s60 offen offset:1024 nt lds
  buffer_load_dwordx4 v6, s[20:23], s60 offen offset:2048 nt lds
  buffer_load_dwordx4 v6, s[20:23], s60 offen offset:3072 nt lds
  s_add_u32 m0, s67, 73728
  s_add_u32 s61, s13, 3
  s_sub_u32 s62, s61, 9
  s_cmp_ge_u32 s61, 9
  s_cselect_b32 s61, s62, s61
  s_lshl_b32 s61, s61, 19
  s_add_u32 s61, s61, s65
  s_add_u32 s60, s61, 262144
  s_add_u32 s60, s60, s10
  s_add_u32 s60, s60, s1
  buffer_load_dwordx4 v7, s[28:31], s60 offen offset:0 lds
  buffer_load_dwordx4 v8, s[28:31], s60 offen offset:1024 lds
  buffer_load_dwordx4 v9, s[28:31], s60 offen offset:2048 lds
  buffer_load_dwordx4 v10, s[28:31], s60 offen offset:3072 lds
  s_waitcnt vmcnt(22)
  s_barrier
  s_cmp_lg_u32 s4, 20
  s_cbranch_scc1 L_hs1_40
  s_mov_b64 exec, 1
  global_store_byte v28, v29, s[46:47] sc1
  s_mov_b64 exec, -1
L_hs1_40:
  s_add_u32 m0, s67, 16384
  s_add_u32 s60, s74, 49152
  s_and_b32 s60, s60, 0x1ffff
  s_add_u32 s60, s60, s64
  s_sub_u32 s60, s60, s0
  s_add_u32 s60, s60, 131072
  buffer_load_dwordx4 v2, s[16:19], s60 offen offset:0 nt lds
  buffer_load_dwordx4 v3, s[16:19], s60 offen offset:1024 nt lds
  buffer_load_dwordx4 v4, s[16:19], s60 offen offset:2048 nt lds
  buffer_load_dwordx4 v5, s[16:19], s60 offen offset:3072 nt lds
  s_add_u32 m0, s67, 32768
  s_add_u32 s60, s74, 32768
  s_and_b32 s60, s60, 0x1ffff
  s_add_u32 s60, s60, s64
  s_sub_u32 s60, s60, s0
  s_add_u32 s60, s60, 131072
  buffer_load_dwordx4 v6, s[20:23], s60 offen offset:0 nt lds
  buffer_load_dwordx4 v6, s[20:23], s60 offen offset:1024 nt lds
  buffer_load_dwordx4 v6, s[20:23], s60 offen offset:2048 nt lds
  buffer_load_dwordx4 v6, s[20:23], s60 offen offset:3072 nt lds
  s_add_u32 m0, s68, 126976
  s_add_u32 s61, s13, 4
  s_sub_u32 s62, s61, 9
  s_cmp_ge_u32 s61, 9
  s_cselect_b32 s61, s62, s61
  s_lshl_b32 s61, s61, 7
  s_add_u32 s60, s61, s66
  buffer_load_dwordx4 v11, s[24:27], s60 offen offset:0 lds
  buffer_load_dwordx4 v12, s[24:27], s60 offen offset:1024 lds
  buffer_load_dwordx4 v13, s[24:27], s60 offen offset:2048 lds
  buffer_load_dwordx4 v14, s[24:27], s60 offen offset:3072 lds
  s_add_u32 m0, s68, 131072
  s_nop 0
  buffer_load_dwordx4 v15, s[24:27], s60 offen offset:0 lds
  buffer_load_dwordx4 v16, s[24:27], s60 offen offset:1024 lds
  s_add_u32 m0, s67, 81920
  s_add_u32 s61, s13, 4
  s_sub_u32 s62, s61, 9
  s_cmp_ge_u32 s61, 9
  s_cselect_b32 s61, s62, s61
  s_lshl_b32 s61, s61, 19
  s_add_u32 s61, s61, s65
  s_add_u32 s60, s61, 0
  s_add_u32 s60, s60, s10
  s_add_u32 s60, s60, s1
  buffer_load_dwordx4 v7, s[28:31], s60 offen offset:0 lds
  buffer_load_dwordx4 v8, s[28:31], s60 offen offset:1024 lds
  buffer_load_dwordx4 v9, s[28:31], s60 offen offset:2048 lds
  buffer_load_dwordx4 v10, s[28:31], s60 offen offset:3072 lds
  s_waitcnt vmcnt(22)
  s_barrier
  s_cmp_lg_u32 s4, 21
  s_cbranch_scc1 L_hs1_41
  s_mov_b64 exec, 1
  global_store_byte v28, v29, s[46:47] sc1
  s_mov_b64 exec, -1
L_hs1_41:
  s_add_u32 m0, s67, 24576
  s_add_u32 s60, s74, 57344
  s_and_b32 s60, s60, 0x1ffff
  s_add_u32 s60, s60, s64
  s_sub_u32 s60, s60, s0
  s_add_u32 s60, s60, 131072
  buffer_load_dwordx4 v2, s[16:19], s60 offen offset:0 nt lds
  buffer_load_dwordx4 v3, s[16:19], s60 offen offset:1024 nt lds
  buffer_load_dwordx4 v4, s[16:19], s60 offen offset:2048 nt lds
  buffer_load_dwordx4 v5, s[16:19], s60 offen offset:3072 nt lds
  s_add_u32 m0, s67, 40960
  s_add_u32 s60, s74, 40960
  s_and_b32 s60, s60, 0x1ffff
  s_add_u32 s60, s60, s64
  s_sub_u32 s60, s60, s0
  s_add_u32 s60, s60, 131072
  buffer_load_dwordx4 v6, s[20:23], s60 offen offset:0 nt lds
  buffer_load_dwordx4 v6, s[20:23], s60 offen offset:1024 nt lds
  buffer_load_dwordx4 v6, s[20:23], s60 offen offset:2048 nt lds
  buffer_load_dwordx4 v6, s[20:23], s60 offen offset:3072 nt lds
  s_add_u32 m0, s67, 90112
  s_add_u32 s61, s13, 4
  s_sub_u32 s62, s61, 9
  s_cmp_ge_u32 s61, 9
  s_cselect_b32 s61, s62, s61
  s_lshl_b32 s61, s61, 19
  s_add_u32 s61, s61, s65
  s_add_u32 s60, s61, 262144
  s_add_u32 s60, s60, s10
  s_add_u32 s60, s60, s1
  buffer_load_dwordx4 v7, s[28:31], s60 offen offset:0 lds
  buffer_load_dwordx4 v8, s[28:31], s60 offen offset:1024 lds
  buffer_load_dwordx4 v9, s[28:31], s60 offen offset:2048 lds
  buffer_load_dwordx4 v10, s[28:31], s60 offen offset:3072 lds
  s_waitcnt vmcnt(22)
  s_barrier
  s_cmp_lg_u32 s4, 22
  s_cbranch_scc1 L_hs1_42
  s_mov_b64 exec, 1
  global_store_byte v28, v29, s[46:47] sc1
  s_mov_b64 exec, -1
L_hs1_42:
  s_add_u32 m0, s67, 0
  s_add_u32 s60, s74, 65536
  s_and_b32 s60, s60, 0x1ffff
  s_add_u32 s60, s60, s64
  s_sub_u32 s60, s60, s0
  s_add_u32 s60, s60, 131072
  buffer_load_dwordx4 v2, s[16:19], s60 offen offset:0 nt lds
  buffer_load_dwordx4 v3, s[16:19], s60 offen offset:1024 nt lds
  buffer_load_dwordx4 v4, s[16:19], s60 offen offset:2048 nt lds
  buffer_load_dwordx4 v5, s[16:19], s60 offen offset:3072 nt lds
  s_add_u32 m0, s67, 49152
  s_add_u32 s60, s74, 49152
  s_and_b32 s60, s60, 0x1ffff
  s_add_u32 s60, s60, s64
  s_sub_u32 s60, s60, s0
  s_add_u32 s60, s60, 131072
  buffer_load_dwordx4 v6, s[20:23], s60 offen offset:0 nt lds
  buffer_load_dwordx4 v6, s[20:23], s60 offen offset:1024 nt lds
  buffer_load_dwordx4 v6, s[20:23], s60 offen offset:2048 nt lds
  buffer_load_dwordx4 v6, s[20:23], s60 offen offset:3072 nt lds
  s_add_u32 m0, s68, 139264
  s_add_u32 s61, s13, 5
  s_sub_u32 s62, s61, 9
  s_cmp_ge_u32 s61, 9
  s_cselect_b32 s61, s62, s61
  s_lshl_b32 s61, s61, 7
  s_add_u32 s60, s61, s66
  buffer_load_dwordx4 v11, s[24:27], s60 offen offset:0 lds
  buffer_load_dwordx4 v12, s[24:27], s60 offen offset:1024 lds
  buffer_load_dwordx4 v13, s[24:27], s60 offen offset:2048 lds
  buffer_load_dwordx4 v14, s[24:27], s60 offen offset:3072 lds
  s_add_u32 m0, s68, 143360
  s_nop 0
  buffer_load_dwordx4 v15, s[24:27], s60 offen offset:0 lds
  buffer_load_dwordx4 v16, s[24:27], s60 offen offset:1024 lds
  s_add_u32 m0, s67, 98304
  s_add_u32 s61, s13, 5
  s_sub_u32 s62, s61, 9
  s_cmp_ge_u32 s61, 9
  s_cselect_b32 s61, s62, s61
  s_lshl_b32 s61, s61, 19
  s_add_u32 s61, s61, s65
  s_add_u32 s60, s61, 0
  s_add_u32 s60, s60, s10
  s_add_u32 s60, s60, s1
  buffer_load_dwordx4 v7, s[28:31], s60 offen offset:0 lds
  buffer_load_dwordx4 v8, s[28:31], s60 offen offset:1024 lds
  buffer_load_dwordx4 v9, s[28:31], s60 offen offset:2048 lds
  buffer_load_dwordx4 v10, s[28:31], s60 offen offset:3072 lds
  s_waitcnt vmcnt(22)
  s_barrier
  s_cmp_lg_u32 s4, 23
  s_cbranch_scc1 L_hs1_43
  s_mov_b64 exec, 1
  global_store_byte v28, v29, s[46:47] sc1
  s_mov_b64 exec, -1
L_hs1_43:
  s_add_u32 m0, s67, 8192
  s_add_u32 s60, s74, 73728
  s_and_b32 s60, s60, 0x1ffff
  s_add_u32 s60, s60, s64
  s_sub_u32 s60, s60, s0
  s_add_u32 s60, s60, 131072
  buffer_load_dwordx4 v2, s[16:19], s60 offen offset:0 nt lds
  buffer_load_dwordx4 v3, s[16:19], s60 offen offset:1024 nt lds
  buffer_load_dwordx4 v4, s[16:19], s60 offen offset:2048 nt lds
  buffer_load_dwordx4 v5, s[16:19], s60 offen offset:3072 nt lds
  s_add_u32 m0, s67, 57344
  s_add_u32 s60, s74, 57344
  s_and_b32 s60, s60, 0x1ffff
  s_add_u32 s60, s60, s64
  s_sub_u32 s60, s60, s0
  s_add_u32 s60, s60, 131072
  buffer_load_dwordx4 v6, s[20:23], s60 offen offset:0 nt lds
  buffer_load_dwordx4 v6, s[20:23], s60 offen offset:1024 nt lds
  buffer_load_dwordx4 v6, s[20:23], s60 offen offset:2048 nt lds
  buffer_load_dwordx4 v6, s[20:23], s60 offen offset:3072 nt lds
  s_add_u32 m0, s67, 106496
  s_add_u32 s61, s13, 5
  s_sub_u32 s62, s61, 9
  s_cmp_ge_u32 s61, 9
  s_cselect_b32 s61, s62, s61
  s_lshl_b32 s61, s61, 19
  s_add_u32 s61, s61, s65
  s_add_u32 s60, s61, 262144
  s_add_u32 s60, s60, s10
  s_add_u32 s60, s60, s1
  buffer_load_dwordx4 v7, s[28:31], s60 offen offset:0 lds
  buffer_load_dwordx4 v8, s[28:31], s60 offen offset:1024 lds
  buffer_load_dwordx4 v9, s[28:31], s60 offen offset:2048 lds
  buffer_load_dwordx4 v10, s[28:31], s60 offen offset:3072 lds
  s_waitcnt vmcnt(22)
  s_barrier
  s_cmp_lg_u32 s4, 24
  s_cbranch_scc1 L_hs1_44
  s_mov_b64 exec, 1
  global_store_byte v28, v29, s[46:47] sc1
  s_mov_b64 exec, -1
L_hs1_44:
  s_add_u32 m0, s67, 16384
  s_add_u32 s60, s74, 81920
  s_and_b32 s60, s60, 0x1ffff
  s_add_u32 s60, s60, s64
  s_sub_u32 s60, s60, s0
  s_add_u32 s60, s60, 131072
  buffer_load_dwordx4 v2, s[16:19], s60 offen offset:0 nt lds
  buffer_load_dwordx4 v3, s[16:19], s60 offen offset:1024 nt lds
  buffer_load_dwordx4 v4, s[16:19], s60 offen offset:2048 nt lds
  buffer_load_dwordx4 v5, s[16:19], s60 offen offset:3072 nt lds
  s_add_u32 m0, s67, 32768
  s_add_u32 s60, s74, 65536
  s_and_b32 s60, s60, 0x1ffff
  s_add_u32 s60, s60, s64
  s_sub_u32 s60, s60, s0
  s_add_u32 s60, s60, 131072
  buffer_load_dwordx4 v6, s[20:23], s60 offen offset:0 nt lds
  buffer_load_dwordx4 v6, s[20:23], s60 offen offset:1024 nt lds
  buffer_load_dwordx4 v6, s[20:23], s60 offen offset:2048 nt lds
  buffer_load_dwordx4 v6, s[20:23], s60 offen offset:3072 nt lds
  s_add_u32 m0, s68, 114688
  s_add_u32 s61, s13, 6
  s_sub_u32 s62, s61, 9
  s_cmp_ge_u32 s61, 9
  s_cselect_b32 s61, s62, s61
  s_lshl_b32 s61, s61, 7
  s_add_u32 s60, s61, s66
  buffer_load_dwordx4 v11, s[24:27], s60 offen offset:0 lds
  buffer_load_dwordx4 v12, s[24:27], s60 offen offset:1024 lds
  buffer_load_dwordx4 v13, s[24:27], s60 offen offset:2048 lds
  buffer_load_dwordx4 v14, s[24:27], s60 offen offset:3072 lds
  s_add_u32 m0, s68, 118784
  s_nop 0
  buffer_load_dwordx4 v15, s[24:27], s60 offen offset:0 lds
  buffer_load_dwordx4 v16, s[24:27], s60 offen offset:1024 lds
  s_add_u32 m0, s67, 65536
  s_add_u32 s61, s13, 6
  s_sub_u32 s62, s61, 9
  s_cmp_ge_u32 s61, 9
  s_cselect_b32 s61, s62, s61
  s_lshl_b32 s61, s61, 19
  s_add_u32 s61, s61, s65
  s_add_u32 s60, s61, 0
  s_add_u32 s60, s60, s10
  s_add_u32 s60, s60, s1
  buffer_load_dwordx4 v7, s[28:31], s60 offen offset:0 lds
  buffer_load_dwordx4 v8, s[28:31], s60 offen offset:1024 lds
  buffer_load_dwordx4 v9, s[28:31], s60 offen offset:2048 lds
  buffer_load_dwordx4 v10, s[28:31], s60 offen offset:3072 lds
  s_waitcnt vmcnt(22)
  s_barrier
  s_cmp_lg_u32 s4, 25
  s_cbranch_scc1 L_hs1_45
  s_mov_b64 exec, 1
  global_store_byte v28, v29, s[46:47] sc1
  s_mov_b64 exec, -1
L_hs1_45:
  s_add_u32 m0, s67, 24576
  s_add_u32 s60, s74, 90112
  s_and_b32 s60, s60, 0x1ffff
  s_add_u32 s60, s60, s64
  s_sub_u32 s60, s60, s0
  s_add_u32 s60, s60, 131072
  buffer_load_dwordx4 v2, s[16:19], s60 offen offset:0 nt lds
  buffer_load_dwordx4 v3, s[16:19], s60 offen offset:1024 nt lds
  buffer_load_dwordx4 v4, s[16:19], s60 offen offset:2048 nt lds
  buffer_load_dwordx4 v5, s[16:19], s60 offen offset:3072 nt lds
  s_add_u32 m0, s67, 40960
  s_add_u32 s60, s74, 73728
  s_and_b32 s60, s60, 0x1ffff
  s_add_u32 s60, s60, s64
  s_sub_u32 s60, s60, s0
  s_add_u32 s60, s60, 131072
  buffer_load_dwordx4 v6, s[20:23], s60 offen offset:0 nt lds
  buffer_load_dwordx4 v6, s[20:23], s60 offen offset:1024 nt lds
  buffer_load_dwordx4 v6, s[20:23], s60 offen offset:2048 nt lds
  buffer_load_dwordx4 v6, s[20:23], s60 offen offset:3072 nt lds
  s_add_u32 m0, s67, 73728
  s_add_u32 s61, s13, 6
  s_sub_u32 s62, s61, 9
  s_cmp_ge_u32 s61, 9
  s_cselect_b32 s61, s62, s61
  s_lshl_b32 s61, s61, 19
  s_add_u32 s61, s61, s65
  s_add_u32 s60, s61, 262144
  s_add_u32 s60, s60, s10
  s_add_u32 s60, s60, s1
  buffer_load_dwordx4 v7, s[28:31], s60 offen offset:0 lds
  buffer_load_dwordx4 v8, s[28:31], s60 offen offset:1024 lds
  buffer_load_dwordx4 v9, s[28:31], s60 offen offset:2048 lds
  buffer_load_dwordx4 v10, s[28:31], s60 offen offset:3072 lds
  s_waitcnt vmcnt(22)
  s_barrier
  s_cmp_lg_u32 s4, 26
  s_cbranch_scc1 L_hs1_46
  s_mov_b64 exec, 1
  global_store_byte v28, v29, s[46:47] sc1
  s_mov_b64 exec, -1
L_hs1_46:
  s_add_u32 m0, s67, 0
  s_add_u32 s60, s74, 98304
  s_and_b32 s60, s60, 0x1ffff
  s_add_u32 s60, s60, s64
  s_sub_u32 s60, s60, s0
  s_add_u32 s60, s60, 131072
  buffer_load_dwordx4 v2, s[16:19], s60 offen offset:0 nt lds
  buffer_load_dwordx4 v3, s[16:19], s60 offen offset:1024 nt lds
  buffer_load_dwordx4 v4, s[16:19], s60 offen offset:2048 nt lds
  buffer_load_dwordx4 v5, s[16:19], s60 offen offset:3072 nt lds
  s_add_u32 m0, s67, 49152
  s_add_u32 s60, s74, 81920
  s_and_b32 s60, s60, 0x1ffff
  s_add_u32 s60, s60, s64
  s_sub_u32 s60, s60, s0
  s_add_u32 s60, s60, 131072
  buffer_load_dwordx4 v6, s[20:23], s60 offen offset:0 nt lds
  buffer_load_dwordx4 v6, s[20:23], s60 offen offset:1024 nt lds
  buffer_load_dwordx4 v6, s[20:23], s60 offen offset:2048 nt lds
  buffer_load_dwordx4 v6, s[20:23], s60 offen offset:3072 nt lds
  s_add_u32 m0, s68, 126976
  s_add_u32 s61, s13, 7
  s_sub_u32 s62, s61, 9
  s_cmp_ge_u32 s61, 9
  s_cselect_b32 s61, s62, s61
  s_lshl_b32 s61, s61, 7
  s_add_u32 s60, s61, s66
  buffer_load_dwordx4 v11, s[24:27], s60 offen offset:0 lds
  buffer_load_dwordx4 v12, s[24:27], s60 offen offset:1024 lds
  buffer_load_dwordx4 v13, s[24:27], s60 offen offset:2048 lds
  buffer_load_dwordx4 v14, s[24:27], s60 offen offset:3072 lds
  s_add_u32 m0, s68, 131072
  s_nop 0
  buffer_load_dwordx4 v15, s[24:27], s60 offen offset:0 lds
  buffer_load_dwordx4 v16, s[24:27], s60 offen offset:1024 lds
  s_add_u32 m0, s67, 81920
  s_add_u32 s61, s13, 7
  s_sub_u32 s62, s61, 9
  s_cmp_ge_u32 s61, 9
  s_cselect_b32 s61, s62, s61
  s_lshl_b32 s61, s61, 19
  s_add_u32 s61, s61, s65
  s_add_u32 s60, s61, 0
  s_add_u32 s60, s60, s10
  s_add_u32 s60, s60, s1
  buffer_load_dwordx4 v7, s[28:31], s60 offen offset:0 lds
  buffer_load_dwordx4 v8, s[28:31], s60 offen offset:1024 lds
  buffer_load_dwordx4 v9, s[28:31], s60 offen offset:2048 lds
  buffer_load_dwordx4 v10, s[28:31], s60 offen offset:3072 lds
  s_waitcnt vmcnt(22)
  s_barrier
  s_cmp_lg_u32 s4, 27
  s_cbranch_scc1 L_hs1_47
  s_mov_b64 exec, 1
  global_store_byte v28, v29, s[46:47] sc1
  s_mov_b64 exec, -1
L_hs1_47:
  s_add_u32 m0, s67, 8192
  s_add_u32 s60, s74, 106496
  s_and_b32 s60, s60, 0x1ffff
  s_add_u32 s60, s60, s64
  s_sub_u32 s60, s60, s0
  s_add_u32 s60, s60, 131072
  buffer_load_dwordx4 v2, s[16:19], s60 offen offset:0 nt lds
  buffer_load_dwordx4 v3, s[16:19], s60 offen offset:1024 nt lds
  buffer_load_dwordx4 v4, s[16:19], s60 offen offset:2048 nt lds
  buffer_load_dwordx4 v5, s[16:19], s60 offen offset:3072 nt lds
  s_add_u32 m0, s67, 57344
  s_add_u32 s60, s74, 90112
  s_and_b32 s60, s60, 0x1ffff
  s_add_u32 s60, s60, s64
  s_sub_u32 s60, s60, s0
  s_add_u32 s60, s60, 131072
  buffer_load_dwordx4 v6, s[20:23], s60 offen offset:0 nt lds
  buffer_load_dwordx4 v6, s[20:23], s60 offen offset:1024 nt lds
  buffer_load_dwordx4 v6, s[20:23], s60 offen offset:2048 nt lds
  buffer_load_dwordx4 v6, s[20:23], s60 offen offset:3072 nt lds
  s_add_u32 m0, s67, 90112
  s_add_u32 s61, s13, 7
  s_sub_u32 s62, s61, 9
  s_cmp_ge_u32 s61, 9
  s_cselect_b32 s61, s62, s61
  s_lshl_b32 s61, s61, 19
  s_add_u32 s61, s61, s65
  s_add_u32 s60, s61, 262144
  s_add_u32 s60, s60, s10
  s_add_u32 s60, s60, s1
  buffer_load_dwordx4 v7, s[28:31], s60 offen offset:0 lds
  buffer_load_dwordx4 v8, s[28:31], s60 offen offset:1024 lds
  buffer_load_dwordx4 v9, s[28:31], s60 offen offset:2048 lds
  buffer_load_dwordx4 v10, s[28:31], s60 offen offset:3072 lds
  s_waitcnt vmcnt(22)
  s_barrier
  s_cmp_lg_u32 s4, 28
  s_cbranch_scc1 L_hs1_48
  s_mov_b64 exec, 1
  global_store_byte v28, v29, s[46:47] sc1
  s_mov_b64 exec, -1
L_hs1_48:
  s_add_u32 m0, s67, 16384
  s_add_u32 s60, s74, 114688
  s_and_b32 s60, s60, 0x1ffff
  s_add_u32 s60, s60, s64
  s_sub_u32 s60, s60, s0
  s_add_u32 s60, s60, 131072
  buffer_load_dwordx4 v2, s[16:19], s60 offen offset:0 nt lds
  buffer_load_dwordx4 v3, s[16:19], s60 offen offset:1024 nt lds
  buffer_load_dwordx4 v4, s[16:19], s60 offen offset:2048 nt lds
  buffer_load_dwordx4 v5, s[16:19], s60 offen offset:3072 nt lds
  s_add_u32 m0, s67, 32768
  s_add_u32 s60, s74, 98304
  s_and_b32 s60, s60, 0x1ffff
  s_add_u32 s60, s60, s64
  s_sub_u32 s60, s60, s0
  s_add_u32 s60, s60, 131072
  buffer_load_dwordx4 v6, s[20:23], s60 offen offset:0 nt lds
  buffer_load_dwordx4 v6, s[20:23], s60 offen offset:1024 nt lds
  buffer_load_dwordx4 v6, s[20:23], s60 offen offset:2048 nt lds
  buffer_load_dwordx4 v6, s[20:23], s60 offen offset:3072 nt lds
  s_add_u32 m0, s68, 139264
  s_add_u32 s61, s13, 8
  s_sub_u32 s62, s61, 9
  s_cmp_ge_u32 s61, 9
  s_cselect_b32 s61, s62, s61
  s_lshl_b32 s61, s61, 7
  s_add_u32 s60, s61, s66
  buffer_load_dwordx4 v11, s[24:27], s60 offen offset:0 lds
  buffer_load_dwordx4 v12, s[24:27], s60 offen offset:1024 lds
  buffer_load_dwordx4 v13, s[24:27], s60 offen offset:2048 lds
  buffer_load_dwordx4 v14, s[24:27], s60 offen offset:3072 lds
  s_add_u32 m0, s68, 143360
  s_nop 0
  buffer_load_dwordx4 v15, s[24:27], s60 offen offset:0 lds
  buffer_load_dwordx4 v16, s[24:27], s60 offen offset:1024 lds
  s_add_u32 m0, s67, 98304
  s_add_u32 s61, s13, 8
  s_sub_u32 s62, s61, 9
  s_cmp_ge_u32 s61, 9
  s_cselect_b32 s61, s62, s61
  s_lshl_b32 s61, s61, 19
  s_add_u32 s61, s61, s65
  s_add_u32 s60, s61, 0
  s_add_u32 s60, s60, s10
  s_add_u32 s60, s60, s1
  buffer_load_dwordx4 v7, s[28:31], s60 offen offset:0 lds
  buffer_load_dwordx4 v8, s[28:31], s60 offen offset:1024 lds
  buffer_load_dwordx4 v9, s[28:31], s60 offen offset:2048 lds
  buffer_load_dwordx4 v10, s[28:31], s60 offen offset:3072 lds
  s_waitcnt vmcnt(22)
  s_barrier
  s_cmp_lg_u32 s4, 29
  s_cbranch_scc1 L_hs1_49
  s_mov_b64 exec, 1
  global_store_byte v28, v29, s[46:47] sc1
  s_mov_b64 exec, -1
L_hs1_49:
  s_add_u32 m0, s67, 24576
  s_add_u32 s60, s74, 122880
  s_and_b32 s60, s60, 0x1ffff
  s_add_u32 s60, s60, s64
  s_sub_u32 s60, s60, s0
  s_add_u32 s60, s60, 131072
  buffer_load_dwordx4 v2, s[16:19], s60 offen offset:0 nt lds
  buffer_load_dwordx4 v3, s[16:19], s60 offen offset:1024 nt lds
  buffer_load_dwordx4 v4, s[16:19], s60 offen offset:2048 nt lds
  buffer_load_dwordx4 v5, s[16:19], s60 offen offset:3072 nt lds
  s_add_u32 m0, s67, 40960
  s_add_u32 s60, s74, 106496
  s_and_b32 s60, s60, 0x1ffff
  s_add_u32 s60, s60, s64
  s_sub_u32 s60, s60, s0
  s_add_u32 s60, s60, 131072
  buffer_load_dwordx4 v6, s[20:23], s60 offen offset:0 nt lds
  buffer_load_dwordx4 v6, s[20:23], s60 offen offset:1024 nt lds
  buffer_load_dwordx4 v6, s[20:23], s60 offen offset:2048 nt lds
  buffer_load_dwordx4 v6, s[20:23], s60 offen offset:3072 nt lds
  s_add_u32 m0, s67, 106496
  s_add_u32 s61, s13, 8
  s_sub_u32 s62, s61, 9
  s_cmp_ge_u32 s61, 9
  s_cselect_b32 s61, s62, s61
  s_lshl_b32 s61, s61, 19
  s_add_u32 s61, s61, s65
  s_add_u32 s60, s61, 262144
  s_add_u32 s60, s60, s10
  s_add_u32 s60, s60, s1
  buffer_load_dwordx4 v7, s[28:31], s60 offen offset:0 lds
  buffer_load_dwordx4 v8, s[28:31], s60 offen offset:1024 lds
  buffer_load_dwordx4 v9, s[28:31], s60 offen offset:2048 lds
  buffer_load_dwordx4 v10, s[28:31], s60 offen offset:3072 lds
  s_waitcnt vmcnt(22)
  s_barrier
  s_cmp_lg_u32 s4, 30
  s_cbranch_scc1 L_hs1_50
  s_mov_b64 exec, 1
  global_store_byte v28, v29, s[46:47] sc1
  s_mov_b64 exec, -1
L_hs1_50:
  s_add_u32 m0, s67, 49152
  s_add_u32 s60, s74, 114688
  s_and_b32 s60, s60, 0x1ffff
  s_add_u32 s60, s60, s64
  s_sub_u32 s60, s60, s0
  s_add_u32 s60, s60, 131072
  buffer_load_dwordx4 v6, s[20:23], s60 offen offset:0 nt lds
  buffer_load_dwordx4 v6, s[20:23], s60 offen offset:1024 nt lds
  buffer_load_dwordx4 v6, s[20:23], s60 offen offset:2048 nt lds
  buffer_load_dwordx4 v6, s[20:23], s60 offen offset:3072 nt lds
  s_add_u32 m0, s68, 114688
  s_add_u32 s61, s13, 0
  s_sub_u32 s62, s61, 9
  s_cmp_ge_u32 s61, 9
  s_cselect_b32 s61, s62, s61
  s_lshl_b32 s61, s61, 7
  s_add_u32 s60, s61, s66
  buffer_load_dwordx4 v11, s[24:27], s60 offen offset:0 lds
  buffer_load_dwordx4 v12, s[24:27], s60 offen offset:1024 lds
  buffer_load_dwordx4 v13, s[24:27], s60 offen offset:2048 lds
  buffer_load_dwordx4 v14, s[24:27], s60 offen offset:3072 lds
  s_add_u32 m0, s68, 118784
  s_nop 0
  buffer_load_dwordx4 v15, s[24:27], s60 offen offset:0 lds
  buffer_load_dwordx4 v16, s[24:27], s60 offen offset:1024 lds
  s_add_u32 m0, s67, 65536
  s_add_u32 s61, s13, 0
  s_sub_u32 s62, s61, 9
  s_cmp_ge_u32 s61, 9
  s_cselect_b32 s61, s62, s61
  s_lshl_b32 s61, s61, 19
  s_add_u32 s61, s61, s65
  s_add_u32 s60, s61, 0
  s_add_u32 s60, s60, s10
  s_sub_u32 s60, s60, s1
  s_add_u32 s60, s60, 256
  buffer_load_dwordx4 v7, s[28:31], s60 offen offset:0 lds
  buffer_load_dwordx4 v8, s[28:31], s60 offen offset:1024 lds
  buffer_load_dwordx4 v9, s[28:31], s60 offen offset:2048 lds
  buffer_load_dwordx4 v10, s[28:31], s60 offen offset:3072 lds
  s_waitcnt vmcnt(18)
  s_barrier
  s_cmp_lg_u32 s4, 31
  s_cbranch_scc1 L_hs1_51
  s_mov_b64 exec, 1
  global_store_byte v28, v29, s[46:47] sc1
  s_mov_b64 exec, -1
L_hs1_51:
  s_add_u32 m0, s67, 57344
  s_add_u32 s60, s74, 122880
  s_and_b32 s60, s60, 0x1ffff
  s_add_u32 s60, s60, s64
  s_sub_u32 s60, s60, s0
  s_add_u32 s60, s60, 131072
  buffer_load_dwordx4 v6, s[20:23], s60 offen offset:0 nt lds
  buffer_load_dwordx4 v6, s[20:23], s60 offen offset:1024 nt lds
  buffer_load_dwordx4 v6, s[20:23], s60 offen offset:2048 nt lds
  buffer_load_dwordx4 v6, s[20:23], s60 offen offset:3072 nt lds
  s_add_u32 m0, s67, 73728
  s_add_u32 s61, s13, 0
  s_sub_u32 s62, s61, 9
  s_cmp_ge_u32 s61, 9
  s_cselect_b32 s61, s62, s61
  s_lshl_b32 s61, s61, 19
  s_add_u32 s61, s61, s65
  s_add_u32 s60, s61, 262144
  s_add_u32 s60, s60, s10
  s_sub_u32 s60, s60, s1
  s_add_u32 s60, s60, 256
  buffer_load_dwordx4 v7, s[28:31], s60 offen offset:0 lds
  buffer_load_dwordx4 v8, s[28:31], s60 offen offset:1024 lds
  buffer_load_dwordx4 v9, s[28:31], s60 offen offset:2048 lds
  buffer_load_dwordx4 v10, s[28:31], s60 offen offset:3072 lds
  s_waitcnt vmcnt(18)
  s_barrier
  s_add_u32 m0, s67, 0
  s_add_u32 s60, s74, 0
  s_and_b32 s60, s60, 0x1ffff
  s_add_u32 s60, s60, s64
  s_add_u32 s60, s60, s9
  s_add_u32 s60, s60, s0
  buffer_load_dwordx4 v2, s[16:19], s60 offen offset:0 nt lds
  buffer_load_dwordx4 v3, s[16:19], s60 offen offset:1024 nt lds
  buffer_load_dwordx4 v4, s[16:19], s60 offen offset:2048 nt lds
  buffer_load_dwordx4 v5, s[16:19], s60 offen offset:3072 nt lds
  s_add_u32 m0, s68, 126976
  s_add_u32 s61, s13, 1
  s_sub_u32 s62, s61, 9
  s_cmp_ge_u32 s61, 9
  s_cselect_b32 s61, s62, s61
  s_lshl_b32 s61, s61, 7
  s_add_u32 s60, s61, s66
  buffer_load_dwordx4 v11, s[24:27], s60 offen offset:0 lds
  buffer_load_dwordx4 v12, s[24:27], s60 offen offset:1024 lds
  buffer_load_dwordx4 v13, s[24:27], s60 offen offset:2048 lds
  buffer_load_dwordx4 v14, s[24:27], s60 offen offset:3072 lds
  s_add_u32 m0, s68, 131072
  s_nop 0
  buffer_load_dwordx4 v15, s[24:27], s60 offen offset:0 lds
  buffer_load_dwordx4 v16, s[24:27], s60 offen offset:1024 lds
  s_add_u32 m0, s67, 81920
  s_add_u32 s61, s13, 1
  s_sub_u32 s62, s61, 9
  s_cmp_ge_u32 s61, 9
  s_cselect_b32 s61, s62, s61
  s_lshl_b32 s61, s61, 19
  s_add_u32 s61, s61, s65
  s_add_u32 s60, s61, 0
  s_add_u32 s60, s60, s10
  s_sub_u32 s60, s60, s1
  s_add_u32 s60, s60, 256
  buffer_load_dwordx4 v7, s[28:31], s60 offen offset:0 lds
  buffer_load_dwordx4 v8, s[28:31], s60 offen offset:1024 lds
  buffer_load_dwordx4 v9, s[28:31], s60 offen offset:2048 lds
  buffer_load_dwordx4 v10, s[28:31], s60 offen offset:3072 lds
  s_waitcnt vmcnt(18)
  s_barrier
  s_add_u32 m0, s67, 8192
  s_add_u32 s60, s74, 8192
  s_and_b32 s60, s60, 0x1ffff
  s_add_u32 s60, s60, s64
  s_add_u32 s60, s60, s9
  s_add_u32 s60, s60, s0
  buffer_load_dwordx4 v2, s[16:19], s60 offen offset:0 nt lds
  buffer_load_dwordx4 v3, s[16:19], s60 offen offset:1024 nt lds
  buffer_load_dwordx4 v4, s[16:19], s60 offen offset:2048 nt lds
  buffer_load_dwordx4 v5, s[16:19], s60 offen offset:3072 nt lds
  s_add_u32 m0, s67, 90112
  s_add_u32 s61, s13, 1
  s_sub_u32 s62, s61, 9
  s_cmp_ge_u32 s61, 9
  s_cselect_b32 s61, s62, s61
  s_lshl_b32 s61, s61, 19
  s_add_u32 s61, s61, s65
  s_add_u32 s60, s61, 262144
  s_add_u32 s60, s60, s10
  s_sub_u32 s60, s60, s1
  s_add_u32 s60, s60, 256
  buffer_load_dwordx4 v7, s[28:31], s60 offen offset:0 lds
  buffer_load_dwordx4 v8, s[28:31], s60 offen offset:1024 lds
  buffer_load_dwordx4 v9, s[28:31], s60 offen offset:2048 lds
  buffer_load_dwordx4 v10, s[28:31], s60 offen offset:3072 lds
  s_waitcnt vmcnt(18)
  s_barrier
  s_add_u32 m0, s67, 16384
  s_add_u32 s60, s74, 16384
  s_and_b32 s60, s60, 0x1ffff
  s_add_u32 s60, s60, s64
  s_add_u32 s60, s60, s9
  s_add_u32 s60, s60, s0
  buffer_load_dwordx4 v2, s[16:19], s60 offen offset:0 nt lds
  buffer_load_dwordx4 v3, s[16:19], s60 offen offset:1024 nt lds
  buffer_load_dwordx4 v4, s[16:19], s60 offen offset:2048 nt lds
  buffer_load_dwordx4 v5, s[16:19], s60 offen offset:3072 nt lds
  s_add_u32 m0, s67, 32768
  s_add_u32 s60, s74, 0
  s_and_b32 s60, s60, 0x1ffff
  s_add_u32 s60, s60, s64
  s_add_u32 s60, s60, s9
  s_add_u32 s60, s60, s0
  buffer_load_dwordx4 v6, s[20:23], s60 offen offset:0 nt lds
  buffer_load_dwordx4 v6, s[20:23], s60 offen offset:1024 nt lds
  buffer_load_dwordx4 v6, s[20:23], s60 offen offset:2048 nt lds
  buffer_load_dwordx4 v6, s[20:23], s60 offen offset:3072 nt lds
  s_add_u32 m0, s68, 139264
  s_add_u32 s61, s13, 2
  s_sub_u32 s62, s61, 9
  s_cmp_ge_u32 s61, 9
  s_cselect_b32 s61, s62, s61
  s_lshl_b32 s61, s61, 7
  s_add_u32 s60, s61, s66
  buffer_load_dwordx4 v11, s[24:27], s60 offen offset:0 lds
  buffer_load_dwordx4 v12, s[24:27], s60 offen offset:1024 lds
  buffer_load_dwordx4 v13, s[24:27], s60 offen offset:2048 lds
  buffer_load_dwordx4 v14, s[24:27], s60 offen offset:3072 lds
  s_add_u32 m0, s68, 143360
  s_nop 0
  buffer_load_dwordx4 v15, s[24:27], s60 offen offset:0 lds
  buffer_load_dwordx4 v16, s[24:27], s60 offen offset:1024 lds
  s_add_u32 m0, s67, 98304
  s_add_u32 s61, s13, 2
  s_sub_u32 s62, s61, 9
  s_cmp_ge_u32 s61, 9
  s_cselect_b32 s61, s62, s61
  s_lshl_b32 s61, s61, 19
  s_add_u32 s61, s61, s65
  s_add_u32 s60, s61, 0
  s_add_u32 s60, s60, s10
  s_sub_u32 s60, s60, s1
  s_add_u32 s60, s60, 256
  buffer_load_dwordx4 v7, s[28:31], s60 offen offset:0 lds
  buffer_load_dwordx4 v8, s[28:31], s60 offen offset:1024 lds
  buffer_load_dwordx4 v9, s[28:31], s60 offen offset:2048 lds
  buffer_load_dwordx4 v10, s[28:31], s60 offen offset:3072 lds
  s_waitcnt vmcnt(22)
  s_barrier
  s_add_u32 m0, s67, 24576
  s_add_u32 s60, s74, 24576
  s_and_b32 s60, s60, 0x1ffff
  s_add_u32 s60, s60, s64
  s_add_u32 s60, s60, s9
  s_add_u32 s60, s60, s0
  buffer_load_dwordx4 v2, s[16:19], s60 offen offset:0 nt lds
  buffer_load_dwordx4 v3, s[16:19], s60 offen offset:1024 nt lds
  buffer_load_dwordx4 v4, s[16:19], s60 offen offset:2048 nt lds
  buffer_load_dwordx4 v5, s[16:19], s60 offen offset:3072 nt lds
  s_add_u32 m0, s67, 40960
  s_add_u32 s60, s74, 8192
  s_and_b32 s60, s60, 0x1ffff
  s_add_u32 s60, s60, s64
  s_add_u32 s60, s60, s9
  s_add_u32 s60, s60, s0
  buffer_load_dwordx4 v6, s[20:23], s60 offen offset:0 nt lds
  buffer_load_dwordx4 v6, s[20:23], s60 offen offset:1024 nt lds
  buffer_load_dwordx4 v6, s[20:23], s60 offen offset:2048 nt lds
  buffer_load_dwordx4 v6, s[20:23], s60 offen offset:3072 nt lds
  s_add_u32 m0, s67, 106496
  s_add_u32 s61, s13, 2
  s_sub_u32 s62, s61, 9
  s_cmp_ge_u32 s61, 9
  s_cselect_b32 s61, s62, s61
  s_lshl_b32 s61, s61, 19
  s_add_u32 s61, s61, s65
  s_add_u32 s60, s61, 262144
  s_add_u32 s60, s60, s10
  s_sub_u32 s60, s60, s1
  s_add_u32 s60, s60, 256
  buffer_load_dwordx4 v7, s[28:31], s60 offen offset:0 lds
  buffer_load_dwordx4 v8, s[28:31], s60 offen offset:1024 lds
  buffer_load_dwordx4 v9, s[28:31], s60 offen offset:2048 lds
  buffer_load_dwordx4 v10, s[28:31], s60 offen offset:3072 lds
  s_waitcnt vmcnt(22)
  s_barrier
  s_add_u32 m0, s67, 0
  s_add_u32 s60, s74, 32768
  s_and_b32 s60, s60, 0x1ffff
  s_add_u32 s60, s60, s64
  s_add_u32 s60, s60, s9
  s_add_u32 s60, s60, s0
  buffer_load_dwordx4 v2, s[16:19], s60 offen offset:0 nt lds
  buffer_load_dwordx4 v3, s[16:19], s60 offen offset:1024 nt lds
  buffer_load_dwordx4 v4, s[16:19], s60 offen offset:2048 nt lds
  buffer_load_dwordx4 v5, s[16:19], s60 offen offset:3072 nt lds
  s_add_u32 m0, s67, 49152
  s_add_u32 s60, s74, 16384
  s_and_b32 s60, s60, 0x1ffff
  s_add_u32 s60, s60, s64
  s_add_u32 s60, s60, s9
  s_add_u32 s60, s60, s0
  buffer_load_dwordx4 v6, s[20:23], s60 offen offset:0 nt lds
  buffer_load_dwordx4 v6, s[20:23], s60 offen offset:1024 nt lds
  buffer_load_dwordx4 v6, s[20:23], s60 offen offset:2048 nt lds
  buffer_load_dwordx4 v6, s[20:23], s60 offen offset:3072 nt lds
  s_add_u32 m0, s68, 114688
  s_add_u32 s61, s13, 3
  s_sub_u32 s62, s61, 9
  s_cmp_ge_u32 s61, 9
  s_cselect_b32 s61, s62, s61
  s_lshl_b32 s61, s61, 7
  s_add_u32 s60, s61, s66
  buffer_load_dwordx4 v11, s[24:27], s60 offen offset:0 lds
  buffer_load_dwordx4 v12, s[24:27], s60 offen offset:1024 lds
  buffer_load_dwordx4 v13, s[24:27], s60 offen offset:2048 lds
  buffer_load_dwordx4 v14, s[24:27], s60 offen offset:3072 lds
  s_add_u32 m0, s68, 118784
  s_nop 0
  buffer_load_dwordx4 v15, s[24:27], s60 offen offset:0 lds
  buffer_load_dwordx4 v16, s[24:27], s60 offen offset:1024 lds
  s_add_u32 m0, s67, 65536
  s_add_u32 s61, s13, 3
  s_sub_u32 s62, s61, 9
  s_cmp_ge_u32 s61, 9
  s_cselect_b32 s61, s62, s61
  s_lshl_b32 s61, s61, 19
  s_add_u32 s61, s61, s65
  s_add_u32 s60, s61, 0
  s_add_u32 s60, s60, s10
  s_sub_u32 s60, s60, s1
  s_add_u32 s60, s60, 256
  buffer_load_dwordx4 v7, s[28:31], s60 offen offset:0 lds
  buffer_load_dwordx4 v8, s[28:31], s60 offen offset:1024 lds
  buffer_load_dwordx4 v9, s[28:31], s60 offen offset:2048 lds
  buffer_load_dwordx4 v10, s[28:31], s60 offen offset:3072 lds
  s_waitcnt vmcnt(22)
  s_barrier
  s_add_u32 m0, s67, 8192
  s_add_u32 s60, s74, 40960
  s_and_b32 s60, s60, 0x1ffff
  s_add_u32 s60, s60, s64
  s_add_u32 s60, s60, s9
  s_add_u32 s60, s60, s0
  buffer_load_dwordx4 v2, s[16:19], s60 offen offset:0 nt lds
  buffer_load_dwordx4 v3, s[16:19], s60 offen offset:1024 nt lds
  buffer_load_dwordx4 v4, s[16:19], s60 offen offset:2048 nt lds
  buffer_load_dwordx4 v5, s[16:19], s60 offen offset:3072 nt lds
  s_add_u32 m0, s67, 57344
  s_add_u32 s60, s74, 24576
  s_and_b32 s60, s60, 0x1ffff
  s_add_u32 s60, s60, s64
  s_add_u32 s60, s60, s9
  s_add_u32 s60, s60, s0
  buffer_load_dwordx4 v6, s[20:23], s60 offen offset:0 nt lds
  buffer_load_dwordx4 v6, s[20:23], s60 offen offset:1024 nt lds
  buffer_load_dwordx4 v6, s[20:23], s60 offen offset:2048 nt lds
  buffer_load_dwordx4 v6, s[20:23], s60 offen offset:3072 nt lds
  s_add_u32 m0, s67, 73728
  s_add_u32 s61, s13, 3
  s_sub_u32 s62, s61, 9
  s_cmp_ge_u32 s61, 9
  s_cselect_b32 s61, s62, s61
  s_lshl_b32 s61, s61, 19
  s_add_u32 s61, s61, s65
  s_add_u32 s60, s61, 262144
  s_add_u32 s60, s60, s10
  s_sub_u32 s60, s60, s1
  s_add_u32 s60, s60, 256
  buffer_load_dwordx4 v7, s[28:31], s60 offen offset:0 lds
  buffer_load_dwordx4 v8, s[28:31], s60 offen offset:1024 lds
  buffer_load_dwordx4 v9, s[28:31], s60 offen offset:2048 lds
  buffer_load_dwordx4 v10, s[28:31], s60 offen offset:3072 lds
  s_waitcnt vmcnt(22)
  s_barrier
  s_cmp_lg_u32 s5, 0
  s_cbranch_scc1 L_hs2_58
  global_load_dwordx2 v[252:253], v255, s[46:47] sc1
L_hs2_58:
  s_add_u32 m0, s67, 16384
  s_add_u32 s60, s74, 49152
  s_and_b32 s60, s60, 0x1ffff
  s_add_u32 s60, s60, s64
  s_add_u32 s60, s60, s9
  s_add_u32 s60, s60, s0
  buffer_load_dwordx4 v2, s[16:19], s60 offen offset:0 nt lds
  buffer_load_dwordx4 v3, s[16:19], s60 offen offset:1024 nt lds
  buffer_load_dwordx4 v4, s[16:19], s60 offen offset:2048 nt lds
  buffer_load_dwordx4 v5, s[16:19], s60 offen offset:3072 nt lds
  s_add_u32 m0, s67, 32768
  s_add_u32 s60, s74, 32768
  s_and_b32 s60, s60, 0x1ffff
  s_add_u32 s60, s60, s64
  s_add_u32 s60, s60, s9
  s_add_u32 s60, s60, s0
  buffer_load_dwordx4 v6, s[20:23], s60 offen offset:0 nt lds
  buffer_load_dwordx4 v6, s[20:23], s60 offen offset:1024 nt lds
  buffer_load_dwordx4 v6, s[20:23], s60 offen offset:2048 nt lds
  buffer_load_dwordx4 v6, s[20:23], s60 offen offset:3072 nt lds
  s_add_u32 m0, s68, 126976
  s_add_u32 s61, s13, 4
  s_sub_u32 s62, s61, 9
  s_cmp_ge_u32 s61, 9
  s_cselect_b32 s61, s62, s61
  s_lshl_b32 s61, s61, 7
  s_add_u32 s60, s61, s66
  buffer_load_dwordx4 v11, s[24:27], s60 offen offset:0 lds
  buffer_load_dwordx4 v12, s[24:27], s60 offen offset:1024 lds
  buffer_load_dwordx4 v13, s[24:27], s60 offen offset:2048 lds
  buffer_load_dwordx4 v14, s[24:27], s60 offen offset:3072 lds
  s_add_u32 m0, s68, 131072
  s_nop 0
  buffer_load_dwordx4 v15, s[24:27], s60 offen offset:0 lds
  buffer_load_dwordx4 v16, s[24:27], s60 offen offset:1024 lds
  s_add_u32 m0, s67, 81920
  s_add_u32 s61, s13, 4
  s_sub_u32 s62, s61, 9
  s_cmp_ge_u32 s61, 9
  s_cselect_b32 s61, s62, s61
  s_lshl_b32 s61, s61, 19
  s_add_u32 s61, s61, s65
  s_add_u32 s60, s61, 0
  s_add_u32 s60, s60, s10
  s_sub_u32 s60, s60, s1
  s_add_u32 s60, s60, 256
  buffer_load_dwordx4 v7, s[28:31], s60 offen offset:0 lds
  buffer_load_dwordx4 v8, s[28:31], s60 offen offset:1024 lds
  buffer_load_dwordx4 v9, s[28:31], s60 offen offset:2048 lds
  buffer_load_dwordx4 v10, s[28:31], s60 offen offset:3072 lds
  s_waitcnt vmcnt(22)
  s_barrier
  s_cmp_lg_u32 s5, 1
  s_cbranch_scc1 L_hs2_59
  global_load_dwordx2 v[252:253], v255, s[46:47] sc1
L_hs2_59:
  s_add_u32 m0, s67, 24576
  s_add_u32 s60, s74, 57344
  s_and_b32 s60, s60, 0x1ffff
  s_add_u32 s60, s60, s64
  s_add_u32 s60, s60, s9
  s_add_u32 s60, s60, s0
  buffer_load_dwordx4 v2, s[16:19], s60 offen offset:0 nt lds
  buffer_load_dwordx4 v3, s[16:19], s60 offen offset:1024 nt lds
  buffer_load_dwordx4 v4, s[16:19], s60 offen offset:2048 nt lds
  buffer_load_dwordx4 v5, s[16:19], s60 offen offset:3072 nt lds
  s_add_u32 m0, s67, 40960
  s_add_u32 s60, s74, 40960
  s_and_b32 s60, s60, 0x1ffff
  s_add_u32 s60, s60, s64
  s_add_u32 s60, s60, s9
  s_add_u32 s60, s60, s0
  buffer_load_dwordx4 v6, s[20:23], s60 offen offset:0 nt lds
  buffer_load_dwordx4 v6, s[20:23], s60 offen offset:1024 nt lds
  buffer_load_dwordx4 v6, s[20:23], s60 offen offset:2048 nt lds
  buffer_load_dwordx4 v6, s[20:23], s60 offen offset:3072 nt lds
  s_add_u32 m0, s67, 90112
  s_add_u32 s61, s13, 4
  s_sub_u32 s62, s61, 9
  s_cmp_ge_u32 s61, 9
  s_cselect_b32 s61, s62, s61
  s_lshl_b32 s61, s61, 19
  s_add_u32 s61, s61, s65
  s_add_u32 s60, s61, 262144
  s_add_u32 s60, s60, s10
  s_sub_u32 s60, s60, s1
  s_add_u32 s60, s60, 256
  buffer_load_dwordx4 v7, s[28:31], s60 offen offset:0 lds
  buffer_load_dwordx4 v8, s[28:31], s60 offen offset:1024 lds
  buffer_load_dwordx4 v9, s[28:31], s60 offen offset:2048 lds
  buffer_load_dwordx4 v10, s[28:31], s60 offen offset:3072 lds
  s_waitcnt vmcnt(22)
  s_barrier
  s_cmp_lg_u32 s5, 2
  s_cbranch_scc1 L_hs2_60
  global_load_dwordx2 v[252:253], v255, s[46:47] sc1
L_hs2_60:
  s_add_u32 m0, s67, 0
  s_add_u32 s60, s74, 65536
  s_and_b32 s60, s60, 0x1ffff
  s_add_u32 s60, s60, s64
  s_add_u32 s60, s60, s9
  s_add_u32 s60, s60, s0
  buffer_load_dwordx4 v2, s[16:19], s60 offen offset:0 nt lds
  buffer_load_dwordx4 v3, s[16:19], s60 offen offset:1024 nt lds
  buffer_load_dwordx4 v4, s[16:19], s60 offen offset:2048 nt lds
  buffer_load_dwordx4 v5, s[16:19], s60 offen offset:3072 nt lds
  s_add_u32 m0, s67, 49152
  s_add_u32 s60, s74, 49152
  s_and_b32 s60, s60, 0x1ffff
  s_add_u32 s60, s60, s64
  s_add_u32 s60, s60, s9
  s_add_u32 s60, s60, s0
  buffer_load_dwordx4 v6, s[20:23], s60 offen offset:0 nt lds
  buffer_load_dwordx4 v6, s[20:23], s60 offen offset:1024 nt lds
  buffer_load_dwordx4 v6, s[20:23], s60 offen offset:2048 nt lds
  buffer_load_dwordx4 v6, s[20:23], s60 offen offset:3072 nt lds
  s_add_u32 m0, s68, 139264
  s_add_u32 s61, s13, 5
  s_sub_u32 s62, s61, 9
  s_cmp_ge_u32 s61, 9
  s_cselect_b32 s61, s62, s61
  s_lshl_b32 s61, s61, 7
  s_add_u32 s60, s61, s66
  buffer_load_dwordx4 v11, s[24:27], s60 offen offset:0 lds
  buffer_load_dwordx4 v12, s[24:27], s60 offen offset:1024 lds
  buffer_load_dwordx4 v13, s[24:27], s60 offen offset:2048 lds
  buffer_load_dwordx4 v14, s[24:27], s60 offen offset:3072 lds
  s_add_u32 m0, s68, 143360
  s_nop 0
  buffer_load_dwordx4 v15, s[24:27], s60 offen offset:0 lds
  buffer_load_dwordx4 v16, s[24:27], s60 offen offset:1024 lds
  s_add_u32 m0, s67, 98304
  s_add_u32 s61, s13, 5
  s_sub_u32 s62, s61, 9
  s_cmp_ge_u32 s61, 9
  s_cselect_b32 s61, s62, s61
  s_lshl_b32 s61, s61, 19
  s_add_u32 s61, s61, s65
  s_add_u32 s60, s61, 0
  s_add_u32 s60, s60, s10
  s_sub_u32 s60, s60, s1
  s_add_u32 s60, s60, 256
  buffer_load_dwordx4 v7, s[28:31], s60 offen offset:0 lds
  buffer_load_dwordx4 v8, s[28:31], s60 offen offset:1024 lds
  buffer_load_dwordx4 v9, s[28:31], s60 offen offset:2048 lds
  buffer_load_dwordx4 v10, s[28:31], s60 offen offset:3072 lds
  s_waitcnt vmcnt(22)
  s_barrier
  s_cmp_lg_u32 s5, 3
  s_cbranch_scc1 L_hs2_61
  global_load_dwordx2 v[252:253], v255, s[46:47] sc1
L_hs2_61:
  s_add_u32 m0, s67, 8192
  s_add_u32 s60, s74, 73728
  s_and_b32 s60, s60, 0x1ffff
  s_add_u32 s60, s60, s64
  s_add_u32 s60, s60, s9
  s_add_u32 s60, s60, s0
  buffer_load_dwordx4 v2, s[16:19], s60 offen offset:0 nt lds
  buffer_load_dwordx4 v3, s[16:19], s60 offen offset:1024 nt lds
  buffer_load_dwordx4 v4, s[16:19], s60 offen offset:2048 nt lds
  buffer_load_dwordx4 v5, s[16:19], s60 offen offset:3072 nt lds
  s_add_u32 m0, s67, 57344
  s_add_u32 s60, s74, 57344
  s_and_b32 s60, s60, 0x1ffff
  s_add_u32 s60, s60, s64
  s_add_u32 s60, s60, s9
  s_add_u32 s60, s60, s0
  buffer_load_dwordx4 v6, s[20:23], s60 offen offset:0 nt lds
  buffer_load_dwordx4 v6, s[20:23], s60 offen offset:1024 nt lds
  buffer_load_dwordx4 v6, s[20:23], s60 offen offset:2048 nt lds
  buffer_load_dwordx4 v6, s[20:23], s60 offen offset:3072 nt lds
  s_add_u32 m0, s67, 106496
  s_add_u32 s61, s13, 5
  s_sub_u32 s62, s61, 9
  s_cmp_ge_u32 s61, 9
  s_cselect_b32 s61, s62, s61
  s_lshl_b32 s61, s61, 19
  s_add_u32 s61, s61, s65
  s_add_u32 s60, s61, 262144
  s_add_u32 s60, s60, s10
  s_sub_u32 s60, s60, s1
  s_add_u32 s60, s60, 256
  buffer_load_dwordx4 v7, s[28:31], s60 offen offset:0 lds
  buffer_load_dwordx4 v8, s[28:31], s60 offen offset:1024 lds
  buffer_load_dwordx4 v9, s[28:31], s60 offen offset:2048 lds
  buffer_load_dwordx4 v10, s[28:31], s60 offen offset:3072 lds
  s_waitcnt vmcnt(22)
  s_barrier
  s_cmp_lg_u32 s5, 4
  s_cbranch_scc1 L_hs2_62
  global_load_dwordx2 v[252:253], v255, s[46:47] sc1
L_hs2_62:
  s_add_u32 m0, s67, 16384
  s_add_u32 s60, s74, 81920
  s_and_b32 s60, s60, 0x1ffff
  s_add_u32 s60, s60, s64
  s_add_u32 s60, s60, s9
  s_add_u32 s60, s60, s0
  buffer_load_dwordx4 v2, s[16:19], s60 offen offset:0 nt lds
  buffer_load_dwordx4 v3, s[16:19], s60 offen offset:1024 nt lds
  buffer_load_dwordx4 v4, s[16:19], s60 offen offset:2048 nt lds
  buffer_load_dwordx4 v5, s[16:19], s60 offen offset:3072 nt lds
  s_add_u32 m0, s67, 32768
  s_add_u32 s60, s74, 65536
  s_and_b32 s60, s60, 0x1ffff
  s_add_u32 s60, s60, s64
  s_add_u32 s60, s60, s9
  s_add_u32 s60, s60, s0
  buffer_load_dwordx4 v6, s[20:23], s60 offen offset:0 nt lds
  buffer_load_dwordx4 v6, s[20:23], s60 offen offset:1024 nt lds
  buffer_load_dwordx4 v6, s[20:23], s60 offen offset:2048 nt lds
  buffer_load_dwordx4 v6, s[20:23], s60 offen offset:3072 nt lds
  s_add_u32 m0, s68, 114688
  s_add_u32 s61, s13, 6
  s_sub_u32 s62, s61, 9
  s_cmp_ge_u32 s61, 9
  s_cselect_b32 s61, s62, s61
  s_lshl_b32 s61, s61, 7
  s_add_u32 s60, s61, s66
  buffer_load_dwordx4 v11, s[24:27], s60 offen offset:0 lds
  buffer_load_dwordx4 v12, s[24:27], s60 offen offset:1024 lds
  buffer_load_dwordx4 v13, s[24:27], s60 offen offset:2048 lds
  buffer_load_dwordx4 v14, s[24:27], s60 offen offset:3072 lds
  s_add_u32 m0, s68, 118784
  s_nop 0
  buffer_load_dwordx4 v15, s[24:27], s60 offen offset:0 lds
  buffer_load_dwordx4 v16, s[24:27], s60 offen offset:1024 lds
  s_add_u32 m0, s67, 65536
  s_add_u32 s61, s13, 6
  s_sub_u32 s62, s61, 9
  s_cmp_ge_u32 s61, 9
  s_cselect_b32 s61, s62, s61
  s_lshl_b32 s61, s61, 19
  s_add_u32 s61, s61, s65
  s_add_u32 s60, s61, 0
  s_add_u32 s60, s60, s10
  s_sub_u32 s60, s60, s1
  s_add_u32 s60, s60, 256
  buffer_load_dwordx4 v7, s[28:31], s60 offen offset:0 lds
  buffer_load_dwordx4 v8, s[28:31], s60 offen offset:1024 lds
  buffer_load_dwordx4 v9, s[28:31], s60 offen offset:2048 lds
  buffer_load_dwordx4 v10, s[28:31], s60 offen offset:3072 lds
  s_waitcnt vmcnt(22)
  s_barrier
  s_cmp_lg_u32 s5, 5
  s_cbranch_scc1 L_hs2_63
  global_load_dwordx2 v[252:253], v255, s[46:47] sc1
L_hs2_63:
  s_add_u32 m0, s67, 24576
  s_add_u32 s60, s74, 90112
  s_and_b32 s60, s60, 0x1ffff
  s_add_u32 s60, s60, s64
  s_add_u32 s60, s60, s9
  s_add_u32 s60, s60, s0
  buffer_load_dwordx4 v2, s[16:19], s60 offen offset:0 nt lds
  buffer_load_dwordx4 v3, s[16:19], s60 offen offset:1024 nt lds
  buffer_load_dwordx4 v4, s[16:19], s60 offen offset:2048 nt lds
  buffer_load_dwordx4 v5, s[16:19], s60 offen offset:3072 nt lds
  s_add_u32 m0, s67, 40960
  s_add_u32 s60, s74, 73728
  s_and_b32 s60, s60, 0x1ffff
  s_add_u32 s60, s60, s64
  s_add_u32 s60, s60, s9
  s_add_u32 s60, s60, s0
  buffer_load_dwordx4 v6, s[20:23], s60 offen offset:0 nt lds
  buffer_load_dwordx4 v6, s[20:23], s60 offen offset:1024 nt lds
  buffer_load_dwordx4 v6, s[20:23], s60 offen offset:2048 nt lds
  buffer_load_dwordx4 v6, s[20:23], s60 offen offset:3072 nt lds
  s_add_u32 m0, s67, 73728
  s_add_u32 s61, s13, 6
  s_sub_u32 s62, s61, 9
  s_cmp_ge_u32 s61, 9
  s_cselect_b32 s61, s62, s61
  s_lshl_b32 s61, s61, 19
  s_add_u32 s61, s61, s65
  s_add_u32 s60, s61, 262144
  s_add_u32 s60, s60, s10
  s_sub_u32 s60, s60, s1
  s_add_u32 s60, s60, 256
  buffer_load_dwordx4 v7, s[28:31], s60 offen offset:0 lds
  buffer_load_dwordx4 v8, s[28:31], s60 offen offset:1024 lds
  buffer_load_dwordx4 v9, s[28:31], s60 offen offset:2048 lds
  buffer_load_dwordx4 v10, s[28:31], s60 offen offset:3072 lds
  s_waitcnt vmcnt(22)
  s_barrier
  s_cmp_lg_u32 s5, 6
  s_cbranch_scc1 L_hs2_64
  global_load_dwordx2 v[252:253], v255, s[46:47] sc1
L_hs2_64:
  buffer_load_dword v27, v25, s[32:35], 0 offen offset:0 nt
  buffer_load_dword v27, v25, s[32:35], 0 offen offset:0 sc1
  s_add_u32 m0, s67, 0
  s_add_u32 s60, s74, 98304
  s_and_b32 s60, s60, 0x1ffff
  s_add_u32 s60, s60, s64
  s_add_u32 s60, s60, s9
  s_add_u32 s60, s60, s0
  buffer_load_dwordx4 v2, s[16:19], s60 offen offset:0 nt lds
  buffer_load_dwordx4 v3, s[16:19], s60 offen offset:1024 nt lds
  buffer_load_dwordx4 v4, s[16:19], s60 offen offset:2048 nt lds
  buffer_load_dwordx4 v5, s[16:19], s60 offen offset:3072 nt lds
  s_add_u32 m0, s67, 49152
  s_add_u32 s60, s74, 81920
  s_and_b32 s60, s60, 0x1ffff
  s_add_u32 s60, s60, s64
  s_add_u32 s60, s60, s9
  s_add_u32 s60, s60, s0
  buffer_load_dwordx4 v6, s[20:23], s60 offen offset:0 nt lds
  buffer_load_dwordx4 v6, s[20:23], s60 offen offset:1024 nt lds
  buffer_load_dwordx4 v6, s[20:23], s60 offen offset:2048 nt lds
  buffer_load_dwordx4 v6, s[20:23], s60 offen offset:3072 nt lds
  s_add_u32 m0, s68, 126976
  s_add_u32 s61, s13, 7
  s_sub_u32 s62, s61, 9
  s_cmp_ge_u32 s61, 9
  s_cselect_b32 s61, s62, s61
  s_lshl_b32 s61, s61, 7
  s_add_u32 s60, s61, s66
  buffer_load_dwordx4 v11, s[24:27], s60 offen offset:0 lds
  buffer_load_dwordx4 v12, s[24:27], s60 offen offset:1024 lds
  buffer_load_dwordx4 v13, s[24:27], s60 offen offset:2048 lds
  buffer_load_dwordx4 v14, s[24:27], s60 offen offset:3072 lds
  s_add_u32 m0, s68, 131072
  s_nop 0
  buffer_load_dwordx4 v15, s[24:27], s60 offen offset:0 lds
  buffer_load_dwordx4 v16, s[24:27], s60 offen offset:1024 lds
  s_add_u32 m0, s67, 81920
  s_add_u32 s61, s13, 7
  s_sub_u32 s62, s61, 9
  s_cmp_ge_u32 s61, 9
  s_cselect_b32 s61, s62, s61
  s_lshl_b32 s61, s61, 19
  s_add_u32 s61, s61, s65
  s_add_u32 s60, s61, 0
  s_add_u32 s60, s60, s10
  s_sub_u32 s60, s60, s1
  s_add_u32 s60, s60, 256
  buffer_load_dwordx4 v7, s[28:31], s60 offen offset:0 lds
  buffer_load_dwordx4 v8, s[28:31], s60 offen offset:1024 lds
  buffer_load_dwordx4 v9, s[28:31], s60 offen offset:2048 lds
  buffer_load_dwordx4 v10, s[28:31], s60 offen offset:3072 lds
  s_waitcnt vmcnt(24)
  s_barrier
  s_cmp_lg_u32 s5, 7
  s_cbranch_scc1 L_hs2_65
  global_load_dwordx2 v[252:253], v255, s[46:47] sc1
L_hs2_65:
  s_add_u32 m0, s67, 8192
  s_add_u32 s60, s74, 106496
  s_and_b32 s60, s60, 0x1ffff
  s_add_u32 s60, s60, s64
  s_add_u32 s60, s60, s9
  s_add_u32 s60, s60, s0
  buffer_load_dwordx4 v2, s[16:19], s60 offen offset:0 nt lds
  buffer_load_dwordx4 v3, s[16:19], s60 offen offset:1024 nt lds
  buffer_load_dwordx4 v4, s[16:19], s60 offen offset:2048 nt lds
  buffer_load_dwordx4 v5, s[16:19], s60 offen offset:3072 nt lds
  s_add_u32 m0, s67, 57344
  s_add_u32 s60, s74, 90112
  s_and_b32 s60, s60, 0x1ffff
  s_add_u32 s60, s60, s64
  s_add_u32 s60, s60, s9
  s_add_u32 s60, s60, s0
  buffer_load_dwordx4 v6, s[20:23], s60 offen offset:0 nt lds
  buffer_load_dwordx4 v6, s[20:23], s60 offen offset:1024 nt lds
  buffer_load_dwordx4 v6, s[20:23], s60 offen offset:2048 nt lds
  buffer_load_dwordx4 v6, s[20:23], s60 offen offset:3072 nt lds
  s_add_u32 m0, s67, 90112
  s_add_u32 s61, s13, 7
  s_sub_u32 s62, s61, 9
  s_cmp_ge_u32 s61, 9
  s_cselect_b32 s61, s62, s61
  s_lshl_b32 s61, s61, 19
  s_add_u32 s61, s61, s65
  s_add_u32 s60, s61, 262144
  s_add_u32 s60, s60, s10
  s_sub_u32 s60, s60, s1
  s_add_u32 s60, s60, 256
  buffer_load_dwordx4 v7, s[28:31], s60 offen offset:0 lds
  buffer_load_dwordx4 v8, s[28:31], s60 offen offset:1024 lds
  buffer_load_dwordx4 v9, s[28:31], s60 offen offset:2048 lds
  buffer_load_dwordx4 v10, s[28:31], s60 offen offset:3072 lds
  s_waitcnt vmcnt(22)
  s_barrier
  s_cmp_lg_u32 s5, 8
  s_cbranch_scc1 L_hs2_66
  global_load_dwordx2 v[252:253], v255, s[46:47] sc1
L_hs2_66:
  s_add_u32 m0, s67, 16384
  s_add_u32 s60, s74, 114688
  s_and_b32 s60, s60, 0x1ffff
  s_add_u32 s60, s60, s64
  s_add_u32 s60, s60, s9
  s_add_u32 s60, s60, s0
  buffer_load_dwordx4 v2, s[16:19], s60 offen offset:0 nt lds
  buffer_load_dwordx4 v3, s[16:19], s60 offen offset:1024 nt lds
  buffer_load_dwordx4 v4, s[16:19], s60 offen offset:2048 nt lds
  buffer_load_dwordx4 v5, s[16:19], s60 offen offset:3072 nt lds
  s_add_u32 m0, s67, 32768
  s_add_u32 s60, s74, 98304
  s_and_b32 s60, s60, 0x1ffff
  s_add_u32 s60, s60, s64
  s_add_u32 s60, s60, s9
  s_add_u32 s60, s60, s0
  buffer_load_dwordx4 v6, s[20:23], s60 offen offset:0 nt lds
  buffer_load_dwordx4 v6, s[20:23], s60 offen offset:1024 nt lds
  buffer_load_dwordx4 v6, s[20:23], s60 offen offset:2048 nt lds
  buffer_load_dwordx4 v6, s[20:23], s60 offen offset:3072 nt lds
  s_add_u32 m0, s68, 139264
  s_add_u32 s61, s13, 8
  s_sub_u32 s62, s61, 9
  s_cmp_ge_u32 s61, 9
  s_cselect_b32 s61, s62, s61
  s_lshl_b32 s61, s61, 7
  s_add_u32 s60, s61, s66
  buffer_load_dwordx4 v11, s[24:27], s60 offen offset:0 lds
  buffer_load_dwordx4 v12, s[24:27], s60 offen offset:1024 lds
  buffer_load_dwordx4 v13, s[24:27], s60 offen offset:2048 lds
  buffer_load_dwordx4 v14, s[24:27], s60 offen offset:3072 lds
  s_add_u32 m0, s68, 143360
  s_nop 0
  buffer_load_dwordx4 v15, s[24:27], s60 offen offset:0 lds
  buffer_load_dwordx4 v16, s[24:27], s60 offen offset:1024 lds
  s_add_u32 m0, s67, 98304
  s_add_u32 s61, s13, 8
  s_sub_u32 s62, s61, 9
  s_cmp_ge_u32 s61, 9
  s_cselect_b32 s61, s62, s61
  s_lshl_b32 s61, s61, 19
  s_add_u32 s61, s61, s65
  s_add_u32 s60, s61, 0
  s_add_u32 s60, s60, s10
  s_sub_u32 s60, s60, s1
  s_add_u32 s60, s60, 256
  buffer_load_dwordx4 v7, s[28:31], s60 offen offset:0 lds
  buffer_load_dwordx4 v8, s[28:31], s60 offen offset:1024 lds
  buffer_load_dwordx4 v9, s[28:31], s60 offen offset:2048 lds
  buffer_load_dwordx4 v10, s[28:31], s60 offen offset:3072 lds
  s_waitcnt vmcnt(22)
  s_barrier
  s_cmp_lg_u32 s5, 9
  s_cbranch_scc1 L_hs2_67
  global_load_dwordx2 v[252:253], v255, s[46:47] sc1
L_hs2_67:
  s_add_u32 m0, s67, 24576
  s_add_u32 s60, s74, 122880
  s_and_b32 s60, s60, 0x1ffff
  s_add_u32 s60, s60, s64
  s_add_u32 s60, s60, s9
  s_add_u32 s60, s60, s0
  buffer_load_dwordx4 v2, s[16:19], s60 offen offset:0 nt lds
  buffer_load_dwordx4 v3, s[16:19], s60 offen offset:1024 nt lds
  buffer_load_dwordx4 v4, s[16:19], s60 offen offset:2048 nt lds
  buffer_load_dwordx4 v5, s[16:19], s60 offen offset:3072 nt lds
  s_add_u32 m0, s67, 40960
  s_add_u32 s60, s74, 106496
  s_and_b32 s60, s60, 0x1ffff
  s_add_u32 s60, s60, s64
  s_add_u32 s60, s60, s9
  s_add_u32 s60, s60, s0
  buffer_load_dwordx4 v6, s[20:23], s60 offen offset:0 nt lds
  buffer_load_dwordx4 v6, s[20:23], s60 offen offset:1024 nt lds
  buffer_load_dwordx4 v6, s[20:23], s60 offen offset:2048 nt lds
  buffer_load_dwordx4 v6, s[20:23], s60 offen offset:3072 nt lds
  s_add_u32 m0, s67, 106496
  s_add_u32 s61, s13, 8
  s_sub_u32 s62, s61, 9
  s_cmp_ge_u32 s61, 9
  s_cselect_b32 s61, s62, s61
  s_lshl_b32 s61, s61, 19
  s_add_u32 s61, s61, s65
  s_add_u32 s60, s61, 262144
  s_add_u32 s60, s60, s10
  s_sub_u32 s60, s60, s1
  s_add_u32 s60, s60, 256
  buffer_load_dwordx4 v7, s[28:31], s60 offen offset:0 lds
  buffer_load_dwordx4 v8, s[28:31], s60 offen offset:1024 lds
  buffer_load_dwordx4 v9, s[28:31], s60 offen offset:2048 lds
  buffer_load_dwordx4 v10, s[28:31], s60 offen offset:3072 lds
  s_add_u32 m0, s67, 0
  s_add_u32 s60, s74, 0
  s_and_b32 s60, s60, 0x1ffff
  s_add_u32 s60, s60, s64
  s_add_u32 s60, s60, s9
  s_sub_u32 s60, s60, s0
  s_add_u32 s60, s60, 131072
  buffer_load_dwordx4 v2, s[16:19], s60 offen offset:0 nt lds
  buffer_load_dwordx4 v3, s[16:19], s60 offen offset:1024 nt lds
  buffer_load_dwordx4 v4, s[16:19], s60 offen offset:2048 nt lds
  buffer_load_dwordx4 v5, s[16:19], s60 offen offset:3072 nt lds
  s_waitcnt vmcnt(26)
  s_barrier
  s_cmp_lg_u32 s5, 10
  s_cbranch_scc1 L_hs2_68
  global_load_dwordx2 v[252:253], v255, s[46:47] sc1
L_hs2_68:
  s_add_u32 m0, s67, 49152
  s_add_u32 s60, s74, 114688
  s_and_b32 s60, s60, 0x1ffff
  s_add_u32 s60, s60, s64
  s_add_u32 s60, s60, s9
  s_add_u32 s60, s60, s0
  buffer_load_dwordx4 v6, s[20:23], s60 offen offset:0 nt lds
  buffer_load_dwordx4 v6, s[20:23], s60 offen offset:1024 nt lds
  buffer_load_dwordx4 v6, s[20:23], s60 offen offset:2048 nt lds
  buffer_load_dwordx4 v6, s[20:23], s60 offen offset:3072 nt lds
  s_add_u32 m0, s67, 8192
  s_add_u32 s60, s74, 8192
  s_and_b32 s60, s60, 0x1ffff
  s_add_u32 s60, s60, s64
  s_add_u32 s60, s60, s9
  s_sub_u32 s60, s60, s0
  s_add_u32 s60, s60, 131072
  buffer_load_dwordx4 v2, s[16:19], s60 offen offset:0 nt lds
  buffer_load_dwordx4 v3, s[16:19], s60 offen offset:1024 nt lds
  buffer_load_dwordx4 v4, s[16:19], s60 offen offset:2048 nt lds
  buffer_load_dwordx4 v5, s[16:19], s60 offen offset:3072 nt lds
  s_waitcnt vmcnt(16)
  s_barrier
  s_cmp_lg_u32 s5, 11
  s_cbranch_scc1 L_hs2_69
  global_load_dwordx2 v[252:253], v255, s[46:47] sc1
L_hs2_69:
  s_add_u32 m0, s67, 57344
  s_add_u32 s60, s74, 122880
  s_and_b32 s60, s60, 0x1ffff
  s_add_u32 s60, s60, s64
  s_add_u32 s60, s60, s9
  s_add_u32 s60, s60, s0
  buffer_load_dwordx4 v6, s[20:23], s60 offen offset:0 nt lds
  buffer_load_dwordx4 v6, s[20:23], s60 offen offset:1024 nt lds
  buffer_load_dwordx4 v6, s[20:23], s60 offen offset:2048 nt lds
  buffer_load_dwordx4 v6, s[20:23], s60 offen offset:3072 nt lds
  s_add_u32 m0, s67, 16384
  s_add_u32 s60, s74, 16384
  s_and_b32 s60, s60, 0x1ffff
  s_add_u32 s60, s60, s64
  s_add_u32 s60, s60, s9
  s_sub_u32 s60, s60, s0
  s_add_u32 s60, s60, 131072
  buffer_load_dwordx4 v2, s[16:19], s60 offen offset:0 nt lds
  buffer_load_dwordx4 v3, s[16:19], s60 offen offset:1024 nt lds
  buffer_load_dwordx4 v4, s[16:19], s60 offen offset:2048 nt lds
  buffer_load_dwordx4 v5, s[16:19], s60 offen offset:3072 nt lds
  s_add_u32 m0, s67, 32768
  s_add_u32 s60, s74, 0
  s_and_b32 s60, s60, 0x1ffff
  s_add_u32 s60, s60, s64
  s_add_u32 s60, s60, s9
  s_sub_u32 s60, s60, s0
  s_add_u32 s60, s60, 131072
  buffer_load_dwordx4 v6, s[20:23], s60 offen offset:0 nt lds
  buffer_load_dwordx4 v6, s[20:23], s60 offen offset:1024 nt lds
  buffer_load_dwordx4 v6, s[20:23], s60 offen offset:2048 nt lds
  buffer_load_dwordx4 v6, s[20:23], s60 offen offset:3072 nt lds
  s_waitcnt vmcnt(16)
  s_barrier
  s_cmp_lg_u32 s5, 12
  s_cbranch_scc1 L_hs2_70
  global_load_dwordx2 v[252:253], v255, s[46:47] sc1
L_hs2_70:
  s_add_u32 m0, s67, 24576
  s_add_u32 s60, s74, 24576
  s_and_b32 s60, s60, 0x1ffff
  s_add_u32 s60, s60, s64
  s_add_u32 s60, s60, s9
  s_sub_u32 s60, s60, s0
  s_add_u32 s60, s60, 131072
  buffer_load_dwordx4 v2, s[16:19], s60 offen offset:0 nt lds
  buffer_load_dwordx4 v3, s[16:19], s60 offen offset:1024 nt lds
  buffer_load_dwordx4 v4, s[16:19], s60 offen offset:2048 nt lds
  buffer_load_dwordx4 v5, s[16:19], s60 offen offset:3072 nt lds
  s_add_u32 m0, s67, 40960
  s_add_u32 s60, s74, 8192
  s_and_b32 s60, s60, 0x1ffff
  s_add_u32 s60, s60, s64
  s_add_u32 s60, s60, s9
  s_sub_u32 s60, s60, s0
  s_add_u32 s60, s60, 131072
  buffer_load_dwordx4 v6, s[20:23], s60 offen offset:0 nt lds
  buffer_load_dwordx4 v6, s[20:23], s60 offen offset:1024 nt lds
  buffer_load_dwordx4 v6, s[20:23], s60 offen offset:2048 nt lds
  buffer_load_dwordx4 v6, s[20:23], s60 offen offset:3072 nt lds
  s_waitcnt vmcnt(16)
  s_barrier
  s_cmp_lg_u32 s5, 13
  s_cbranch_scc1 L_hs2_71
  global_load_dwordx2 v[252:253], v255, s[46:47] sc1
L_hs2_71:
  s_add_u32 m0, s67, 49152
  s_add_u32 s60, s74, 16384
  s_and_b32 s60, s60, 0x1ffff
  s_add_u32 s60, s60, s64
  s_add_u32 s60, s60, s9
  s_sub_u32 s60, s60, s0
  s_add_u32 s60, s60, 131072
  buffer_load_dwordx4 v6, s[20:23], s60 offen offset:0 nt lds
  buffer_load_dwordx4 v6, s[20:23], s60 offen offset:1024 nt lds
  buffer_load_dwordx4 v6, s[20:23], s60 offen offset:2048 nt lds
  buffer_load_dwordx4 v6, s[20:23], s60 offen offset:3072 nt lds
  s_barrier
  s_cmp_lg_u32 s5, 14
  s_cbranch_scc1 L_hs2_72
  global_load_dwordx2 v[252:253], v255, s[46:47] sc1
L_hs2_72:
  s_mul_i32 s62, s58, 6144
  s_lshl_b32 s63, s8, 8
  s_lshl_b32 s61, s58, 4
  s_add_u32 s63, s63, s61
  s_mul_i32 s63, s63, 1152
  s_add_u32 m0, s62, 139264
  s_add_u32 s60, s63, 0
  s_add_u32 s60, s60, s3
  buffer_load_dwordx4 v246, s[32:35], s60 offen offset:0 lds
  buffer_load_dwordx4 v247, s[32:35], s60 offen offset:1024 lds
  buffer_load_dwordx4 v248, s[32:35], s60 offen offset:2048 lds
  s_add_u32 m0, s62, 142336
  s_add_u32 s60, s63, 9216
  s_add_u32 s60, s60, s3
  buffer_load_dwordx4 v246, s[32:35], s60 offen offset:0 lds
  buffer_load_dwordx4 v247, s[32:35], s60 offen offset:1024 lds
  buffer_load_dwordx4 v248, s[32:35], s60 offen offset:2048 lds
  s_add_u32 m0, s67, 57344
  s_add_u32 s60, s74, 24576
  s_and_b32 s60, s60, 0x1ffff
  s_add_u32 s60, s60, s64
  s_add_u32 s60, s60, s9
  s_sub_u32 s60, s60, s0
  s_add_u32 s60, s60, 131072
  buffer_load_dwordx4 v6, s[20:23], s60 offen offset:0 nt lds
  buffer_load_dwordx4 v6, s[20:23], s60 offen offset:1024 nt lds
  buffer_load_dwordx4 v6, s[20:23], s60 offen offset:2048 nt lds
  buffer_load_dwordx4 v6, s[20:23], s60 offen offset:3072 nt lds
  s_barrier
  s_cmp_lg_u32 s5, 15
  s_cbranch_scc1 L_hs2_73
  global_load_dwordx2 v[252:253], v255, s[46:47] sc1
L_hs2_73:
  s_add_u32 m0, s67, 0
  s_add_u32 s60, s74, 32768
  s_and_b32 s60, s60, 0x1ffff
  s_add_u32 s60, s60, s64
  s_add_u32 s60, s60, s9
  s_sub_u32 s60, s60, s0
  s_add_u32 s60, s60, 131072
  buffer_load_dwordx4 v2, s[16:19], s60 offen offset:0 nt lds
  buffer_load_dwordx4 v3, s[16:19], s60 offen offset:1024 nt lds
  buffer_load_dwordx4 v4, s[16:19], s60 offen offset:2048 nt lds
  buffer_load_dwordx4 v5, s[16:19], s60 offen offset:3072 nt lds
  s_mul_i32 s62, s58, 6144
  s_lshl_b32 s63, s8, 8
  s_lshl_b32 s61, s58, 4
  s_add_u32 s63, s63, s61
  s_mul_i32 s63, s63, 1152
  s_add_u32 m0, s62, 151552
  s_add_u32 s60, s63, 36864
  s_add_u32 s60, s60, s3
  buffer_load_dwordx4 v246, s[32:35], s60 offen offset:0 lds
  buffer_load_dwordx4 v247, s[32:35], s60 offen offset:1024 lds
  buffer_load_dwordx4 v248, s[32:35], s60 offen offset:2048 lds
  s_add_u32 m0, s62, 154624
  s_add_u32 s60, s63, 46080
  s_add_u32 s60, s60, s3
  buffer_load_dwordx4 v246, s[32:35], s60 offen offset:0 lds
  buffer_load_dwordx4 v247, s[32:35], s60 offen offset:1024 lds
  buffer_load_dwordx4 v248, s[32:35], s60 offen offset:2048 lds
  s_waitcnt vmcnt(32)
  s_barrier
  s_add_u32 m0, s67, 8192
  s_add_u32 s60, s74, 40960
  s_and_b32 s60, s60, 0x1ffff
  s_add_u32 s60, s60, s64
  s_add_u32 s60, s60, s9
  s_sub_u32 s60, s60, s0
  s_add_u32 s60, s60, 131072
  buffer_load_dwordx4 v2, s[16:19], s60 offen offset:0 nt lds
  buffer_load_dwordx4 v3, s[16:19], s60 offen offset:1024 nt lds
  buffer_load_dwordx4 v4, s[16:19], s60 offen offset:2048 nt lds
  buffer_load_dwordx4 v5, s[16:19], s60 offen offset:3072 nt lds
  ds_read_b128 v[208:211], v250 offset:24576
  ds_read_b128 v[212:215], v250 offset:25600
  ds_read_b128 v[216:219], v250 offset:26624
  ds_read_b128 v[220:223], v250 offset:27648
  ds_read_b128 v[224:227], v250 offset:28672
  ds_read_b128 v[228:231], v250 offset:29696
  ds_read_b128 v[232:235], v250 offset:30720
  ds_read_b128 v[236:239], v250 offset:31744
  s_waitcnt lgkmcnt(0)
  s_waitcnt vmcnt(28)
  s_barrier
  s_add_u32 m0, s67, 16384
  s_add_u32 s60, s74, 49152
  s_and_b32 s60, s60, 0x1ffff
  s_add_u32 s60, s60, s64
  s_add_u32 s60, s60, s9
  s_sub_u32 s60, s60, s0
  s_add_u32 s60, s60, 131072
  buffer_load_dwordx4 v2, s[16:19], s60 offen offset:0 nt lds
  buffer_load_dwordx4 v3, s[16:19], s60 offen offset:1024 nt lds
  buffer_load_dwordx4 v4, s[16:19], s60 offen offset:2048 nt lds
  buffer_load_dwordx4 v5, s[16:19], s60 offen offset:3072 nt lds
  s_add_u32 m0, s67, 32768
  s_add_u32 s60, s74, 32768
  s_and_b32 s60, s60, 0x1ffff
  s_add_u32 s60, s60, s64
  s_add_u32 s60, s60, s9
  s_sub_u32 s60, s60, s0
  s_add_u32 s60, s60, 131072
  buffer_load_dwordx4 v6, s[20:23], s60 offen offset:0 nt lds
  buffer_load_dwordx4 v6, s[20:23], s60 offen offset:1024 nt lds
  buffer_load_dwordx4 v6, s[20:23], s60 offen offset:2048 nt lds
  buffer_load_dwordx4 v6, s[20:23], s60 offen offset:3072 nt lds
  s_mul_i32 s62, s58, 6144
  s_lshl_b32 s63, s8, 8
  s_lshl_b32 s61, s58, 4
  s_add_u32 s63, s63, s61
  s_mul_i32 s63, s63, 1152
  s_add_u32 m0, s62, 90112
  s_add_u32 s60, s63, 73728
  s_add_u32 s60, s60, s3
  buffer_load_dwordx4 v246, s[32:35], s60 offen offset:0 lds
  buffer_load_dwordx4 v247, s[32:35], s60 offen offset:1024 lds
  buffer_load_dwordx4 v248, s[32:35], s60 offen offset:2048 lds
  s_add_u32 m0, s62, 93184
  s_add_u32 s60, s63, 82944
  s_add_u32 s60, s60, s3
  buffer_load_dwordx4 v246, s[32:35], s60 offen offset:0 lds
  buffer_load_dwordx4 v247, s[32:35], s60 offen offset:1024 lds
  buffer_load_dwordx4 v248, s[32:35], s60 offen offset:2048 lds
  ds_read_b128 v[128:131], v250 offset:0
  ds_read_b128 v[132:135], v250 offset:1024
  ds_read_b128 v[136:139], v250 offset:2048
  ds_read_b128 v[140:143], v250 offset:3072
  ds_read_b128 v[144:147], v250 offset:4096
  ds_read_b128 v[148:151], v250 offset:5120
  ds_read_b128 v[152:155], v250 offset:6144
  ds_read_b128 v[156:159], v250 offset:7168
  s_waitcnt lgkmcnt(0)
  s_waitcnt vmcnt(24)
  s_barrier
  buffer_load_dword v27, v25, s[32:35], 0 offen offset:384 nt
  buffer_load_dword v27, v25, s[32:35], 0 offen offset:384 sc1
  s_add_u32 m0, s67, 24576
  s_add_u32 s60, s74, 57344
  s_and_b32 s60, s60, 0x1ffff
  s_add_u32 s60, s60, s64
  s_add_u32 s60, s60, s9
  s_sub_u32 s60, s60, s0
  s_add_u32 s60, s60, 131072
  buffer_load_dwordx4 v2, s[16:19], s60 offen offset:0 nt lds
  buffer_load_dwordx4 v3, s[16:19], s60 offen offset:1024 nt lds
  buffer_load_dwordx4 v4, s[16:19], s60 offen offset:2048 nt lds
  buffer_load_dwordx4 v5, s[16:19], s60 offen offset:3072 nt lds
  s_add_u32 m0, s67, 40960
  s_add_u32 s60, s74, 40960
  s_and_b32 s60, s60, 0x1ffff
  s_add_u32 s60, s60, s64
  s_add_u32 s60, s60, s9
  s_sub_u32 s60, s60, s0
  s_add_u32 s60, s60, 131072
  buffer_load_dwordx4 v6, s[20:23], s60 offen offset:0 nt lds
  buffer_load_dwordx4 v6, s[20:23], s60 offen offset:1024 nt lds
  buffer_load_dwordx4 v6, s[20:23], s60 offen offset:2048 nt lds
  buffer_load_dwordx4 v6, s[20:23], s60 offen offset:3072 nt lds
  s_mul_i32 s62, s58, 6144
  s_lshl_b32 s63, s8, 8
  s_lshl_b32 s61, s58, 4
  s_add_u32 s63, s63, s61
  s_mul_i32 s63, s63, 1152
  s_add_u32 m0, s62, 102400
  s_add_u32 s60, s63, 110592
  s_add_u32 s60, s60, s3
  buffer_load_dwordx4 v246, s[32:35], s60 offen offset:0 lds
  buffer_load_dwordx4 v247, s[32:35], s60 offen offset:1024 lds
  buffer_load_dwordx4 v248, s[32:35], s60 offen offset:2048 lds
  s_add_u32 m0, s62, 105472
  s_add_u32 s60, s63, 119808
  s_add_u32 s60, s60, s3
  buffer_load_dwordx4 v246, s[32:35], s60 offen offset:0 lds
  buffer_load_dwordx4 v247, s[32:35], s60 offen offset:1024 lds
  buffer_load_dwordx4 v248, s[32:35], s60 offen offset:2048 lds
  ds_read_b128 v[160:163], v251 offset:0
  ds_read_b128 v[164:167], v251 offset:1024
  ds_read_b128 v[168:171], v251 offset:2048
  ds_read_b128 v[172:175], v251 offset:3072
  ds_read_b128 v[176:179], v251 offset:4096
  ds_read_b128 v[180:183], v251 offset:5120
  ds_read_b128 v[184:187], v251 offset:6144
  ds_read_b128 v[188:191], v251 offset:7168
  s_waitcnt lgkmcnt(0)
  s_waitcnt vmcnt(30)
  s_barrier
  s_add_u32 m0, s67, 0
  s_add_u32 s60, s74, 65536
  s_and_b32 s60, s60, 0x1ffff
  s_add_u32 s60, s60, s64
  s_add_u32 s60, s60, s9
  s_sub_u32 s60, s60, s0
  s_add_u32 s60, s60, 131072
  buffer_load_dwordx4 v2, s[16:19], s60 offen offset:0 nt lds
  buffer_load_dwordx4 v3, s[16:19], s60 offen offset:1024 nt lds
  buffer_load_dwordx4 v4, s[16:19], s60 offen offset:2048 nt lds
  buffer_load_dwordx4 v5, s[16:19], s60 offen offset:3072 nt lds
  s_add_u32 m0, s67, 49152
  s_add_u32 s60, s74, 49152
  s_and_b32 s60, s60, 0x1ffff
  s_add_u32 s60, s60, s64
  s_add_u32 s60, s60, s9
  s_sub_u32 s60, s60, s0
  s_add_u32 s60, s60, 131072
  buffer_load_dwordx4 v6, s[20:23], s60 offen offset:0 nt lds
  buffer_load_dwordx4 v6, s[20:23], s60 offen offset:1024 nt lds
  buffer_load_dwordx4 v6, s[20:23], s60 offen offset:2048 nt lds
  buffer_load_dwordx4 v6, s[20:23], s60 offen offset:3072 nt lds
  s_mul_i32 s62, s58, 6144
  s_lshl_b32 s63, s8, 8
  s_lshl_b32 s61, s58, 4
  s_add_u32 s63, s63, s61
  s_mul_i32 s63, s63, 1152
  s_add_u32 m0, s62, 139264
  s_add_u32 s60, s63, 0
  s_sub_u32 s60, s60, s3
  s_add_u32 s60, s60, 147456
  buffer_load_dwordx4 v246, s[32:35], s60 offen offset:0 lds
  buffer_load_dwordx4 v247, s[32:35], s60 offen offset:1024 lds
  buffer_load_dwordx4 v248, s[32:35], s60 offen offset:2048 lds
  s_add_u32 m0, s62, 142336
  s_add_u32 s60, s63, 9216
  s_sub_u32 s60, s60, s3
  s_add_u32 s60, s60, 147456
  buffer_load_dwordx4 v246, s[32:35], s60 offen offset:0 lds
  buffer_load_dwordx4 v247, s[32:35], s60 offen offset:1024 lds
  buffer_load_dwordx4 v248, s[32:35], s60 offen offset:2048 lds
  s_waitcnt vmcnt(30)
  s_barrier
  s_add_u32 m0, s67, 8192
  s_add_u32 s60, s74, 73728
  s_and_b32 s60, s60, 0x1ffff
  s_add_u32 s60, s60, s64
  s_add_u32 s60, s60, s9
  s_sub_u32 s60, s60, s0
  s_add_u32 s60, s60, 131072
  buffer_load_dwordx4 v2, s[16:19], s60 offen offset:0 nt lds
  buffer_load_dwordx4 v3, s[16:19], s60 offen offset:1024 nt lds
  buffer_load_dwordx4 v4, s[16:19], s60 offen offset:2048 nt lds
  buffer_load_dwordx4 v5, s[16:19], s60 offen offset:3072 nt lds
  s_add_u32 m0, s67, 57344
  s_add_u32 s60, s74, 57344
  s_and_b32 s60, s60, 0x1ffff
  s_add_u32 s60, s60, s64
  s_add_u32 s60, s60, s9
  s_sub_u32 s60, s60, s0
  s_add_u32 s60, s60, 131072
  buffer_load_dwordx4 v6, s[20:23], s60 offen offset:0 nt lds
  buffer_load_dwordx4 v6, s[20:23], s60 offen offset:1024 nt lds
  buffer_load_dwordx4 v6, s[20:23], s60 offen offset:2048 nt lds
  buffer_load_dwordx4 v6, s[20:23], s60 offen offset:3072 nt lds
  s_mul_i32 s62, s58, 6144
  s_lshl_b32 s63, s8, 8
  s_lshl_b32 s61, s58, 4
  s_add_u32 s63, s63, s61
  s_mul_i32 s63, s63, 1152
  s_add_u32 m0, s62, 151552
  s_add_u32 s60, s63, 36864
  s_sub_u32 s60, s60, s3
  s_add_u32 s60, s60, 147456
  buffer_load_dwordx4 v246, s[32:35], s60 offen offset:0 lds
  buffer_load_dwordx4 v247, s[32:35], s60 offen offset:1024 lds
  buffer_load_dwordx4 v248, s[32:35], s60 offen offset:2048 lds
  s_add_u32 m0, s62, 154624
  s_add_u32 s60, s63, 46080
  s_sub_u32 s60, s60, s3
  s_add_u32 s60, s60, 147456
  buffer_load_dwordx4 v246, s[32:35], s60 offen offset:0 lds
  buffer_load_dwordx4 v247, s[32:35], s60 offen offset:1024 lds
  buffer_load_dwordx4 v248, s[32:35], s60 offen offset:2048 lds
  s_waitcnt vmcnt(28)
  s_barrier
  s_add_u32 m0, s67, 16384
  s_add_u32 s60, s74, 81920
  s_and_b32 s60, s60, 0x1ffff
  s_add_u32 s60, s60, s64
  s_add_u32 s60, s60, s9
  s_sub_u32 s60, s60, s0
  s_add_u32 s60, s60, 131072
  buffer_load_dwordx4 v2, s[16:19], s60 offen offset:0 nt lds
  buffer_load_dwordx4 v3, s[16:19], s60 offen offset:1024 nt lds
  buffer_load_dwordx4 v4, s[16:19], s60 offen offset:2048 nt lds
  buffer_load_dwordx4 v5, s[16:19], s60 offen offset:3072 nt lds
  s_add_u32 m0, s67, 32768
  s_add_u32 s60, s74, 65536
  s_and_b32 s60, s60, 0x1ffff
  s_add_u32 s60, s60, s64
  s_add_u32 s60, s60, s9
  s_sub_u32 s60, s60, s0
  s_add_u32 s60, s60, 131072
  buffer_load_dwordx4 v6, s[20:23], s60 offen offset:0 nt lds
  buffer_load_dwordx4 v6, s[20:23], s60 offen offset:1024 nt lds
  buffer_load_dwordx4 v6, s[20:23], s60 offen offset:2048 nt lds
  buffer_load_dwordx4 v6, s[20:23], s60 offen offset:3072 nt lds
  s_mul_i32 s62, s58, 6144
  s_lshl_b32 s63, s8, 8
  s_lshl_b32 s61, s58, 4
  s_add_u32 s63, s63, s61
  s_mul_i32 s63, s63, 1152
  s_add_u32 m0, s62, 90112
  s_add_u32 s60, s63, 73728
  s_sub_u32 s60, s60, s3
  s_add_u32 s60, s60, 147456
  buffer_load_dwordx4 v246, s[32:35], s60 offen offset:0 lds
  buffer_load_dwordx4 v247, s[32:35], s60 offen offset:1024 lds
  buffer_load_dwordx4 v248, s[32:35], s60 offen offset:2048 lds
  s_add_u32 m0, s62, 93184
  s_add_u32 s60, s63, 82944
  s_sub_u32 s60, s60, s3
  s_add_u32 s60, s60, 147456
  buffer_load_dwordx4 v246, s[32:35], s60 offen offset:0 lds
  buffer_load_dwordx4 v247, s[32:35], s60 offen offset:1024 lds
  buffer_load_dwordx4 v248, s[32:35], s60 offen offset:2048 lds
  s_waitcnt vmcnt(28)
  s_barrier
  s_cmp_lg_u32 s51, 6
  s_cbranch_scc1 L_hs3
  s_branch L_hs3_chk
L_hs3_spin:
  global_load_dwordx2 v[252:253], v255, s[46:47] sc1
  s_waitcnt vmcnt(0)
L_hs3_chk:
  v_and_b32 v252, v252, v253
  s_nop 0
  v_readfirstlane_b32 s60, v252
  s_nop 3
  s_cmp_eq_u32 s60, 0x01010101
  s_cbranch_scc1 L_hs3
  s_sleep 8
  s_branch L_hs3_spin
L_hs3:
  s_add_u32 m0, s67, 24576
  s_add_u32 s60, s74, 90112
  s_and_b32 s60, s60, 0x1ffff
  s_add_u32 s60, s60, s64
  s_add_u32 s60, s60, s9
  s_sub_u32 s60, s60, s0
  s_add_u32 s60, s60, 131072
  buffer_load_dwordx4 v2, s[16:19], s60 offen offset:0 nt lds
  buffer_load_dwordx4 v3, s[16:19], s60 offen offset:1024 nt lds
  buffer_load_dwordx4 v4, s[16:19], s60 offen offset:2048 nt lds
  buffer_load_dwordx4 v5, s[16:19], s60 offen offset:3072 nt lds
  s_add_u32 m0, s67, 40960
  s_add_u32 s60, s74, 73728
  s_and_b32 s60, s60, 0x1ffff
  s_add_u32 s60, s60, s64
  s_add_u32 s60, s60, s9
  s_sub_u32 s60, s60, s0
  s_add_u32 s60, s60, 131072
  buffer_load_dwordx4 v6, s[20:23], s60 offen offset:0 nt lds
  buffer_load_dwordx4 v6, s[20:23], s60 offen offset:1024 nt lds
  buffer_load_dwordx4 v6, s[20:23], s60 offen offset:2048 nt lds
  buffer_load_dwordx4 v6, s[20:23], s60 offen offset:3072 nt lds
  s_mul_i32 s62, s58, 6144
  s_lshl_b32 s63, s8, 8
  s_lshl_b32 s61, s58, 4
  s_add_u32 s63, s63, s61
  s_mul_i32 s63, s63, 1152
  s_add_u32 m0, s62, 102400
  s_add_u32 s60, s63, 110592
  s_sub_u32 s60, s60, s3
  s_add_u32 s60, s60, 147456
  buffer_load_dwordx4 v246, s[32:35], s60 offen offset:0 lds
  buffer_load_dwordx4 v247, s[32:35], s60 offen offset:1024 lds
  buffer_load_dwordx4 v248, s[32:35], s60 offen offset:2048 lds
  s_add_u32 m0, s62, 105472
  s_add_u32 s60, s63, 119808
  s_sub_u32 s60, s60, s3
  s_add_u32 s60, s60, 147456
  buffer_load_dwordx4 v246, s[32:35], s60 offen offset:0 lds
  buffer_load_dwordx4 v247, s[32:35], s60 offen offset:1024 lds
  buffer_load_dwordx4 v248, s[32:35], s60 offen offset:2048 lds
  s_waitcnt vmcnt(28)
  s_barrier
  s_add_u32 m0, s67, 0
  s_add_u32 s60, s74, 98304
  s_and_b32 s60, s60, 0x1ffff
  s_add_u32 s60, s60, s64
  s_add_u32 s60, s60, s9
  s_sub_u32 s60, s60, s0
  s_add_u32 s60, s60, 131072
  buffer_load_dwordx4 v2, s[16:19], s60 offen offset:0 nt lds
  buffer_load_dwordx4 v3, s[16:19], s60 offen offset:1024 nt lds
  buffer_load_dwordx4 v4, s[16:19], s60 offen offset:2048 nt lds
  buffer_load_dwordx4 v5, s[16:19], s60 offen offset:3072 nt lds
  s_add_u32 m0, s67, 49152
  s_add_u32 s60, s74, 81920
  s_and_b32 s60, s60, 0x1ffff
  s_add_u32 s60, s60, s64
  s_add_u32 s60, s60, s9
  s_sub_u32 s60, s60, s0
  s_add_u32 s60, s60, 131072
  buffer_load_dwordx4 v6, s[20:23], s60 offen offset:0 nt lds
  buffer_load_dwordx4 v6, s[20:23], s60 offen offset:1024 nt lds
  buffer_load_dwordx4 v6, s[20:23], s60 offen offset:2048 nt lds
  buffer_load_dwordx4 v6, s[20:23], s60 offen offset:3072 nt lds
  s_mul_i32 s62, s58, 6144
  s_lshl_b32 s63, s8, 8
  s_lshl_b32 s61, s58, 4
  s_add_u32 s63, s63, s61
  s_mul_i32 s63, s63, 1152
  s_add_u32 m0, s62, 139264
  s_add_u32 s60, s63, 0
  s_add_u32 s60, s60, s11
  s_add_u32 s60, s60, s3
  buffer_load_dwordx4 v246, s[32:35], s60 offen offset:0 lds
  buffer_load_dwordx4 v247, s[32:35], s60 offen offset:1024 lds
  buffer_load_dwordx4 v248, s[32:35], s60 offen offset:2048 lds
  s_add_u32 m0, s62, 142336
  s_add_u32 s60, s63, 9216
  s_add_u32 s60, s60, s11
  s_add_u32 s60, s60, s3
  buffer_load_dwordx4 v246, s[32:35], s60 offen offset:0 lds
  buffer_load_dwordx4 v247, s[32:35], s60 offen offset:1024 lds
  buffer_load_dwordx4 v248, s[32:35], s60 offen offset:2048 lds
  s_waitcnt vmcnt(28)
  s_barrier
  buffer_load_dword v27, v25, s[32:35], 0 offen offset:768 nt
  buffer_load_dword v27, v25, s[32:35], 0 offen offset:768 sc1
  s_add_u32 m0, s67, 8192
  s_add_u32 s60, s74, 106496
  s_and_b32 s60, s60, 0x1ffff
  s_add_u32 s60, s60, s64
  s_add_u32 s60, s60, s9
  s_sub_u32 s60, s60, s0
  s_add_u32 s60, s60, 131072
  buffer_load_dwordx4 v2, s[16:19], s60 offen offset:0 nt lds
  buffer_load_dwordx4 v3, s[16:19], s60 offen offset:1024 nt lds
  buffer_load_dwordx4 v4, s[16:19], s60 offen offset:2048 nt lds
  buffer_load_dwordx4 v5, s[16:19], s60 offen offset:3072 nt lds
  s_add_u32 m0, s67, 57344
  s_add_u32 s60, s74, 90112
  s_and_b32 s60, s60, 0x1ffff
  s_add_u32 s60, s60, s64
  s_add_u32 s60, s60, s9
  s_sub_u32 s60, s60, s0
  s_add_u32 s60, s60, 131072
  buffer_load_dwordx4 v6, s[20:23], s60 offen offset:0 nt lds
  buffer_load_dwordx4 v6, s[20:23], s60 offen offset:1024 nt lds
  buffer_load_dwordx4 v6, s[20:23], s60 offen offset:2048 nt lds
  buffer_load_dwordx4 v6, s[20:23], s60 offen offset:3072 nt lds
  s_mul_i32 s62, s58, 6144
  s_lshl_b32 s63, s8, 8
  s_lshl_b32 s61, s58, 4
  s_add_u32 s63, s63, s61
  s_mul_i32 s63, s63, 1152
  s_add_u32 m0, s62, 151552
  s_add_u32 s60, s63, 36864
  s_add_u32 s60, s60, s11
  s_add_u32 s60, s60, s3
  buffer_load_dwordx4 v246, s[32:35], s60 offen offset:0 lds
  buffer_load_dwordx4 v247, s[32:35], s60 offen offset:1024 lds
  buffer_load_dwordx4 v248, s[32:35], s60 offen offset:2048 lds
  s_add_u32 m0, s62, 154624
  s_add_u32 s60, s63, 46080
  s_add_u32 s60, s60, s11
  s_add_u32 s60, s60, s3
  buffer_load_dwordx4 v246, s[32:35], s60 offen offset:0 lds
  buffer_load_dwordx4 v247, s[32:35], s60 offen offset:1024 lds
  buffer_load_dwordx4 v248, s[32:35], s60 offen offset:2048 lds
  s_waitcnt vmcnt(30)
  s_barrier
  s_add_u32 m0, s67, 16384
  s_add_u32 s60, s74, 114688
  s_and_b32 s60, s60, 0x1ffff
  s_add_u32 s60, s60, s64
  s_add_u32 s60, s60, s9
  s_sub_u32 s60, s60, s0
  s_add_u32 s60, s60, 131072
  buffer_load_dwordx4 v2, s[16:19], s60 offen offset:0 nt lds
  buffer_load_dwordx4 v3, s[16:19], s60 offen offset:1024 nt lds
  buffer_load_dwordx4 v4, s[16:19], s60 offen offset:2048 nt lds
  buffer_load_dwordx4 v5, s[16:19], s60 offen offset:3072 nt lds
  s_add_u32 m0, s67, 32768
  s_add_u32 s60, s74, 98304
  s_and_b32 s60, s60, 0x1ffff
  s_add_u32 s60, s60, s64
  s_add_u32 s60, s60, s9
  s_sub_u32 s60, s60, s0
  s_add_u32 s60, s60, 131072
  buffer_load_dwordx4 v6, s[20:23], s60 offen offset:0 nt lds
  buffer_load_dwordx4 v6, s[20:23], s60 offen offset:1024 nt lds
  buffer_load_dwordx4 v6, s[20:23], s60 offen offset:2048 nt lds
  buffer_load_dwordx4 v6, s[20:23], s60 offen offset:3072 nt lds
  s_mul_i32 s62, s58, 6144
  s_lshl_b32 s63, s8, 8
  s_lshl_b32 s61, s58, 4
  s_add_u32 s63, s63, s61
  s_mul_i32 s63, s63, 1152
  s_add_u32 m0, s62, 90112
  s_add_u32 s60, s63, 73728
  s_add_u32 s60, s60, s11
  s_add_u32 s60, s60, s3
  buffer_load_dwordx4 v246, s[32:35], s60 offen offset:0 lds
  buffer_load_dwordx4 v247, s[32:35], s60 offen offset:1024 lds
  buffer_load_dwordx4 v248, s[32:35], s60 offen offset:2048 lds
  s_add_u32 m0, s62, 93184
  s_add_u32 s60, s63, 82944
  s_add_u32 s60, s60, s11
  s_add_u32 s60, s60, s3
  buffer_load_dwordx4 v246, s[32:35], s60 offen offset:0 lds
  buffer_load_dwordx4 v247, s[32:35], s60 offen offset:1024 lds
  buffer_load_dwordx4 v248, s[32:35], s60 offen offset:2048 lds
  s_waitcnt vmcnt(30)
  s_barrier
  s_add_u32 m0, s67, 24576
  s_add_u32 s60, s74, 122880
  s_and_b32 s60, s60, 0x1ffff
  s_add_u32 s60, s60, s64
  s_add_u32 s60, s60, s9
  s_sub_u32 s60, s60, s0
  s_add_u32 s60, s60, 131072
  buffer_load_dwordx4 v2, s[16:19], s60 offen offset:0 nt lds
  buffer_load_dwordx4 v3, s[16:19], s60 offen offset:1024 nt lds
  buffer_load_dwordx4 v4, s[16:19], s60 offen offset:2048 nt lds
  buffer_load_dwordx4 v5, s[16:19], s60 offen offset:3072 nt lds
  s_add_u32 m0, s67, 40960
  s_add_u32 s60, s74, 106496
  s_and_b32 s60, s60, 0x1ffff
  s_add_u32 s60, s60, s64
  s_add_u32 s60, s60, s9
  s_sub_u32 s60, s60, s0
  s_add_u32 s60, s60, 131072
  buffer_load_dwordx4 v6, s[20:23], s60 offen offset:0 nt lds
  buffer_load_dwordx4 v6, s[20:23], s60 offen offset:1024 nt lds
  buffer_load_dwordx4 v6, s[20:23], s60 offen offset:2048 nt lds
  buffer_load_dwordx4 v6, s[20:23], s60 offen offset:3072 nt lds
  s_mul_i32 s62, s58, 6144
  s_lshl_b32 s63, s8, 8
  s_lshl_b32 s61, s58, 4
  s_add_u32 s63, s63, s61
  s_mul_i32 s63, s63, 1152
  s_add_u32 m0, s62, 102400
  s_add_u32 s60, s63, 110592
  s_add_u32 s60, s60, s11
  s_add_u32 s60, s60, s3
  buffer_load_dwordx4 v246, s[32:35], s60 offen offset:0 lds
  buffer_load_dwordx4 v247, s[32:35], s60 offen offset:1024 lds
  buffer_load_dwordx4 v248, s[32:35], s60 offen offset:2048 lds
  s_add_u32 m0, s62, 105472
  s_add_u32 s60, s63, 119808
  s_add_u32 s60, s60, s11
  s_add_u32 s60, s60, s3
  buffer_load_dwordx4 v246, s[32:35], s60 offen offset:0 lds
  buffer_load_dwordx4 v247, s[32:35], s60 offen offset:1024 lds
  buffer_load_dwordx4 v248, s[32:35], s60 offen offset:2048 lds
  s_waitcnt vmcnt(28)
  s_barrier
  s_add_u32 m0, s67, 49152
  s_add_u32 s60, s74, 114688
  s_and_b32 s60, s60, 0x1ffff
  s_add_u32 s60, s60, s64
  s_add_u32 s60, s60, s9
  s_sub_u32 s60, s60, s0
  s_add_u32 s60, s60, 131072
  buffer_load_dwordx4 v6, s[20:23], s60 offen offset:0 nt lds
  buffer_load_dwordx4 v6, s[20:23], s60 offen offset:1024 nt lds
  buffer_load_dwordx4 v6, s[20:23], s60 offen offset:2048 nt lds
  buffer_load_dwordx4 v6, s[20:23], s60 offen offset:3072 nt lds
  s_waitcnt vmcnt(18)
  s_barrier
  s_add_u32 m0, s67, 57344
  s_add_u32 s60, s74, 122880
  s_and_b32 s60, s60, 0x1ffff
  s_add_u32 s60, s60, s64
  s_add_u32 s60, s60, s9
  s_sub_u32 s60, s60, s0
  s_add_u32 s60, s60, 131072
  buffer_load_dwordx4 v6, s[20:23], s60 offen offset:0 nt lds
  buffer_load_dwordx4 v6, s[20:23], s60 offen offset:1024 nt lds
  buffer_load_dwordx4 v6, s[20:23], s60 offen offset:2048 nt lds
  buffer_load_dwordx4 v6, s[20:23], s60 offen offset:3072 nt lds
  s_waitcnt vmcnt(8)
  s_barrier
  s_waitcnt vmcnt(4)
  s_barrier
  s_mul_i32 s62, s58, 12288
  s_lshl_b32 s63, s8, 8
  s_lshl_b32 s61, s58, 5
  s_add_u32 s63, s63, s61
  s_mul_i32 s63, s63, 1152
  s_add_u32 m0, s62, 0
  s_add_u32 s60, s63, 0
  s_add_u32 s60, s60, s11
  s_sub_u32 s60, s60, s3
  s_add_u32 s60, s60, 147456
  buffer_load_dwordx4 v246, s[32:35], s60 offen offset:0 lds
  buffer_load_dwordx4 v247, s[32:35], s60 offen offset:1024 lds
  buffer_load_dwordx4 v248, s[32:35], s60 offen offset:2048 lds
  s_add_u32 m0, s62, 3072
  s_add_u32 s60, s63, 9216
  s_add_u32 s60, s60, s11
  s_sub_u32 s60, s60, s3
  s_add_u32 s60, s60, 147456
  buffer_load_dwordx4 v246, s[32:35], s60 offen offset:0 lds
  buffer_load_dwordx4 v247, s[32:35], s60 offen offset:1024 lds
  buffer_load_dwordx4 v248, s[32:35], s60 offen offset:2048 lds
  s_add_u32 m0, s62, 6144
  s_add_u32 s60, s63, 18432
  s_add_u32 s60, s60, s11
  s_sub_u32 s60, s60, s3
  s_add_u32 s60, s60, 147456
  buffer_load_dwordx4 v246, s[32:35], s60 offen offset:0 lds
  buffer_load_dwordx4 v247, s[32:35], s60 offen offset:1024 lds
  buffer_load_dwordx4 v248, s[32:35], s60 offen offset:2048 lds
  s_add_u32 m0, s62, 9216
  s_add_u32 s60, s63, 27648
  s_add_u32 s60, s60, s11
  s_sub_u32 s60, s60, s3
  s_add_u32 s60, s60, 147456
  buffer_load_dwordx4 v246, s[32:35], s60 offen offset:0 lds
  buffer_load_dwordx4 v247, s[32:35], s60 offen offset:1024 lds
  buffer_load_dwordx4 v248, s[32:35], s60 offen offset:2048 lds
  s_mul_i32 s62, s58, 12288
  s_lshl_b32 s63, s8, 8
  s_lshl_b32 s61, s58, 5
  s_add_u32 s63, s63, s61
  s_mul_i32 s63, s63, 1152
  s_add_u32 m0, s62, 24576
  s_add_u32 s60, s63, 73728
  s_add_u32 s60, s60, s11
  s_sub_u32 s60, s60, s3
  s_add_u32 s60, s60, 147456
  buffer_load_dwordx4 v246, s[32:35], s60 offen offset:0 lds
  buffer_load_dwordx4 v247, s[32:35], s60 offen offset:1024 lds
  buffer_load_dwordx4 v248, s[32:35], s60 offen offset:2048 lds
  s_add_u32 m0, s62, 27648
  s_add_u32 s60, s63, 82944
  s_add_u32 s60, s60, s11
  s_sub_u32 s60, s60, s3
  s_add_u32 s60, s60, 147456
  buffer_load_dwordx4 v246, s[32:35], s60 offen offset:0 lds
  buffer_load_dwordx4 v247, s[32:35], s60 offen offset:1024 lds
  buffer_load_dwordx4 v248, s[32:35], s60 offen offset:2048 lds
  s_add_u32 m0, s62, 30720
  s_add_u32 s60, s63, 92160
  s_add_u32 s60, s60, s11
  s_sub_u32 s60, s60, s3
  s_add_u32 s60, s60, 147456
  buffer_load_dwordx4 v246, s[32:35], s60 offen offset:0 lds
  buffer_load_dwordx4 v247, s[32:35], s60 offen offset:1024 lds
  buffer_load_dwordx4 v248, s[32:35], s60 offen offset:2048 lds
  s_add_u32 m0, s62, 33792
  s_add_u32 s60, s63, 101376
  s_add_u32 s60, s60, s11
  s_sub_u32 s60, s60, s3
  s_add_u32 s60, s60, 147456
  buffer_load_dwordx4 v246, s[32:35], s60 offen offset:0 lds
  buffer_load_dwordx4 v247, s[32:35], s60 offen offset:1024 lds
  buffer_load_dwordx4 v248, s[32:35], s60 offen offset:2048 lds
  s_waitcnt vmcnt(24)
  s_barrier
  s_waitcnt vmcnt(0)
  s_barrier
L_nonx:
  s_setprio 0
  s_add_u32 m0, s70, 49152
  s_add_u32 s60, s69, 384
  s_add_u32 s60, s60, s3
  buffer_load_dwordx4 v246, s[32:35], s60 offen offset:0 lds
  buffer_load_dwordx4 v247, s[32:35], s60 offen offset:1024 lds
  buffer_load_dwordx4 v248, s[32:35], s60 offen offset:2048 lds
  s_add_u32 m0, s70, 73728
  s_add_u32 s60, s69, 74112
  s_add_u32 s60, s60, s3
  buffer_load_dwordx4 v246, s[32:35], s60 offen offset:0 lds
  buffer_load_dwordx4 v247, s[32:35], s60 offen offset:1024 lds
  buffer_load_dwordx4 v248, s[32:35], s60 offen offset:2048 lds
  s_barrier
  ds_read_b128 v[32:35], v251 offset:24576
  ds_read_b128 v[36:39], v251 offset:25600
  ds_read_b128 v[40:43], v251 offset:26624
  ds_read_b128 v[44:47], v251 offset:27648
  ds_read_b128 v[48:51], v251 offset:28672
  ds_read_b128 v[52:55], v251 offset:29696
  ds_read_b128 v[56:59], v251 offset:30720
  ds_read_b128 v[60:63], v251 offset:31744
  s_waitcnt lgkmcnt(0)
  s_waitcnt vmcnt(3)
  s_barrier
  s_add_u32 m0, s70, 0
  s_add_u32 s60, s69, 384
  s_sub_u32 s60, s60, s3
  s_add_u32 s60, s60, 147456
  buffer_load_dwordx4 v246, s[32:35], s60 offen offset:0 lds
  buffer_load_dwordx4 v247, s[32:35], s60 offen offset:1024 lds
  buffer_load_dwordx4 v248, s[32:35], s60 offen offset:2048 lds
  s_waitcnt vmcnt(3)
L_op:
  s_cmp_eq_u32 s58, 2
  s_cbranch_scc1 L_op3
L_op2:
  s_barrier
  ds_read_b64_tr_b16 v[112:113], v243 offset:0
  ds_read_b64_tr_b16 v[114:115], v243 offset:3072
  ds_read_b64_tr_b16 v[116:117], v244 offset:0
  ds_read_b64_tr_b16 v[118:119], v244 offset:3072
  ds_read_b64_tr_b16 v[120:121], v243 offset:6144
  ds_read_b64_tr_b16 v[122:123], v243 offset:9216
  ds_read_b64_tr_b16 v[124:125], v244 offset:6144
  ds_read_b64_tr_b16 v[126:127], v244 offset:9216
  ds_read_b64_tr_b16 v[192:193], v243 offset:12288
  ds_read_b64_tr_b16 v[194:195], v243 offset:15360
  ds_read_b64_tr_b16 v[196:197], v244 offset:12288
  ds_read_b64_tr_b16 v[198:199], v244 offset:15360
  s_waitcnt lgkmcnt(10)
  v_mfma_f32_32x32x16_bf16 v[64:79], v[112:115], v[128:131], 0
  ds_read_b64_tr_b16 v[112:113], v243 offset:18432
  ds_read_b64_tr_b16 v[114:115], v243 offset:21504
  s_waitcnt lgkmcnt(10)
  v_mfma_f32_32x32x16_bf16 v[80:95], v[116:119], v[128:131], 0
  ds_read_b64_tr_b16 v[116:117], v244 offset:18432
  ds_read_b64_tr_b16 v[118:119], v244 offset:21504
  s_add_u32 m0, s70, 24576
  s_add_u32 s60, s69, 74112
  s_sub_u32 s60, s60, s3
  s_add_u32 s60, s60, 147456
  buffer_load_dwordx4 v246, s[32:35], s60 offen offset:0 lds
  buffer_load_dwordx4 v247, s[32:35], s60 offen offset:1024 lds
  buffer_load_dwordx4 v248, s[32:35], s60 offen offset:2048 lds
  s_waitcnt lgkmcnt(10)
  v_mfma_f32_32x32x16_bf16 v[64:79], v[120:123], v[132:135], v[64:79]
  ds_read_b64_tr_b16 v[120:121], v243 offset:24576
  ds_read_b64_tr_b16 v[122:123], v243 offset:27648
  s_waitcnt lgkmcnt(10)
  v_mfma_f32_32x32x16_bf16 v[80:95], v[124:127], v[132:135], v[80:95]
  ds_read_b64_tr_b16 v[124:125], v244 offset:24576
  ds_read_b64_tr_b16 v[126:127], v244 offset:27648
  s_waitcnt lgkmcnt(10)
  v_mfma_f32_32x32x16_bf16 v[64:79], v[192:195], v[136:139], v[64:79]
  ds_read_b64_tr_b16 v[192:193], v243 offset:30720
  ds_read_b64_tr_b16 v[194:195], v243 offset:33792
  s_waitcnt lgkmcnt(10)
  v_mfma_f32_32x32x16_bf16 v[80:95], v[196:199], v[136:139], v[80:95]
  ds_read_b64_tr_b16 v[196:197], v244 offset:30720
  ds_read_b64_tr_b16 v[198:199], v244 offset:33792
  s_waitcnt lgkmcnt(10)
  v_mfma_f32_32x32x16_bf16 v[64:79], v[112:115], v[140:143], v[64:79]
  ds_read_b64_tr_b16 v[112:113], v243 offset:36864
  ds_read_b64_tr_b16 v[114:115], v243 offset:39936
  s_waitcnt lgkmcnt(10)
  v_mfma_f32_32x32x16_bf16 v[80:95], v[116:119], v[140:143], v[80:95]
  ds_read_b64_tr_b16 v[116:117], v244 offset:36864
  ds_read_b64_tr_b16 v[118:119], v244 offset:39936
  s_waitcnt vmcnt(3)
  s_barrier
  s_waitcnt lgkmcnt(10)
  v_mfma_f32_32x32x16_bf16 v[64:79], v[120:123], v[144:147], v[64:79]
  ds_read_b64_tr_b16 v[120:121], v243 offset:43008
  ds_read_b64_tr_b16 v[122:123], v243 offset:46080
  s_waitcnt lgkmcnt(10)
  v_mfma_f32_32x32x16_bf16 v[80:95], v[124:127], v[144:147], v[80:95]
  ds_read_b64_tr_b16 v[124:125], v244 offset:43008
  ds_read_b64_tr_b16 v[126:127], v244 offset:46080
  s_add_u32 m0, s70, 49152
  s_add_u32 s60, s69, 384
  s_add_u32 s60, s60, s11
  s_add_u32 s60, s60, s3
  buffer_load_dwordx4 v246, s[32:35], s60 offen offset:0 lds
  buffer_load_dwordx4 v247, s[32:35], s60 offen offset:1024 lds
  buffer_load_dwordx4 v248, s[32:35], s60 offen offset:2048 lds
  s_waitcnt lgkmcnt(10)
  v_mfma_f32_32x32x16_bf16 v[64:79], v[192:195], v[148:151], v[64:79]
  ds_read_b64_tr_b16 v[192:193], v240 offset:0
  ds_read_b64_tr_b16 v[194:195], v240 offset:3072
  s_waitcnt lgkmcnt(10)
  v_mfma_f32_32x32x16_bf16 v[80:95], v[196:199], v[148:151], v[80:95]
  ds_read_b64_tr_b16 v[196:197], v241 offset:0
  ds_read_b64_tr_b16 v[198:199], v241 offset:3072
  s_waitcnt lgkmcnt(10)
  v_mfma_f32_32x32x16_bf16 v[64:79], v[112:115], v[152:155], v[64:79]
  ds_read_b64_tr_b16 v[112:113], v240 offset:6144
  ds_read_b64_tr_b16 v[114:115], v240 offset:9216
  s_waitcnt lgkmcnt(10)
  v_mfma_f32_32x32x16_bf16 v[80:95], v[116:119], v[152:155], v[80:95]
  ds_read_b64_tr_b16 v[116:117], v241 offset:6144
  ds_read_b64_tr_b16 v[118:119], v241 offset:9216
  s_waitcnt lgkmcnt(10)
  v_mfma_f32_32x32x16_bf16 v[64:79], v[120:123], v[156:159], v[64:79]
  ds_read_b64_tr_b16 v[120:121], v240 offset:12288
  ds_read_b64_tr_b16 v[122:123], v240 offset:15360
  s_waitcnt lgkmcnt(10)
  v_mfma_f32_32x32x16_bf16 v[80:95], v[124:127], v[156:159], v[80:95]
  ds_read_b64_tr_b16 v[124:125], v241 offset:12288
  ds_read_b64_tr_b16 v[126:127], v241 offset:15360
  s_waitcnt vmcnt(3)
  s_barrier
  s_waitcnt lgkmcnt(10)
  v_mfma_f32_32x32x16_bf16 v[64:79], v[192:195], v[208:211], v[64:79]
  ds_read_b64_tr_b16 v[192:193], v240 offset:18432
  ds_read_b64_tr_b16 v[194:195], v240 offset:21504
  s_waitcnt lgkmcnt(10)
  v_mfma_f32_32x32x16_bf16 v[80:95], v[196:199], v[208:211], v[80:95]
  ds_read_b64_tr_b16 v[196:197], v241 offset:18432
  ds_read_b64_tr_b16 v[198:199], v241 offset:21504
  s_add_u32 m0, s70, 73728
  s_add_u32 s60, s69, 74112
  s_add_u32 s60, s60, s11
  s_add_u32 s60, s60, s3
  buffer_load_dwordx4 v246, s[32:35], s60 offen offset:0 lds
  buffer_load_dwordx4 v247, s[32:35], s60 offen offset:1024 lds
  buffer_load_dwordx4 v248, s[32:35], s60 offen offset:2048 lds
  s_waitcnt lgkmcnt(10)
  v_mfma_f32_32x32x16_bf16 v[64:79], v[112:115], v[212:215], v[64:79]
  ds_read_b64_tr_b16 v[112:113], v240 offset:24576
  ds_read_b64_tr_b16 v[114:115], v240 offset:27648
  s_waitcnt lgkmcnt(10)
  v_mfma_f32_32x32x16_bf16 v[80:95], v[116:119], v[212:215], v[80:95]
  ds_read_b64_tr_b16 v[116:117], v241 offset:24576
  ds_read_b64_tr_b16 v[118:119], v241 offset:27648
  s_waitcnt lgkmcnt(10)
  v_mfma_f32_32x32x16_bf16 v[64:79], v[120:123], v[216:219], v[64:79]
  ds_read_b64_tr_b16 v[120:121], v240 offset:30720
  ds_read_b64_tr_b16 v[122:123], v240 offset:33792
  s_waitcnt lgkmcnt(10)
  v_mfma_f32_32x32x16_bf16 v[80:95], v[124:127], v[216:219], v[80:95]
  ds_read_b64_tr_b16 v[124:125], v241 offset:30720
  ds_read_b64_tr_b16 v[126:127], v241 offset:33792
  s_waitcnt lgkmcnt(10)
  v_mfma_f32_32x32x16_bf16 v[64:79], v[192:195], v[220:223], v[64:79]
  ds_read_b64_tr_b16 v[192:193], v240 offset:36864
  ds_read_b64_tr_b16 v[194:195], v240 offset:39936
  s_waitcnt lgkmcnt(10)
  v_mfma_f32_32x32x16_bf16 v[80:95], v[196:199], v[220:223], v[80:95]
  ds_read_b64_tr_b16 v[196:197], v241 offset:36864
  ds_read_b64_tr_b16 v[198:199], v241 offset:39936
  s_waitcnt vmcnt(3)
  s_barrier
  s_waitcnt lgkmcnt(10)
  v_mfma_f32_32x32x16_bf16 v[64:79], v[112:115], v[224:227], v[64:79]
  ds_read_b64_tr_b16 v[112:113], v240 offset:43008
  ds_read_b64_tr_b16 v[114:115], v240 offset:46080
  s_waitcnt lgkmcnt(10)
  v_mfma_f32_32x32x16_bf16 v[80:95], v[116:119], v[224:227], v[80:95]
  ds_read_b64_tr_b16 v[116:117], v241 offset:43008
  ds_read_b64_tr_b16 v[118:119], v241 offset:46080
  s_add_u32 m0, s70, 0
  s_add_u32 s60, s69, 384
  s_add_u32 s60, s60, s11
  s_sub_u32 s60, s60, s3
  s_add_u32 s60, s60, 147456
  buffer_load_dwordx4 v246, s[32:35], s60 offen offset:0 lds
  buffer_load_dwordx4 v247, s[32:35], s60 offen offset:1024 lds
  buffer_load_dwordx4 v248, s[32:35], s60 offen offset:2048 lds
  s_waitcnt lgkmcnt(10)
  v_mfma_f32_32x32x16_bf16 v[64:79], v[120:123], v[228:231], v[64:79]
  ds_read_b64_tr_b16 v[120:121], v243 offset:0
  ds_read_b64_tr_b16 v[122:123], v243 offset:3072
  s_waitcnt lgkmcnt(10)
  v_mfma_f32_32x32x16_bf16 v[80:95], v[124:127], v[228:231], v[80:95]
  ds_read_b64_tr_b16 v[124:125], v244 offset:0
  ds_read_b64_tr_b16 v[126:127], v244 offset:3072
  s_waitcnt lgkmcnt(10)
  v_mfma_f32_32x32x16_bf16 v[64:79], v[192:195], v[232:235], v[64:79]
  ds_read_b64_tr_b16 v[192:193], v243 offset:6144
  ds_read_b64_tr_b16 v[194:195], v243 offset:9216
  s_waitcnt lgkmcnt(10)
  v_mfma_f32_32x32x16_bf16 v[80:95], v[196:199], v[232:235], v[80:95]
  ds_read_b64_tr_b16 v[196:197], v244 offset:6144
  ds_read_b64_tr_b16 v[198:199], v244 offset:9216
  s_waitcnt lgkmcnt(10)
  v_mfma_f32_32x32x16_bf16 v[64:79], v[112:115], v[236:239], v[64:79]
  ds_read_b64_tr_b16 v[112:113], v243 offset:12288
  ds_read_b64_tr_b16 v[114:115], v243 offset:15360
  s_waitcnt lgkmcnt(10)
  v_mfma_f32_32x32x16_bf16 v[80:95], v[116:119], v[236:239], v[80:95]
  ds_read_b64_tr_b16 v[116:117], v244 offset:12288
  ds_read_b64_tr_b16 v[118:119], v244 offset:15360
  s_waitcnt vmcnt(3)
  s_barrier
  s_waitcnt lgkmcnt(10)
  v_mfma_f32_32x32x16_bf16 v[64:79], v[120:123], v[160:163], v[64:79]
  ds_read_b64_tr_b16 v[120:121], v243 offset:18432
  ds_read_b64_tr_b16 v[122:123], v243 offset:21504
  s_waitcnt lgkmcnt(10)
  v_mfma_f32_32x32x16_bf16 v[80:95], v[124:127], v[160:163], v[80:95]
  ds_read_b64_tr_b16 v[124:125], v244 offset:18432
  ds_read_b64_tr_b16 v[126:127], v244 offset:21504
  s_add_u32 m0, s70, 24576
  s_add_u32 s60, s69, 74112
  s_add_u32 s60, s60, s11
  s_sub_u32 s60, s60, s3
  s_add_u32 s60, s60, 147456
  buffer_load_dwordx4 v246, s[32:35], s60 offen offset:0 lds
  buffer_load_dwordx4 v247, s[32:35], s60 offen offset:1024 lds
  buffer_load_dwordx4 v248, s[32:35], s60 offen offset:2048 lds
  s_waitcnt lgkmcnt(10)
  v_mfma_f32_32x32x16_bf16 v[64:79], v[192:195], v[164:167], v[64:79]
  ds_read_b64_tr_b16 v[192:193], v243 offset:24576
  ds_read_b64_tr_b16 v[194:195], v243 offset:27648
  s_waitcnt lgkmcnt(10)
  v_mfma_f32_32x32x16_bf16 v[80:95], v[196:199], v[164:167], v[80:95]
  ds_read_b64_tr_b16 v[196:197], v244 offset:24576
  ds_read_b64_tr_b16 v[198:199], v244 offset:27648
  s_waitcnt lgkmcnt(10)
  v_mfma_f32_32x32x16_bf16 v[64:79], v[112:115], v[168:171], v[64:79]
  ds_read_b64_tr_b16 v[112:113], v243 offset:30720
  ds_read_b64_tr_b16 v[114:115], v243 offset:33792
  s_waitcnt lgkmcnt(10)
  v_mfma_f32_32x32x16_bf16 v[80:95], v[116:119], v[168:171], v[80:95]
  ds_read_b64_tr_b16 v[116:117], v244 offset:30720
  ds_read_b64_tr_b16 v[118:119], v244 offset:33792
  s_waitcnt lgkmcnt(10)
  v_mfma_f32_32x32x16_bf16 v[64:79], v[120:123], v[172:175], v[64:79]
  ds_read_b64_tr_b16 v[120:121], v243 offset:36864
  ds_read_b64_tr_b16 v[122:123], v243 offset:39936
  s_waitcnt lgkmcnt(10)
  v_mfma_f32_32x32x16_bf16 v[80:95], v[124:127], v[172:175], v[80:95]
  ds_read_b64_tr_b16 v[124:125], v244 offset:36864
  ds_read_b64_tr_b16 v[126:127], v244 offset:39936
  s_waitcnt vmcnt(3)
  s_barrier
  s_waitcnt lgkmcnt(10)
  v_mfma_f32_32x32x16_bf16 v[64:79], v[192:195], v[176:179], v[64:79]
  ds_read_b64_tr_b16 v[192:193], v243 offset:43008
  ds_read_b64_tr_b16 v[194:195], v243 offset:46080
  s_waitcnt lgkmcnt(10)
  v_mfma_f32_32x32x16_bf16 v[80:95], v[196:199], v[176:179], v[80:95]
  ds_read_b64_tr_b16 v[196:197], v244 offset:43008
  ds_read_b64_tr_b16 v[198:199], v244 offset:46080
  s_add_u32 m0, s70, 49152
  s_add_u32 s60, s69, 768
  s_add_u32 s60, s60, s3
  buffer_load_dwordx4 v246, s[32:35], s60 offen offset:0 lds
  buffer_load_dwordx4 v247, s[32:35], s60 offen offset:1024 lds
  buffer_load_dwordx4 v248, s[32:35], s60 offen offset:2048 lds
  s_waitcnt lgkmcnt(10)
  v_mfma_f32_32x32x16_bf16 v[64:79], v[112:115], v[180:183], v[64:79]
  ds_read_b64_tr_b16 v[112:113], v240 offset:0
  ds_read_b64_tr_b16 v[114:115], v240 offset:3072
  s_waitcnt lgkmcnt(10)
  v_mfma_f32_32x32x16_bf16 v[80:95], v[116:119], v[180:183], v[80:95]
  ds_read_b64_tr_b16 v[116:117], v241 offset:0
  ds_read_b64_tr_b16 v[118:119], v241 offset:3072
  s_waitcnt lgkmcnt(10)
  v_mfma_f32_32x32x16_bf16 v[64:79], v[120:123], v[184:187], v[64:79]
  ds_read_b64_tr_b16 v[120:121], v240 offset:6144
  ds_read_b64_tr_b16 v[122:123], v240 offset:9216
  s_waitcnt lgkmcnt(10)
  v_mfma_f32_32x32x16_bf16 v[80:95], v[124:127], v[184:187], v[80:95]
  ds_read_b64_tr_b16 v[124:125], v241 offset:6144
  ds_read_b64_tr_b16 v[126:127], v241 offset:9216
  s_waitcnt lgkmcnt(10)
  v_mfma_f32_32x32x16_bf16 v[64:79], v[192:195], v[188:191], v[64:79]
  ds_read_b64_tr_b16 v[192:193], v240 offset:12288
  ds_read_b64_tr_b16 v[194:195], v240 offset:15360
  s_waitcnt lgkmcnt(10)
  v_mfma_f32_32x32x16_bf16 v[80:95], v[196:199], v[188:191], v[80:95]
  ds_read_b64_tr_b16 v[196:197], v241 offset:12288
  ds_read_b64_tr_b16 v[198:199], v241 offset:15360
  s_waitcnt vmcnt(3)
  s_barrier
  s_waitcnt lgkmcnt(10)
  v_mfma_f32_32x32x16_bf16 v[64:79], v[112:115], v[32:35], v[64:79]
  ds_read_b64_tr_b16 v[112:113], v240 offset:18432
  ds_read_b64_tr_b16 v[114:115], v240 offset:21504
  s_waitcnt lgkmcnt(10)
  v_mfma_f32_32x32x16_bf16 v[80:95], v[116:119], v[32:35], v[80:95]
  ds_read_b64_tr_b16 v[116:117], v241 offset:18432
  ds_read_b64_tr_b16 v[118:119], v241 offset:21504
  s_add_u32 m0, s70, 73728
  s_add_u32 s60, s69, 74496
  s_add_u32 s60, s60, s3
  buffer_load_dwordx4 v246, s[32:35], s60 offen offset:0 lds
  buffer_load_dwordx4 v247, s[32:35], s60 offen offset:1024 lds
  buffer_load_dwordx4 v248, s[32:35], s60 offen offset:2048 lds
  s_waitcnt lgkmcnt(10)
  v_mfma_f32_32x32x16_bf16 v[64:79], v[120:123], v[36:39], v[64:79]
  ds_read_b64_tr_b16 v[120:121], v240 offset:24576
  ds_read_b64_tr_b16 v[122:123], v240 offset:27648
  s_waitcnt lgkmcnt(10)
  v_mfma_f32_32x32x16_bf16 v[80:95], v[124:127], v[36:39], v[80:95]
  ds_read_b64_tr_b16 v[124:125], v241 offset:24576
  ds_read_b64_tr_b16 v[126:127], v241 offset:27648
  s_waitcnt lgkmcnt(10)
  v_mfma_f32_32x32x16_bf16 v[64:79], v[192:195], v[40:43], v[64:79]
  ds_read_b64_tr_b16 v[192:193], v240 offset:30720
  ds_read_b64_tr_b16 v[194:195], v240 offset:33792
  s_waitcnt lgkmcnt(10)
  v_mfma_f32_32x32x16_bf16 v[80:95], v[196:199], v[40:43], v[80:95]
  ds_read_b64_tr_b16 v[196:197], v241 offset:30720
  ds_read_b64_tr_b16 v[198:199], v241 offset:33792
  s_waitcnt lgkmcnt(10)
  v_mfma_f32_32x32x16_bf16 v[64:79], v[112:115], v[44:47], v[64:79]
  ds_read_b64_tr_b16 v[112:113], v240 offset:36864
  ds_read_b64_tr_b16 v[114:115], v240 offset:39936
  s_waitcnt lgkmcnt(10)
  v_mfma_f32_32x32x16_bf16 v[80:95], v[116:119], v[44:47], v[80:95]
  ds_read_b64_tr_b16 v[116:117], v241 offset:36864
  ds_read_b64_tr_b16 v[118:119], v241 offset:39936
  s_waitcnt vmcnt(3)
  s_barrier
  s_waitcnt lgkmcnt(10)
  v_mfma_f32_32x32x16_bf16 v[64:79], v[120:123], v[48:51], v[64:79]
  ds_read_b64_tr_b16 v[120:121], v240 offset:43008
  ds_read_b64_tr_b16 v[122:123], v240 offset:46080
  s_waitcnt lgkmcnt(10)
  v_mfma_f32_32x32x16_bf16 v[80:95], v[124:127], v[48:51], v[80:95]
  ds_read_b64_tr_b16 v[124:125], v241 offset:43008
  ds_read_b64_tr_b16 v[126:127], v241 offset:46080
  s_add_u32 m0, s70, 0
  s_add_u32 s60, s69, 768
  s_sub_u32 s60, s60, s3
  s_add_u32 s60, s60, 147456
  buffer_load_dwordx4 v246, s[32:35], s60 offen offset:0 lds
  buffer_load_dwordx4 v247, s[32:35], s60 offen offset:1024 lds
  buffer_load_dwordx4 v248, s[32:35], s60 offen offset:2048 lds
  s_waitcnt lgkmcnt(10)
  v_mfma_f32_32x32x16_bf16 v[64:79], v[192:195], v[52:55], v[64:79]
  ds_read_b64_tr_b16 v[192:193], v243 offset:0
  ds_read_b64_tr_b16 v[194:195], v243 offset:3072
  s_waitcnt lgkmcnt(10)
  v_mfma_f32_32x32x16_bf16 v[80:95], v[196:199], v[52:55], v[80:95]
  ds_read_b64_tr_b16 v[196:197], v244 offset:0
  ds_read_b64_tr_b16 v[198:199], v244 offset:3072
  s_waitcnt lgkmcnt(10)
  v_mfma_f32_32x32x16_bf16 v[64:79], v[112:115], v[56:59], v[64:79]
  ds_read_b64_tr_b16 v[112:113], v243 offset:6144
  ds_read_b64_tr_b16 v[114:115], v243 offset:9216
  s_waitcnt lgkmcnt(10)
  v_mfma_f32_32x32x16_bf16 v[80:95], v[116:119], v[56:59], v[80:95]
  ds_read_b64_tr_b16 v[116:117], v244 offset:6144
  ds_read_b64_tr_b16 v[118:119], v244 offset:9216
  s_waitcnt lgkmcnt(10)
  v_mfma_f32_32x32x16_bf16 v[64:79], v[120:123], v[60:63], v[64:79]
  ds_read_b64_tr_b16 v[120:121], v243 offset:12288
  ds_read_b64_tr_b16 v[122:123], v243 offset:15360
  s_waitcnt lgkmcnt(10)
  v_mfma_f32_32x32x16_bf16 v[80:95], v[124:127], v[60:63], v[80:95]
  ds_read_b64_tr_b16 v[124:125], v244 offset:12288
  ds_read_b64_tr_b16 v[126:127], v244 offset:15360
  s_nop 15
  s_nop 3
  v_cvt_pk_bf16_f32 v12, v64, v65
  v_cvt_pk_bf16_f32 v13, v66, v67
  v_cvt_pk_bf16_f32 v14, v68, v69
  v_cvt_pk_bf16_f32 v15, v70, v71
  v_cvt_pk_bf16_f32 v16, v72, v73
  v_cvt_pk_bf16_f32 v17, v74, v75
  v_cvt_pk_bf16_f32 v18, v76, v77
  v_cvt_pk_bf16_f32 v19, v78, v79
  s_add_u32 s60, s71, 36864
  buffer_store_dwordx4 v[12:15], v249, s[36:39], s60 offen offset:0 sc1
  buffer_store_dwordx4 v[16:19], v249, s[36:39], s60 offen offset:1024 sc1
  v_cvt_pk_bf16_f32 v20, v80, v81
  v_cvt_pk_bf16_f32 v21, v82, v83
  v_cvt_pk_bf16_f32 v22, v84, v85
  v_cvt_pk_bf16_f32 v23, v86, v87
  v_cvt_pk_bf16_f32 v24, v88, v89
  v_cvt_pk_bf16_f32 v25, v90, v91
  v_cvt_pk_bf16_f32 v26, v92, v93
  v_cvt_pk_bf16_f32 v27, v94, v95
  s_add_u32 s60, s71, 43008
  buffer_store_dwordx4 v[20:23], v249, s[36:39], s60 offen offset:0 sc1
  buffer_store_dwordx4 v[24:27], v249, s[36:39], s60 offen offset:1024 sc1
  s_waitcnt vmcnt(7)
  s_barrier
  s_waitcnt lgkmcnt(10)
  v_mfma_f32_32x32x16_bf16 v[64:79], v[192:195], v[128:131], 0
  ds_read_b64_tr_b16 v[192:193], v243 offset:18432
  ds_read_b64_tr_b16 v[194:195], v243 offset:21504
  s_waitcnt lgkmcnt(10)
  v_mfma_f32_32x32x16_bf16 v[80:95], v[196:199], v[128:131], 0
  ds_read_b64_tr_b16 v[196:197], v244 offset:18432
  ds_read_b64_tr_b16 v[198:199], v244 offset:21504
  s_add_u32 m0, s70, 24576
  s_add_u32 s60, s69, 74496
  s_sub_u32 s60, s60, s3
  s_add_u32 s60, s60, 147456
  buffer_load_dwordx4 v246, s[32:35], s60 offen offset:0 lds
  buffer_load_dwordx4 v247, s[32:35], s60 offen offset:1024 lds
  buffer_load_dwordx4 v248, s[32:35], s60 offen offset:2048 lds
  s_waitcnt lgkmcnt(10)
  v_mfma_f32_32x32x16_bf16 v[64:79], v[112:115], v[132:135], v[64:79]
  ds_read_b64_tr_b16 v[112:113], v243 offset:24576
  ds_read_b64_tr_b16 v[114:115], v243 offset:27648
  s_waitcnt lgkmcnt(10)
  v_mfma_f32_32x32x16_bf16 v[80:95], v[116:119], v[132:135], v[80:95]
  ds_read_b64_tr_b16 v[116:117], v244 offset:24576
  ds_read_b64_tr_b16 v[118:119], v244 offset:27648
  s_waitcnt lgkmcnt(10)
  v_mfma_f32_32x32x16_bf16 v[64:79], v[120:123], v[136:139], v[64:79]
  ds_read_b64_tr_b16 v[120:121], v243 offset:30720
  ds_read_b64_tr_b16 v[122:123], v243 offset:33792
  s_waitcnt lgkmcnt(10)
  v_mfma_f32_32x32x16_bf16 v[80:95], v[124:127], v[136:139], v[80:95]
  ds_read_b64_tr_b16 v[124:125], v244 offset:30720
  ds_read_b64_tr_b16 v[126:127], v244 offset:33792
  s_waitcnt lgkmcnt(10)
  v_mfma_f32_32x32x16_bf16 v[64:79], v[192:195], v[140:143], v[64:79]
  ds_read_b64_tr_b16 v[192:193], v243 offset:36864
  ds_read_b64_tr_b16 v[194:195], v243 offset:39936
  s_waitcnt lgkmcnt(10)
  v_mfma_f32_32x32x16_bf16 v[80:95], v[196:199], v[140:143], v[80:95]
  ds_read_b64_tr_b16 v[196:197], v244 offset:36864
  ds_read_b64_tr_b16 v[198:199], v244 offset:39936
  s_waitcnt vmcnt(7)
  s_barrier
  s_waitcnt lgkmcnt(10)
  v_mfma_f32_32x32x16_bf16 v[64:79], v[112:115], v[144:147], v[64:79]
  ds_read_b64_tr_b16 v[112:113], v243 offset:43008
  ds_read_b64_tr_b16 v[114:115], v243 offset:46080
  s_waitcnt lgkmcnt(10)
  v_mfma_f32_32x32x16_bf16 v[80:95], v[116:119], v[144:147], v[80:95]
  ds_read_b64_tr_b16 v[116:117], v244 offset:43008
  ds_read_b64_tr_b16 v[118:119], v244 offset:46080
  s_add_u32 m0, s70, 49152
  s_add_u32 s60, s69, 768
  s_add_u32 s60, s60, s11
  s_add_u32 s60, s60, s3
  buffer_load_dwordx4 v246, s[32:35], s60 offen offset:0 lds
  buffer_load_dwordx4 v247, s[32:35], s60 offen offset:1024 lds
  buffer_load_dwordx4 v248, s[32:35], s60 offen offset:2048 lds
  s_waitcnt lgkmcnt(10)
  v_mfma_f32_32x32x16_bf16 v[64:79], v[120:123], v[148:151], v[64:79]
  ds_read_b64_tr_b16 v[120:121], v240 offset:0
  ds_read_b64_tr_b16 v[122:123], v240 offset:3072
  s_waitcnt lgkmcnt(10)
  v_mfma_f32_32x32x16_bf16 v[80:95], v[124:127], v[148:151], v[80:95]
  ds_read_b64_tr_b16 v[124:125], v241 offset:0
  ds_read_b64_tr_b16 v[126:127], v241 offset:3072
  s_waitcnt lgkmcnt(10)
  v_mfma_f32_32x32x16_bf16 v[64:79], v[192:195], v[152:155], v[64:79]
  ds_read_b64_tr_b16 v[192:193], v240 offset:6144
  ds_read_b64_tr_b16 v[194:195], v240 offset:9216
  s_waitcnt lgkmcnt(10)
  v_mfma_f32_32x32x16_bf16 v[80:95], v[196:199], v[152:155], v[80:95]
  ds_read_b64_tr_b16 v[196:197], v241 offset:6144
  ds_read_b64_tr_b16 v[198:199], v241 offset:9216
  s_waitcnt lgkmcnt(10)
  v_mfma_f32_32x32x16_bf16 v[64:79], v[112:115], v[156:159], v[64:79]
  ds_read_b64_tr_b16 v[112:113], v240 offset:12288
  ds_read_b64_tr_b16 v[114:115], v240 offset:15360
  s_waitcnt lgkmcnt(10)
  v_mfma_f32_32x32x16_bf16 v[80:95], v[116:119], v[156:159], v[80:95]
  ds_read_b64_tr_b16 v[116:117], v241 offset:12288
  ds_read_b64_tr_b16 v[118:119], v241 offset:15360
  s_waitcnt vmcnt(3)
  s_barrier
  s_waitcnt lgkmcnt(10)
  v_mfma_f32_32x32x16_bf16 v[64:79], v[120:123], v[208:211], v[64:79]
  ds_read_b64_tr_b16 v[120:121], v240 offset:18432
  ds_read_b64_tr_b16 v[122:123], v240 offset:21504
  s_waitcnt lgkmcnt(10)
  v_mfma_f32_32x32x16_bf16 v[80:95], v[124:127], v[208:211], v[80:95]
  ds_read_b64_tr_b16 v[124:125], v241 offset:18432
  ds_read_b64_tr_b16 v[126:127], v241 offset:21504
  s_add_u32 m0, s70, 73728
  s_add_u32 s60, s69, 74496
  s_add_u32 s60, s60, s11
  s_add_u32 s60, s60, s3
  buffer_load_dwordx4 v246, s[32:35], s60 offen offset:0 lds
  buffer_load_dwordx4 v247, s[32:35], s60 offen offset:1024 lds
  buffer_load_dwordx4 v248, s[32:35], s60 offen offset:2048 lds
  s_cmp_lg_u32 s51, 6
  s_cbranch_scc1 L_noflag_L_op2a
  v_mov_b32 v5, 1
  s_lshl_b64 exec, 1, s50
  global_store_dword v254, v5, s[14:15] sc1
  s_mov_b64 exec, -1
L_noflag_L_op2a:
  s_waitcnt lgkmcnt(10)
  v_mfma_f32_32x32x16_bf16 v[64:79], v[192:195], v[212:215], v[64:79]
  ds_read_b64_tr_b16 v[192:193], v240 offset:24576
  ds_read_b64_tr_b16 v[194:195], v240 offset:27648
  s_waitcnt lgkmcnt(10)
  v_mfma_f32_32x32x16_bf16 v[80:95], v[196:199], v[212:215], v[80:95]
  ds_read_b64_tr_b16 v[196:197], v241 offset:24576
  ds_read_b64_tr_b16 v[198:199], v241 offset:27648
  s_waitcnt lgkmcnt(10)
  v_mfma_f32_32x32x16_bf16 v[64:79], v[112:115], v[216:219], v[64:79]
  ds_read_b64_tr_b16 v[112:113], v240 offset:30720
  ds_read_b64_tr_b16 v[114:115], v240 offset:33792
  s_waitcnt lgkmcnt(10)
  v_mfma_f32_32x32x16_bf16 v[80:95], v[116:119], v[216:219], v[80:95]
  ds_read_b64_tr_b16 v[116:117], v241 offset:30720
  ds_read_b64_tr_b16 v[118:119], v241 offset:33792
  s_waitcnt lgkmcnt(10)
  v_mfma_f32_32x32x16_bf16 v[64:79], v[120:123], v[220:223], v[64:79]
  ds_read_b64_tr_b16 v[120:121], v240 offset:36864
  ds_read_b64_tr_b16 v[122:123], v240 offset:39936
  s_waitcnt lgkmcnt(10)
  v_mfma_f32_32x32x16_bf16 v[80:95], v[124:127], v[220:223], v[80:95]
  ds_read_b64_tr_b16 v[124:125], v241 offset:36864
  ds_read_b64_tr_b16 v[126:127], v241 offset:39936
  s_waitcnt vmcnt(3)
  s_barrier
  s_waitcnt lgkmcnt(10)
  v_mfma_f32_32x32x16_bf16 v[64:79], v[192:195], v[224:227], v[64:79]
  ds_read_b64_tr_b16 v[192:193], v240 offset:43008
  ds_read_b64_tr_b16 v[194:195], v240 offset:46080
  s_waitcnt lgkmcnt(10)
  v_mfma_f32_32x32x16_bf16 v[80:95], v[196:199], v[224:227], v[80:95]
  ds_read_b64_tr_b16 v[196:197], v241 offset:43008
  ds_read_b64_tr_b16 v[198:199], v241 offset:46080
  s_add_u32 m0, s70, 0
  s_add_u32 s60, s69, 768
  s_add_u32 s60, s60, s11
  s_sub_u32 s60, s60, s3
  s_add_u32 s60, s60, 147456
  buffer_load_dwordx4 v246, s[32:35], s60 offen offset:0 lds
  buffer_load_dwordx4 v247, s[32:35], s60 offen offset:1024 lds
  buffer_load_dwordx4 v248, s[32:35], s60 offen offset:2048 lds
  s_waitcnt lgkmcnt(10)
  v_mfma_f32_32x32x16_bf16 v[64:79], v[112:115], v[228:231], v[64:79]
  ds_read_b64_tr_b16 v[112:113], v243 offset:0
  ds_read_b64_tr_b16 v[114:115], v243 offset:3072
  s_waitcnt lgkmcnt(10)
  v_mfma_f32_32x32x16_bf16 v[80:95], v[116:119], v[228:231], v[80:95]
  ds_read_b64_tr_b16 v[116:117], v244 offset:0
  ds_read_b64_tr_b16 v[118:119], v244 offset:3072
  s_waitcnt lgkmcnt(10)
  v_mfma_f32_32x32x16_bf16 v[64:79], v[120:123], v[232:235], v[64:79]
  ds_read_b64_tr_b16 v[120:121], v243 offset:6144
  ds_read_b64_tr_b16 v[122:123], v243 offset:9216
  s_waitcnt lgkmcnt(10)
  v_mfma_f32_32x32x16_bf16 v[80:95], v[124:127], v[232:235], v[80:95]
  ds_read_b64_tr_b16 v[124:125], v244 offset:6144
  ds_read_b64_tr_b16 v[126:127], v244 offset:9216
  s_waitcnt lgkmcnt(10)
  v_mfma_f32_32x32x16_bf16 v[64:79], v[192:195], v[236:239], v[64:79]
  ds_read_b64_tr_b16 v[192:193], v243 offset:12288
  ds_read_b64_tr_b16 v[194:195], v243 offset:15360
  s_waitcnt lgkmcnt(10)
  v_mfma_f32_32x32x16_bf16 v[80:95], v[196:199], v[236:239], v[80:95]
  ds_read_b64_tr_b16 v[196:197], v244 offset:12288
  ds_read_b64_tr_b16 v[198:199], v244 offset:15360
  s_waitcnt vmcnt(3)
  s_barrier
  s_waitcnt lgkmcnt(10)
  v_mfma_f32_32x32x16_bf16 v[64:79], v[112:115], v[160:163], v[64:79]
  ds_read_b64_tr_b16 v[112:113], v243 offset:18432
  ds_read_b64_tr_b16 v[114:115], v243 offset:21504
  s_waitcnt lgkmcnt(10)
  v_mfma_f32_32x32x16_bf16 v[80:95], v[116:119], v[160:163], v[80:95]
  ds_read_b64_tr_b16 v[116:117], v244 offset:18432
  ds_read_b64_tr_b16 v[118:119], v244 offset:21504
  s_add_u32 m0, s70, 24576
  s_add_u32 s60, s69, 74496
  s_add_u32 s60, s60, s11
  s_sub_u32 s60, s60, s3
  s_add_u32 s60, s60, 147456
  buffer_load_dwordx4 v246, s[32:35], s60 offen offset:0 lds
  buffer_load_dwordx4 v247, s[32:35], s60 offen offset:1024 lds
  buffer_load_dwordx4 v248, s[32:35], s60 offen offset:2048 lds
  s_waitcnt lgkmcnt(10)
  v_mfma_f32_32x32x16_bf16 v[64:79], v[120:123], v[164:167], v[64:79]
  ds_read_b64_tr_b16 v[120:121], v243 offset:24576
  ds_read_b64_tr_b16 v[122:123], v243 offset:27648
  s_waitcnt lgkmcnt(10)
  v_mfma_f32_32x32x16_bf16 v[80:95], v[124:127], v[164:167], v[80:95]
  ds_read_b64_tr_b16 v[124:125], v244 offset:24576
  ds_read_b64_tr_b16 v[126:127], v244 offset:27648
  s_waitcnt lgkmcnt(10)
  v_mfma_f32_32x32x16_bf16 v[64:79], v[192:195], v[168:171], v[64:79]
  ds_read_b64_tr_b16 v[192:193], v243 offset:30720
  ds_read_b64_tr_b16 v[194:195], v243 offset:33792
  s_waitcnt lgkmcnt(10)
  v_mfma_f32_32x32x16_bf16 v[80:95], v[196:199], v[168:171], v[80:95]
  ds_read_b64_tr_b16 v[196:197], v244 offset:30720
  ds_read_b64_tr_b16 v[198:199], v244 offset:33792
  s_waitcnt lgkmcnt(10)
  v_mfma_f32_32x32x16_bf16 v[64:79], v[112:115], v[172:175], v[64:79]
  ds_read_b64_tr_b16 v[112:113], v243 offset:36864
  ds_read_b64_tr_b16 v[114:115], v243 offset:39936
  s_waitcnt lgkmcnt(10)
  v_mfma_f32_32x32x16_bf16 v[80:95], v[116:119], v[172:175], v[80:95]
  ds_read_b64_tr_b16 v[116:117], v244 offset:36864
  ds_read_b64_tr_b16 v[118:119], v244 offset:39936
  s_waitcnt vmcnt(3)
  s_barrier
  s_waitcnt lgkmcnt(10)
  v_mfma_f32_32x32x16_bf16 v[64:79], v[120:123], v[176:179], v[64:79]
  ds_read_b64_tr_b16 v[120:121], v243 offset:43008
  ds_read_b64_tr_b16 v[122:123], v243 offset:46080
  s_waitcnt lgkmcnt(10)
  v_mfma_f32_32x32x16_bf16 v[80:95], v[124:127], v[176:179], v[80:95]
  ds_read_b64_tr_b16 v[124:125], v244 offset:43008
  ds_read_b64_tr_b16 v[126:127], v244 offset:46080
  global_load_dword v252, v254, s[14:15] sc1
  s_waitcnt lgkmcnt(10)
  v_mfma_f32_32x32x16_bf16 v[64:79], v[192:195], v[180:183], v[64:79]
  ds_read_b64_tr_b16 v[192:193], v240 offset:0
  ds_read_b64_tr_b16 v[194:195], v240 offset:3072
  s_waitcnt lgkmcnt(10)
  v_mfma_f32_32x32x16_bf16 v[80:95], v[196:199], v[180:183], v[80:95]
  ds_read_b64_tr_b16 v[196:197], v241 offset:0
  ds_read_b64_tr_b16 v[198:199], v241 offset:3072
  s_waitcnt lgkmcnt(10)
  v_mfma_f32_32x32x16_bf16 v[64:79], v[112:115], v[184:187], v[64:79]
  ds_read_b64_tr_b16 v[112:113], v240 offset:6144
  ds_read_b64_tr_b16 v[114:115], v240 offset:9216
  s_waitcnt lgkmcnt(10)
  v_mfma_f32_32x32x16_bf16 v[80:95], v[116:119], v[184:187], v[80:95]
  ds_read_b64_tr_b16 v[116:117], v241 offset:6144
  ds_read_b64_tr_b16 v[118:119], v241 offset:9216
  s_waitcnt lgkmcnt(10)
  v_mfma_f32_32x32x16_bf16 v[64:79], v[120:123], v[188:191], v[64:79]
  ds_read_b64_tr_b16 v[120:121], v240 offset:12288
  ds_read_b64_tr_b16 v[122:123], v240 offset:15360
  s_waitcnt lgkmcnt(10)
  v_mfma_f32_32x32x16_bf16 v[80:95], v[124:127], v[188:191], v[80:95]
  ds_read_b64_tr_b16 v[124:125], v241 offset:12288
  ds_read_b64_tr_b16 v[126:127], v241 offset:15360
  s_waitcnt vmcnt(1)
  s_barrier
  s_waitcnt lgkmcnt(10)
  v_mfma_f32_32x32x16_bf16 v[64:79], v[192:195], v[32:35], v[64:79]
  ds_read_b64_tr_b16 v[192:193], v240 offset:18432
  ds_read_b64_tr_b16 v[194:195], v240 offset:21504
  s_waitcnt lgkmcnt(10)
  v_mfma_f32_32x32x16_bf16 v[80:95], v[196:199], v[32:35], v[80:95]
  ds_read_b64_tr_b16 v[196:197], v241 offset:18432
  ds_read_b64_tr_b16 v[198:199], v241 offset:21504
  s_waitcnt lgkmcnt(10)
  v_mfma_f32_32x32x16_bf16 v[64:79], v[112:115], v[36:39], v[64:79]
  ds_read_b64_tr_b16 v[112:113], v240 offset:24576
  ds_read_b64_tr_b16 v[114:115], v240 offset:27648
  s_waitcnt lgkmcnt(10)
  v_mfma_f32_32x32x16_bf16 v[80:95], v[116:119], v[36:39], v[80:95]
  ds_read_b64_tr_b16 v[116:117], v241 offset:24576
  ds_read_b64_tr_b16 v[118:119], v241 offset:27648
  s_waitcnt lgkmcnt(10)
  v_mfma_f32_32x32x16_bf16 v[64:79], v[120:123], v[40:43], v[64:79]
  ds_read_b64_tr_b16 v[120:121], v240 offset:30720
  ds_read_b64_tr_b16 v[122:123], v240 offset:33792
  s_waitcnt lgkmcnt(10)
  v_mfma_f32_32x32x16_bf16 v[80:95], v[124:127], v[40:43], v[80:95]
  ds_read_b64_tr_b16 v[124:125], v241 offset:30720
  ds_read_b64_tr_b16 v[126:127], v241 offset:33792
  s_waitcnt lgkmcnt(10)
  v_mfma_f32_32x32x16_bf16 v[64:79], v[192:195], v[44:47], v[64:79]
  ds_read_b64_tr_b16 v[192:193], v240 offset:36864
  ds_read_b64_tr_b16 v[194:195], v240 offset:39936
  s_waitcnt lgkmcnt(10)
  v_mfma_f32_32x32x16_bf16 v[80:95], v[196:199], v[44:47], v[80:95]
  ds_read_b64_tr_b16 v[196:197], v241 offset:36864
  ds_read_b64_tr_b16 v[198:199], v241 offset:39936
  s_barrier
  s_waitcnt lgkmcnt(10)
  v_mfma_f32_32x32x16_bf16 v[64:79], v[112:115], v[48:51], v[64:79]
  ds_read_b64_tr_b16 v[112:113], v240 offset:43008
  ds_read_b64_tr_b16 v[114:115], v240 offset:46080
  s_waitcnt lgkmcnt(10)
  v_mfma_f32_32x32x16_bf16 v[80:95], v[116:119], v[48:51], v[80:95]
  ds_read_b64_tr_b16 v[116:117], v241 offset:43008
  ds_read_b64_tr_b16 v[118:119], v241 offset:46080
  s_waitcnt lgkmcnt(10)
  v_mfma_f32_32x32x16_bf16 v[64:79], v[120:123], v[52:55], v[64:79]
  s_waitcnt lgkmcnt(8)
  v_mfma_f32_32x32x16_bf16 v[80:95], v[124:127], v[52:55], v[80:95]
  s_waitcnt lgkmcnt(6)
  v_mfma_f32_32x32x16_bf16 v[64:79], v[192:195], v[56:59], v[64:79]
  s_waitcnt lgkmcnt(4)
  v_mfma_f32_32x32x16_bf16 v[80:95], v[196:199], v[56:59], v[80:95]
  s_waitcnt lgkmcnt(2)
  v_mfma_f32_32x32x16_bf16 v[64:79], v[112:115], v[60:63], v[64:79]
  s_waitcnt lgkmcnt(0)
  v_mfma_f32_32x32x16_bf16 v[80:95], v[116:119], v[60:63], v[80:95]
  s_nop 15
  s_nop 3
  v_cvt_pk_bf16_f32 v12, v64, v65
  v_cvt_pk_bf16_f32 v13, v66, v67
  v_cvt_pk_bf16_f32 v14, v68, v69
  v_cvt_pk_bf16_f32 v15, v70, v71
  v_cvt_pk_bf16_f32 v16, v72, v73
  v_cvt_pk_bf16_f32 v17, v74, v75
  v_cvt_pk_bf16_f32 v18, v76, v77
  v_cvt_pk_bf16_f32 v19, v78, v79
  s_add_u32 s60, s71, 73728
  buffer_store_dwordx4 v[12:15], v249, s[36:39], s60 offen offset:0 sc1
  buffer_store_dwordx4 v[16:19], v249, s[36:39], s60 offen offset:1024 sc1
  v_cvt_pk_bf16_f32 v20, v80, v81
  v_cvt_pk_bf16_f32 v21, v82, v83
  v_cvt_pk_bf16_f32 v22, v84, v85
  v_cvt_pk_bf16_f32 v23, v86, v87
  v_cvt_pk_bf16_f32 v24, v88, v89
  v_cvt_pk_bf16_f32 v25, v90, v91
  v_cvt_pk_bf16_f32 v26, v92, v93
  v_cvt_pk_bf16_f32 v27, v94, v95
  s_add_u32 s60, s71, 79872
  buffer_store_dwordx4 v[20:23], v249, s[36:39], s60 offen offset:0 sc1
  buffer_store_dwordx4 v[24:27], v249, s[36:39], s60 offen offset:1024 sc1
  v_and_b32 v8, 31, v30
  v_mul_u32_u24 v8, 2304, v8
  v_lshrrev_b32 v9, 5, v30
  v_lshl_add_u32 v8, v9, 4, v8
  v_and_b32 v28, 7, v30
  v_cmp_eq_u32 vcc, s50, v28
  s_nop 1
  v_cndmask_b32 v28, 0, 3, vcc
  s_waitcnt vmcnt(4)
  v_or_b32 v252, v252, v28
  v_and_b32 v252, 1, v252
  v_cmp_ne_u32 vcc, 0, v252
  s_nop 3
  s_cmp_eq_u64 vcc, -1
  s_cbranch_scc1 L_pollok_L_op2a
L_poll_L_op2a:
  global_load_dword v252, v254, s[14:15] sc1
  s_waitcnt vmcnt(0)
  v_or_b32 v252, v252, v28
  v_and_b32 v252, 1, v252
  v_cmp_ne_u32 vcc, 0, v252
  s_nop 3
  s_cmp_eq_u64 vcc, -1
  s_cbranch_scc1 L_polldone_L_op2a
  s_sleep 2
  s_branch L_poll_L_op2a
L_polldone_L_op2a:
L_pollok_L_op2a:
  s_mul_i32 s73, s50, 9
  s_add_u32 s73, s73, s51
  s_mul_i32 s60, s72, 884736
  s_lshl_b32 s61, s73, 10
  s_add_u32 s60, s60, s61
  buffer_load_dwordx4 v[32:35], v249, s[36:39], s60 offen sc1
  s_add_u32 s60, s60, 110592
  buffer_load_dwordx4 v[36:39], v249, s[36:39], s60 offen sc1
  s_add_u32 s60, s60, 110592
  buffer_load_dwordx4 v[40:43], v249, s[36:39], s60 offen sc1
  s_add_u32 s60, s60, 110592
  buffer_load_dwordx4 v[44:47], v249, s[36:39], s60 offen sc1
  s_add_u32 s60, s60, 110592
  buffer_load_dwordx4 v[48:51], v249, s[36:39], s60 offen sc1
  s_add_u32 s60, s60, 110592
  buffer_load_dwordx4 v[52:55], v249, s[36:39], s60 offen sc1
  s_add_u32 s60, s60, 110592
  buffer_load_dwordx4 v[56:59], v249, s[36:39], s60 offen sc1
  s_add_u32 s60, s60, 110592
  buffer_load_dwordx4 v[60:63], v249, s[36:39], s60 offen sc1
  s_waitcnt vmcnt(8)
  s_barrier
  s_cmp_lg_u32 s51, 6
  s_cbranch_scc1 L_noflag_L_op2b
  v_mov_b32 v5, 3
  s_lshl_b64 exec, 1, s50
  global_store_dword v254, v5, s[14:15] sc1
  s_mov_b64 exec, -1
L_noflag_L_op2b:
  s_lshr_b32 s60, s73, 1
  s_mul_hi_u32 s61, s60, 0x55555556
  s_mul_i32 s62, s61, 3
  s_sub_u32 s62, s60, s62
  s_mul_i32 s60, s49, 96
  s_lshl_b32 s62, s62, 5
  s_add_u32 s60, s60, s62
  s_mul_i32 s60, s60, 2304
  s_mul_i32 s62, s48, 1152
  s_add_u32 s60, s60, s62
  s_lshl_b32 s61, s61, 6
  s_add_u32 s60, s60, s61
  s_and_b32 s61, s73, 1
  s_lshl_b32 s61, s61, 5
  s_add_u32 s60, s60, s61
  s_waitcnt vmcnt(7)
  v_lshlrev_b32 v64, 16, v32
  v_and_b32 v65, 0xffff0000, v32
  v_lshlrev_b32 v66, 16, v33
  v_and_b32 v67, 0xffff0000, v33
  v_lshlrev_b32 v68, 16, v34
  v_and_b32 v69, 0xffff0000, v34
  v_lshlrev_b32 v70, 16, v35
  v_and_b32 v71, 0xffff0000, v35
  s_waitcnt vmcnt(6)
  v_lshlrev_b32 v6, 16, v36
  v_and_b32 v7, 0xffff0000, v36
  v_add_f32 v64, v64, v6
  v_add_f32 v65, v65, v7
  v_lshlrev_b32 v6, 16, v37
  v_and_b32 v7, 0xffff0000, v37
  v_add_f32 v66, v66, v6
  v_add_f32 v67, v67, v7
  v_lshlrev_b32 v6, 16, v38
  v_and_b32 v7, 0xffff0000, v38
  v_add_f32 v68, v68, v6
  v_add_f32 v69, v69, v7
  v_lshlrev_b32 v6, 16, v39
  v_and_b32 v7, 0xffff0000, v39
  v_add_f32 v70, v70, v6
  v_add_f32 v71, v71, v7
  s_waitcnt vmcnt(5)
  v_lshlrev_b32 v6, 16, v40
  v_and_b32 v7, 0xffff0000, v40
  v_add_f32 v64, v64, v6
  v_add_f32 v65, v65, v7
  v_lshlrev_b32 v6, 16, v41
  v_and_b32 v7, 0xffff0000, v41
  v_add_f32 v66, v66, v6
  v_add_f32 v67, v67, v7
  v_lshlrev_b32 v6, 16, v42
  v_and_b32 v7, 0xffff0000, v42
  v_add_f32 v68, v68, v6
  v_add_f32 v69, v69, v7
  v_lshlrev_b32 v6, 16, v43
  v_and_b32 v7, 0xffff0000, v43
  v_add_f32 v70, v70, v6
  v_add_f32 v71, v71, v7
  s_waitcnt vmcnt(4)
  v_lshlrev_b32 v6, 16, v44
  v_and_b32 v7, 0xffff0000, v44
  v_add_f32 v64, v64, v6
  v_add_f32 v65, v65, v7
  v_lshlrev_b32 v6, 16, v45
  v_and_b32 v7, 0xffff0000, v45
  v_add_f32 v66, v66, v6
  v_add_f32 v67, v67, v7
  v_lshlrev_b32 v6, 16, v46
  v_and_b32 v7, 0xffff0000, v46
  v_add_f32 v68, v68, v6
  v_add_f32 v69, v69, v7
  v_lshlrev_b32 v6, 16, v47
  v_and_b32 v7, 0xffff0000, v47
  v_add_f32 v70, v70, v6
  v_add_f32 v71, v71, v7
  s_waitcnt vmcnt(3)
  v_lshlrev_b32 v6, 16, v48
  v_and_b32 v7, 0xffff0000, v48
  v_add_f32 v64, v64, v6
  v_add_f32 v65, v65, v7
  v_lshlrev_b32 v6, 16, v49
  v_and_b32 v7, 0xffff0000, v49
  v_add_f32 v66, v66, v6
  v_add_f32 v67, v67, v7
  v_lshlrev_b32 v6, 16, v50
  v_and_b32 v7, 0xffff0000, v50
  v_add_f32 v68, v68, v6
  v_add_f32 v69, v69, v7
  v_lshlrev_b32 v6, 16, v51
  v_and_b32 v7, 0xffff0000, v51
  v_add_f32 v70, v70, v6
  v_add_f32 v71, v71, v7
  s_waitcnt vmcnt(2)
  v_lshlrev_b32 v6, 16, v52
  v_and_b32 v7, 0xffff0000, v52
  v_add_f32 v64, v64, v6
  v_add_f32 v65, v65, v7
  v_lshlrev_b32 v6, 16, v53
  v_and_b32 v7, 0xffff0000, v53
  v_add_f32 v66, v66, v6
  v_add_f32 v67, v67, v7
  v_lshlrev_b32 v6, 16, v54
  v_and_b32 v7, 0xffff0000, v54
  v_add_f32 v68, v68, v6
  v_add_f32 v69, v69, v7
  v_lshlrev_b32 v6, 16, v55
  v_and_b32 v7, 0xffff0000, v55
  v_add_f32 v70, v70, v6
  v_add_f32 v71, v71, v7
  s_waitcnt vmcnt(1)
  v_lshlrev_b32 v6, 16, v56
  v_and_b32 v7, 0xffff0000, v56
  v_add_f32 v64, v64, v6
  v_add_f32 v65, v65, v7
  v_lshlrev_b32 v6, 16, v57
  v_and_b32 v7, 0xffff0000, v57
  v_add_f32 v66, v66, v6
  v_add_f32 v67, v67, v7
  v_lshlrev_b32 v6, 16, v58
  v_and_b32 v7, 0xffff0000, v58
  v_add_f32 v68, v68, v6
  v_add_f32 v69, v69, v7
  v_lshlrev_b32 v6, 16, v59
  v_and_b32 v7, 0xffff0000, v59
  v_add_f32 v70, v70, v6
  v_add_f32 v71, v71, v7
  s_waitcnt vmcnt(0)
  v_lshlrev_b32 v6, 16, v60
  v_and_b32 v7, 0xffff0000, v60
  v_add_f32 v64, v64, v6
  v_add_f32 v65, v65, v7
  v_lshlrev_b32 v6, 16, v61
  v_and_b32 v7, 0xffff0000, v61
  v_add_f32 v66, v66, v6
  v_add_f32 v67, v67, v7
  v_lshlrev_b32 v6, 16, v62
  v_and_b32 v7, 0xffff0000, v62
  v_add_f32 v68, v68, v6
  v_add_f32 v69, v69, v7
  v_lshlrev_b32 v6, 16, v63
  v_and_b32 v7, 0xffff0000, v63
  v_add_f32 v70, v70, v6
  v_add_f32 v71, v71, v7
  v_cvt_pk_bf16_f32 v32, v64, v65
  v_cvt_pk_bf16_f32 v33, v66, v67
  v_cvt_pk_bf16_f32 v34, v68, v69
  v_cvt_pk_bf16_f32 v35, v70, v71
  s_nop 1
  v_permlane32_swap_b32 v32, v34
  v_permlane32_swap_b32 v33, v35
  buffer_store_dwordx4 v[32:35], v8, s[40:43], s60 offen
  s_cmp_lg_u32 s51, 6
  s_cbranch_scc1 L_nopoll_L_op2
L_poll_L_op2b:
  global_load_dword v252, v254, s[14:15] sc1
  s_waitcnt vmcnt(0)
  v_or_b32 v252, v252, v28
  v_and_b32 v252, 2, v252
  v_cmp_ne_u32 vcc, 0, v252
  s_nop 3
  s_cmp_eq_u64 vcc, -1
  s_cbranch_scc1 L_polldone_L_op2b
  s_sleep 2
  s_branch L_poll_L_op2b
L_polldone_L_op2b:
L_nopoll_L_op2:
  s_barrier
  s_lshl_b32 s73, s51, 3
  s_add_u32 s73, s73, s50
  s_add_u32 s73, s73, 72
  s_mul_i32 s60, s50, 9
  s_add_u32 s60, s60, 8
  s_cmp_eq_u32 s51, 7
  s_cselect_b32 s73, s60, s73
  s_cmp_ge_u32 s73, 108
  s_cbranch_scc1 L_fin_L_op2
  s_mul_i32 s60, s72, 884736
  s_lshl_b32 s61, s73, 10
  s_add_u32 s60, s60, s61
  buffer_load_dwordx4 v[96:99], v249, s[36:39], s60 offen sc1
  s_add_u32 s60, s60, 110592
  buffer_load_dwordx4 v[100:103], v249, s[36:39], s60 offen sc1
  s_add_u32 s60, s60, 110592
  buffer_load_dwordx4 v[104:107], v249, s[36:39], s60 offen sc1
  s_add_u32 s60, s60, 110592
  buffer_load_dwordx4 v[108:111], v249, s[36:39], s60 offen sc1
  s_add_u32 s60, s60, 110592
  buffer_load_dwordx4 v[112:115], v249, s[36:39], s60 offen sc1
  s_add_u32 s60, s60, 110592
  buffer_load_dwordx4 v[116:119], v249, s[36:39], s60 offen sc1
  s_add_u32 s60, s60, 110592
  buffer_load_dwordx4 v[120:123], v249, s[36:39], s60 offen sc1
  s_add_u32 s60, s60, 110592
  buffer_load_dwordx4 v[124:127], v249, s[36:39], s60 offen sc1
  s_lshr_b32 s60, s73, 1
  s_mul_hi_u32 s61, s60, 0x55555556
  s_mul_i32 s62, s61, 3
  s_sub_u32 s62, s60, s62
  s_mul_i32 s60, s49, 96
  s_lshl_b32 s62, s62, 5
  s_add_u32 s60, s60, s62
  s_mul_i32 s60, s60, 2304
  s_mul_i32 s62, s48, 1152
  s_add_u32 s60, s60, s62
  s_lshl_b32 s61, s61, 6
  s_add_u32 s60, s60, s61
  s_and_b32 s61, s73, 1
  s_lshl_b32 s61, s61, 5
  s_add_u32 s60, s60, s61
  s_waitcnt vmcnt(7)
  v_lshlrev_b32 v128, 16, v96
  v_and_b32 v129, 0xffff0000, v96
  v_lshlrev_b32 v130, 16, v97
  v_and_b32 v131, 0xffff0000, v97
  v_lshlrev_b32 v132, 16, v98
  v_and_b32 v133, 0xffff0000, v98
  v_lshlrev_b32 v134, 16, v99
  v_and_b32 v135, 0xffff0000, v99
  s_waitcnt vmcnt(6)
  v_lshlrev_b32 v6, 16, v100
  v_and_b32 v7, 0xffff0000, v100
  v_add_f32 v128, v128, v6
  v_add_f32 v129, v129, v7
  v_lshlrev_b32 v6, 16, v101
  v_and_b32 v7, 0xffff0000, v101
  v_add_f32 v130, v130, v6
  v_add_f32 v131, v131, v7
  v_lshlrev_b32 v6, 16, v102
  v_and_b32 v7, 0xffff0000, v102
  v_add_f32 v132, v132, v6
  v_add_f32 v133, v133, v7
  v_lshlrev_b32 v6, 16, v103
  v_and_b32 v7, 0xffff0000, v103
  v_add_f32 v134, v134, v6
  v_add_f32 v135, v135, v7
  s_waitcnt vmcnt(5)
  v_lshlrev_b32 v6, 16, v104
  v_and_b32 v7, 0xffff0000, v104
  v_add_f32 v128, v128, v6
  v_add_f32 v129, v129, v7
  v_lshlrev_b32 v6, 16, v105
  v_and_b32 v7, 0xffff0000, v105
  v_add_f32 v130, v130, v6
  v_add_f32 v131, v131, v7
  v_lshlrev_b32 v6, 16, v106
  v_and_b32 v7, 0xffff0000, v106
  v_add_f32 v132, v132, v6
  v_add_f32 v133, v133, v7
  v_lshlrev_b32 v6, 16, v107
  v_and_b32 v7, 0xffff0000, v107
  v_add_f32 v134, v134, v6
  v_add_f32 v135, v135, v7
  s_waitcnt vmcnt(4)
  v_lshlrev_b32 v6, 16, v108
  v_and_b32 v7, 0xffff0000, v108
  v_add_f32 v128, v128, v6
  v_add_f32 v129, v129, v7
  v_lshlrev_b32 v6, 16, v109
  v_and_b32 v7, 0xffff0000, v109
  v_add_f32 v130, v130, v6
  v_add_f32 v131, v131, v7
  v_lshlrev_b32 v6, 16, v110
  v_and_b32 v7, 0xffff0000, v110
  v_add_f32 v132, v132, v6
  v_add_f32 v133, v133, v7
  v_lshlrev_b32 v6, 16, v111
  v_and_b32 v7, 0xffff0000, v111
  v_add_f32 v134, v134, v6
  v_add_f32 v135, v135, v7
  s_waitcnt vmcnt(3)
  v_lshlrev_b32 v6, 16, v112
  v_and_b32 v7, 0xffff0000, v112
  v_add_f32 v128, v128, v6
  v_add_f32 v129, v129, v7
  v_lshlrev_b32 v6, 16, v113
  v_and_b32 v7, 0xffff0000, v113
  v_add_f32 v130, v130, v6
  v_add_f32 v131, v131, v7
  v_lshlrev_b32 v6, 16, v114
  v_and_b32 v7, 0xffff0000, v114
  v_add_f32 v132, v132, v6
  v_add_f32 v133, v133, v7
  v_lshlrev_b32 v6, 16, v115
  v_and_b32 v7, 0xffff0000, v115
  v_add_f32 v134, v134, v6
  v_add_f32 v135, v135, v7
  s_waitcnt vmcnt(2)
  v_lshlrev_b32 v6, 16, v116
  v_and_b32 v7, 0xffff0000, v116
  v_add_f32 v128, v128, v6
  v_add_f32 v129, v129, v7
  v_lshlrev_b32 v6, 16, v117
  v_and_b32 v7, 0xffff0000, v117
  v_add_f32 v130, v130, v6
  v_add_f32 v131, v131, v7
  v_lshlrev_b32 v6, 16, v118
  v_and_b32 v7, 0xffff0000, v118
  v_add_f32 v132, v132, v6
  v_add_f32 v133, v133, v7
  v_lshlrev_b32 v6, 16, v119
  v_and_b32 v7, 0xffff0000, v119
  v_add_f32 v134, v134, v6
  v_add_f32 v135, v135, v7
  s_waitcnt vmcnt(1)
  v_lshlrev_b32 v6, 16, v120
  v_and_b32 v7, 0xffff0000, v120
  v_add_f32 v128, v128, v6
  v_add_f32 v129, v129, v7
  v_lshlrev_b32 v6, 16, v121
  v_and_b32 v7, 0xffff0000, v121
  v_add_f32 v130, v130, v6
  v_add_f32 v131, v131, v7
  v_lshlrev_b32 v6, 16, v122
  v_and_b32 v7, 0xffff0000, v122
  v_add_f32 v132, v132, v6
  v_add_f32 v133, v133, v7
  v_lshlrev_b32 v6, 16, v123
  v_and_b32 v7, 0xffff0000, v123
  v_add_f32 v134, v134, v6
  v_add_f32 v135, v135, v7
  s_waitcnt vmcnt(0)
  v_lshlrev_b32 v6, 16, v124
  v_and_b32 v7, 0xffff0000, v124
  v_add_f32 v128, v128, v6
  v_add_f32 v129, v129, v7
  v_lshlrev_b32 v6, 16, v125
  v_and_b32 v7, 0xffff0000, v125
  v_add_f32 v130, v130, v6
  v_add_f32 v131, v131, v7
  v_lshlrev_b32 v6, 16, v126
  v_and_b32 v7, 0xffff0000, v126
  v_add_f32 v132, v132, v6
  v_add_f32 v133, v133, v7
  v_lshlrev_b32 v6, 16, v127
  v_and_b32 v7, 0xffff0000, v127
  v_add_f32 v134, v134, v6
  v_add_f32 v135, v135, v7
  v_cvt_pk_bf16_f32 v96, v128, v129
  v_cvt_pk_bf16_f32 v97, v130, v131
  v_cvt_pk_bf16_f32 v98, v132, v133
  v_cvt_pk_bf16_f32 v99, v134, v135
  s_nop 1
  v_permlane32_swap_b32 v96, v98
  v_permlane32_swap_b32 v97, v99
  buffer_store_dwordx4 v[96:99], v8, s[40:43], s60 offen
L_fin_L_op2:
  s_endpgm
L_op3:
  s_barrier
  ds_read_b64_tr_b16 v[112:113], v243 offset:0
  ds_read_b64_tr_b16 v[114:115], v243 offset:3072
  ds_read_b64_tr_b16 v[116:117], v244 offset:0
  ds_read_b64_tr_b16 v[118:119], v244 offset:3072
  ds_read_b64_tr_b16 v[120:121], v245 offset:0
  ds_read_b64_tr_b16 v[122:123], v245 offset:3072
  ds_read_b64_tr_b16 v[124:125], v243 offset:6144
  ds_read_b64_tr_b16 v[126:127], v243 offset:9216
  ds_read_b64_tr_b16 v[192:193], v244 offset:6144
  ds_read_b64_tr_b16 v[194:195], v244 offset:9216
  ds_read_b64_tr_b16 v[196:197], v245 offset:6144
  ds_read_b64_tr_b16 v[198:199], v245 offset:9216
  s_waitcnt lgkmcnt(10)
  v_mfma_f32_32x32x16_bf16 v[64:79], v[112:115], v[128:131], 0
  ds_read_b64_tr_b16 v[112:113], v243 offset:12288
  ds_read_b64_tr_b16 v[114:115], v243 offset:15360
  s_waitcnt lgkmcnt(10)
  v_mfma_f32_32x32x16_bf16 v[80:95], v[116:119], v[128:131], 0
  ds_read_b64_tr_b16 v[116:117], v244 offset:12288
  ds_read_b64_tr_b16 v[118:119], v244 offset:15360
  s_add_u32 m0, s70, 24576
  s_add_u32 s60, s69, 74112
  s_sub_u32 s60, s60, s3
  s_add_u32 s60, s60, 147456
  buffer_load_dwordx4 v246, s[32:35], s60 offen offset:0 lds
  buffer_load_dwordx4 v247, s[32:35], s60 offen offset:1024 lds
  buffer_load_dwordx4 v248, s[32:35], s60 offen offset:2048 lds
  s_waitcnt lgkmcnt(10)
  v_mfma_f32_32x32x16_bf16 v[96:111], v[120:123], v[128:131], 0
  ds_read_b64_tr_b16 v[120:121], v245 offset:12288
  ds_read_b64_tr_b16 v[122:123], v245 offset:15360
  s_waitcnt lgkmcnt(10)
  v_mfma_f32_32x32x16_bf16 v[64:79], v[124:127], v[132:135], v[64:79]
  ds_read_b64_tr_b16 v[124:125], v243 offset:18432
  ds_read_b64_tr_b16 v[126:127], v243 offset:21504
  s_waitcnt lgkmcnt(10)
  v_mfma_f32_32x32x16_bf16 v[80:95], v[192:195], v[132:135], v[80:95]
  ds_read_b64_tr_b16 v[192:193], v244 offset:18432
  ds_read_b64_tr_b16 v[194:195], v244 offset:21504
  s_waitcnt lgkmcnt(10)
  v_mfma_f32_32x32x16_bf16 v[96:111], v[196:199], v[132:135], v[96:111]
  ds_read_b64_tr_b16 v[196:197], v245 offset:18432
  ds_read_b64_tr_b16 v[198:199], v245 offset:21504
  s_waitcnt lgkmcnt(10)
  v_mfma_f32_32x32x16_bf16 v[64:79], v[112:115], v[136:139], v[64:79]
  ds_read_b64_tr_b16 v[112:113], v243 offset:24576
  ds_read_b64_tr_b16 v[114:115], v243 offset:27648
  s_waitcnt lgkmcnt(10)
  v_mfma_f32_32x32x16_bf16 v[80:95], v[116:119], v[136:139], v[80:95]
  ds_read_b64_tr_b16 v[116:117], v244 offset:24576
  ds_read_b64_tr_b16 v[118:119], v244 offset:27648
  s_waitcnt lgkmcnt(10)
  v_mfma_f32_32x32x16_bf16 v[96:111], v[120:123], v[136:139], v[96:111]
  ds_read_b64_tr_b16 v[120:121], v245 offset:24576
  ds_read_b64_tr_b16 v[122:123], v245 offset:27648
  s_waitcnt lgkmcnt(10)
  v_mfma_f32_32x32x16_bf16 v[64:79], v[124:127], v[140:143], v[64:79]
  ds_read_b64_tr_b16 v[124:125], v243 offset:30720
  ds_read_b64_tr_b16 v[126:127], v243 offset:33792
  s_waitcnt lgkmcnt(10)
  v_mfma_f32_32x32x16_bf16 v[80:95], v[192:195], v[140:143], v[80:95]
  ds_read_b64_tr_b16 v[192:193], v244 offset:30720
  ds_read_b64_tr_b16 v[194:195], v244 offset:33792
  s_waitcnt lgkmcnt(10)
  v_mfma_f32_32x32x16_bf16 v[96:111], v[196:199], v[140:143], v[96:111]
  ds_read_b64_tr_b16 v[196:197], v245 offset:30720
  ds_read_b64_tr_b16 v[198:199], v245 offset:33792
  s_waitcnt vmcnt(3)
  s_barrier
  s_waitcnt lgkmcnt(10)
  v_mfma_f32_32x32x16_bf16 v[64:79], v[112:115], v[144:147], v[64:79]
  ds_read_b64_tr_b16 v[112:113], v243 offset:36864
  ds_read_b64_tr_b16 v[114:115], v243 offset:39936
  s_waitcnt lgkmcnt(10)
  v_mfma_f32_32x32x16_bf16 v[80:95], v[116:119], v[144:147], v[80:95]
  ds_read_b64_tr_b16 v[116:117], v244 offset:36864
  ds_read_b64_tr_b16 v[118:119], v244 offset:39936
  s_add_u32 m0, s70, 49152
  s_add_u32 s60, s69, 384
  s_add_u32 s60, s60, s11
  s_add_u32 s60, s60, s3
  buffer_load_dwordx4 v246, s[32:35], s60 offen offset:0 lds
  buffer_load_dwordx4 v247, s[32:35], s60 offen offset:1024 lds
  buffer_load_dwordx4 v248, s[32:35], s60 offen offset:2048 lds
  s_waitcnt lgkmcnt(10)
  v_mfma_f32_32x32x16_bf16 v[96:111], v[120:123], v[144:147], v[96:111]
  ds_read_b64_tr_b16 v[120:121], v245 offset:36864
  ds_read_b64_tr_b16 v[122:123], v245 offset:39936
  s_waitcnt lgkmcnt(10)
  v_mfma_f32_32x32x16_bf16 v[64:79], v[124:127], v[148:151], v[64:79]
  ds_read_b64_tr_b16 v[124:125], v243 offset:43008
  ds_read_b64_tr_b16 v[126:127], v243 offset:46080
  s_waitcnt lgkmcnt(10)
  v_mfma_f32_32x32x16_bf16 v[80:95], v[192:195], v[148:151], v[80:95]
  ds_read_b64_tr_b16 v[192:193], v244 offset:43008
  ds_read_b64_tr_b16 v[194:195], v244 offset:46080
  s_waitcnt lgkmcnt(10)
  v_mfma_f32_32x32x16_bf16 v[96:111], v[196:199], v[148:151], v[96:111]
  ds_read_b64_tr_b16 v[196:197], v245 offset:43008
  ds_read_b64_tr_b16 v[198:199], v245 offset:46080
  s_waitcnt lgkmcnt(10)
  v_mfma_f32_32x32x16_bf16 v[64:79], v[112:115], v[152:155], v[64:79]
  ds_read_b64_tr_b16 v[112:113], v240 offset:0
  ds_read_b64_tr_b16 v[114:115], v240 offset:3072
  s_waitcnt lgkmcnt(10)
  v_mfma_f32_32x32x16_bf16 v[80:95], v[116:119], v[152:155], v[80:95]
  ds_read_b64_tr_b16 v[116:117], v241 offset:0
  ds_read_b64_tr_b16 v[118:119], v241 offset:3072
  s_waitcnt lgkmcnt(10)
  v_mfma_f32_32x32x16_bf16 v[96:111], v[120:123], v[152:155], v[96:111]
  ds_read_b64_tr_b16 v[120:121], v242 offset:0
  ds_read_b64_tr_b16 v[122:123], v242 offset:3072
  s_waitcnt lgkmcnt(10)
  v_mfma_f32_32x32x16_bf16 v[64:79], v[124:127], v[156:159], v[64:79]
  ds_read_b64_tr_b16 v[124:125], v240 offset:6144
  ds_read_b64_tr_b16 v[126:127], v240 offset:9216
  s_waitcnt lgkmcnt(10)
  v_mfma_f32_32x32x16_bf16 v[80:95], v[192:195], v[156:159], v[80:95]
  ds_read_b64_tr_b16 v[192:193], v241 offset:6144
  ds_read_b64_tr_b16 v[194:195], v241 offset:9216
  s_waitcnt lgkmcnt(10)
  v_mfma_f32_32x32x16_bf16 v[96:111], v[196:199], v[156:159], v[96:111]
  ds_read_b64_tr_b16 v[196:197], v242 offset:6144
  ds_read_b64_tr_b16 v[198:199], v242 offset:9216
  s_waitcnt vmcnt(3)
  s_barrier
  s_waitcnt lgkmcnt(10)
  v_mfma_f32_32x32x16_bf16 v[64:79], v[112:115], v[208:211], v[64:79]
  ds_read_b64_tr_b16 v[112:113], v240 offset:12288
  ds_read_b64_tr_b16 v[114:115], v240 offset:15360
  s_waitcnt lgkmcnt(10)
  v_mfma_f32_32x32x16_bf16 v[80:95], v[116:119], v[208:211], v[80:95]
  ds_read_b64_tr_b16 v[116:117], v241 offset:12288
  ds_read_b64_tr_b16 v[118:119], v241 offset:15360
  s_add_u32 m0, s70, 73728
  s_add_u32 s60, s69, 74112
  s_add_u32 s60, s60, s11
  s_add_u32 s60, s60, s3
  buffer_load_dwordx4 v246, s[32:35], s60 offen offset:0 lds
  buffer_load_dwordx4 v247, s[32:35], s60 offen offset:1024 lds
  buffer_load_dwordx4 v248, s[32:35], s60 offen offset:2048 lds
  s_waitcnt lgkmcnt(10)
  v_mfma_f32_32x32x16_bf16 v[96:111], v[120:123], v[208:211], v[96:111]
  ds_read_b64_tr_b16 v[120:121], v242 offset:12288
  ds_read_b64_tr_b16 v[122:123], v242 offset:15360
  s_waitcnt lgkmcnt(10)
  v_mfma_f32_32x32x16_bf16 v[64:79], v[124:127], v[212:215], v[64:79]
  ds_read_b64_tr_b16 v[124:125], v240 offset:18432
  ds_read_b64_tr_b16 v[126:127], v240 offset:21504
  s_waitcnt lgkmcnt(10)
  v_mfma_f32_32x32x16_bf16 v[80:95], v[192:195], v[212:215], v[80:95]
  ds_read_b64_tr_b16 v[192:193], v241 offset:18432
  ds_read_b64_tr_b16 v[194:195], v241 offset:21504
  s_waitcnt lgkmcnt(10)
  v_mfma_f32_32x32x16_bf16 v[96:111], v[196:199], v[212:215], v[96:111]
  ds_read_b64_tr_b16 v[196:197], v242 offset:18432
  ds_read_b64_tr_b16 v[198:199], v242 offset:21504
  s_waitcnt lgkmcnt(10)
  v_mfma_f32_32x32x16_bf16 v[64:79], v[112:115], v[216:219], v[64:79]
  ds_read_b64_tr_b16 v[112:113], v240 offset:24576
  ds_read_b64_tr_b16 v[114:115], v240 offset:27648
  s_waitcnt lgkmcnt(10)
  v_mfma_f32_32x32x16_bf16 v[80:95], v[116:119], v[216:219], v[80:95]
  ds_read_b64_tr_b16 v[116:117], v241 offset:24576
  ds_read_b64_tr_b16 v[118:119], v241 offset:27648
  s_waitcnt lgkmcnt(10)
  v_mfma_f32_32x32x16_bf16 v[96:111], v[120:123], v[216:219], v[96:111]
  ds_read_b64_tr_b16 v[120:121], v242 offset:24576
  ds_read_b64_tr_b16 v[122:123], v242 offset:27648
  s_waitcnt lgkmcnt(10)
  v_mfma_f32_32x32x16_bf16 v[64:79], v[124:127], v[220:223], v[64:79]
  ds_read_b64_tr_b16 v[124:125], v240 offset:30720
  ds_read_b64_tr_b16 v[126:127], v240 offset:33792
  s_waitcnt lgkmcnt(10)
  v_mfma_f32_32x32x16_bf16 v[80:95], v[192:195], v[220:223], v[80:95]
  ds_read_b64_tr_b16 v[192:193], v241 offset:30720
  ds_read_b64_tr_b16 v[194:195], v241 offset:33792
  s_waitcnt lgkmcnt(10)
  v_mfma_f32_32x32x16_bf16 v[96:111], v[196:199], v[220:223], v[96:111]
  ds_read_b64_tr_b16 v[196:197], v242 offset:30720
  ds_read_b64_tr_b16 v[198:199], v242 offset:33792
  s_waitcnt vmcnt(3)
  s_barrier
  s_waitcnt lgkmcnt(10)
  v_mfma_f32_32x32x16_bf16 v[64:79], v[112:115], v[224:227], v[64:79]
  ds_read_b64_tr_b16 v[112:113], v240 offset:36864
  ds_read_b64_tr_b16 v[114:115], v240 offset:39936
  s_waitcnt lgkmcnt(10)
  v_mfma_f32_32x32x16_bf16 v[80:95], v[116:119], v[224:227], v[80:95]
  ds_read_b64_tr_b16 v[116:117], v241 offset:36864
  ds_read_b64_tr_b16 v[118:119], v241 offset:39936
  s_add_u32 m0, s70, 0
  s_add_u32 s60, s69, 384
  s_add_u32 s60, s60, s11
  s_sub_u32 s60, s60, s3
  s_add_u32 s60, s60, 147456
  buffer_load_dwordx4 v246, s[32:35], s60 offen offset:0 lds
  buffer_load_dwordx4 v247, s[32:35], s60 offen offset:1024 lds
  buffer_load_dwordx4 v248, s[32:35], s60 offen offset:2048 lds
  s_waitcnt lgkmcnt(10)
  v_mfma_f32_32x32x16_bf16 v[96:111], v[120:123], v[224:227], v[96:111]
  ds_read_b64_tr_b16 v[120:121], v242 offset:36864
  ds_read_b64_tr_b16 v[122:123], v242 offset:39936
  s_waitcnt lgkmcnt(10)
  v_mfma_f32_32x32x16_bf16 v[64:79], v[124:127], v[228:231], v[64:79]
  ds_read_b64_tr_b16 v[124:125], v240 offset:43008
  ds_read_b64_tr_b16 v[126:127], v240 offset:46080
  s_waitcnt lgkmcnt(10)
  v_mfma_f32_32x32x16_bf16 v[80:95], v[192:195], v[228:231], v[80:95]
  ds_read_b64_tr_b16 v[192:193], v241 offset:43008
  ds_read_b64_tr_b16 v[194:195], v241 offset:46080
  s_waitcnt lgkmcnt(10)
  v_mfma_f32_32x32x16_bf16 v[96:111], v[196:199], v[228:231], v[96:111]
  ds_read_b64_tr_b16 v[196:197], v242 offset:43008
  ds_read_b64_tr_b16 v[198:199], v242 offset:46080
  s_waitcnt lgkmcnt(10)
  v_mfma_f32_32x32x16_bf16 v[64:79], v[112:115], v[232:235], v[64:79]
  ds_read_b64_tr_b16 v[112:113], v243 offset:0
  ds_read_b64_tr_b16 v[114:115], v243 offset:3072
  s_waitcnt lgkmcnt(10)
  v_mfma_f32_32x32x16_bf16 v[80:95], v[116:119], v[232:235], v[80:95]
  ds_read_b64_tr_b16 v[116:117], v244 offset:0
  ds_read_b64_tr_b16 v[118:119], v244 offset:3072
  s_waitcnt lgkmcnt(10)
  v_mfma_f32_32x32x16_bf16 v[96:111], v[120:123], v[232:235], v[96:111]
  ds_read_b64_tr_b16 v[120:121], v245 offset:0
  ds_read_b64_tr_b16 v[122:123], v245 offset:3072
  s_waitcnt lgkmcnt(10)
  v_mfma_f32_32x32x16_bf16 v[64:79], v[124:127], v[236:239], v[64:79]
  ds_read_b64_tr_b16 v[124:125], v243 offset:6144
  ds_read_b64_tr_b16 v[126:127], v243 offset:9216
  s_waitcnt lgkmcnt(10)
  v_mfma_f32_32x32x16_bf16 v[80:95], v[192:195], v[236:239], v[80:95]
  ds_read_b64_tr_b16 v[192:193], v244 offset:6144
  ds_read_b64_tr_b16 v[194:195], v244 offset:9216
  s_waitcnt lgkmcnt(10)
  v_mfma_f32_32x32x16_bf16 v[96:111], v[196:199], v[236:239], v[96:111]
  ds_read_b64_tr_b16 v[196:197], v245 offset:6144
  ds_read_b64_tr_b16 v[198:199], v245 offset:9216
  s_waitcnt vmcnt(3)
  s_barrier
  s_waitcnt lgkmcnt(10)
  v_mfma_f32_32x32x16_bf16 v[64:79], v[112:115], v[160:163], v[64:79]
  ds_read_b64_tr_b16 v[112:113], v243 offset:12288
  ds_read_b64_tr_b16 v[114:115], v243 offset:15360
  s_waitcnt lgkmcnt(10)
  v_mfma_f32_32x32x16_bf16 v[80:95], v[116:119], v[160:163], v[80:95]
  ds_read_b64_tr_b16 v[116:117], v244 offset:12288
  ds_read_b64_tr_b16 v[118:119], v244 offset:15360
  s_add_u32 m0, s70, 24576
  s_add_u32 s60, s69, 74112
  s_add_u32 s60, s60, s11
  s_sub_u32 s60, s60, s3
  s_add_u32 s60, s60, 147456
  buffer_load_dwordx4 v246, s[32:35], s60 offen offset:0 lds
  buffer_load_dwordx4 v247, s[32:35], s60 offen offset:1024 lds
  buffer_load_dwordx4 v248, s[32:35], s60 offen offset:2048 lds
  s_waitcnt lgkmcnt(10)
  v_mfma_f32_32x32x16_bf16 v[96:111], v[120:123], v[160:163], v[96:111]
  ds_read_b64_tr_b16 v[120:121], v245 offset:12288
  ds_read_b64_tr_b16 v[122:123], v245 offset:15360
  s_waitcnt lgkmcnt(10)
  v_mfma_f32_32x32x16_bf16 v[64:79], v[124:127], v[164:167], v[64:79]
  ds_read_b64_tr_b16 v[124:125], v243 offset:18432
  ds_read_b64_tr_b16 v[126:127], v243 offset:21504
  s_waitcnt lgkmcnt(10)
  v_mfma_f32_32x32x16_bf16 v[80:95], v[192:195], v[164:167], v[80:95]
  ds_read_b64_tr_b16 v[192:193], v244 offset:18432
  ds_read_b64_tr_b16 v[194:195], v244 offset:21504
  s_waitcnt lgkmcnt(10)
  v_mfma_f32_32x32x16_bf16 v[96:111], v[196:199], v[164:167], v[96:111]
  ds_read_b64_tr_b16 v[196:197], v245 offset:18432
  ds_read_b64_tr_b16 v[198:199], v245 offset:21504
  s_waitcnt lgkmcnt(10)
  v_mfma_f32_32x32x16_bf16 v[64:79], v[112:115], v[168:171], v[64:79]
  ds_read_b64_tr_b16 v[112:113], v243 offset:24576
  ds_read_b64_tr_b16 v[114:115], v243 offset:27648
  s_waitcnt lgkmcnt(10)
  v_mfma_f32_32x32x16_bf16 v[80:95], v[116:119], v[168:171], v[80:95]
  ds_read_b64_tr_b16 v[116:117], v244 offset:24576
  ds_read_b64_tr_b16 v[118:119], v244 offset:27648
  s_waitcnt lgkmcnt(10)
  v_mfma_f32_32x32x16_bf16 v[96:111], v[120:123], v[168:171], v[96:111]
  ds_read_b64_tr_b16 v[120:121], v245 offset:24576
  ds_read_b64_tr_b16 v[122:123], v245 offset:27648
  s_waitcnt lgkmcnt(10)
  v_mfma_f32_32x32x16_bf16 v[64:79], v[124:127], v[172:175], v[64:79]
  ds_read_b64_tr_b16 v[124:125], v243 offset:30720
  ds_read_b64_tr_b16 v[126:127], v243 offset:33792
  s_waitcnt lgkmcnt(10)
  v_mfma_f32_32x32x16_bf16 v[80:95], v[192:195], v[172:175], v[80:95]
  ds_read_b64_tr_b16 v[192:193], v244 offset:30720
  ds_read_b64_tr_b16 v[194:195], v244 offset:33792
  s_waitcnt lgkmcnt(10)
  v_mfma_f32_32x32x16_bf16 v[96:111], v[196:199], v[172:175], v[96:111]
  ds_read_b64_tr_b16 v[196:197], v245 offset:30720
  ds_read_b64_tr_b16 v[198:199], v245 offset:33792
  s_waitcnt vmcnt(3)
  s_barrier
  s_waitcnt lgkmcnt(10)
  v_mfma_f32_32x32x16_bf16 v[64:79], v[112:115], v[176:179], v[64:79]
  ds_read_b64_tr_b16 v[112:113], v243 offset:36864
  ds_read_b64_tr_b16 v[114:115], v243 offset:39936
  s_waitcnt lgkmcnt(10)
  v_mfma_f32_32x32x16_bf16 v[80:95], v[116:119], v[176:179], v[80:95]
  ds_read_b64_tr_b16 v[116:117], v244 offset:36864
  ds_read_b64_tr_b16 v[118:119], v244 offset:39936
  s_add_u32 m0, s70, 49152
  s_add_u32 s60, s69, 768
  s_add_u32 s60, s60, s3
  buffer_load_dwordx4 v246, s[32:35], s60 offen offset:0 lds
  buffer_load_dwordx4 v247, s[32:35], s60 offen offset:1024 lds
  buffer_load_dwordx4 v248, s[32:35], s60 offen offset:2048 lds
  s_waitcnt lgkmcnt(10)
  v_mfma_f32_32x32x16_bf16 v[96:111], v[120:123], v[176:179], v[96:111]
  ds_read_b64_tr_b16 v[120:121], v245 offset:36864
  ds_read_b64_tr_b16 v[122:123], v245 offset:39936
  s_waitcnt lgkmcnt(10)
  v_mfma_f32_32x32x16_bf16 v[64:79], v[124:127], v[180:183], v[64:79]
  ds_read_b64_tr_b16 v[124:125], v243 offset:43008
  ds_read_b64_tr_b16 v[126:127], v243 offset:46080
  s_waitcnt lgkmcnt(10)
  v_mfma_f32_32x32x16_bf16 v[80:95], v[192:195], v[180:183], v[80:95]
  ds_read_b64_tr_b16 v[192:193], v244 offset:43008
  ds_read_b64_tr_b16 v[194:195], v244 offset:46080
  s_waitcnt lgkmcnt(10)
  v_mfma_f32_32x32x16_bf16 v[96:111], v[196:199], v[180:183], v[96:111]
  ds_read_b64_tr_b16 v[196:197], v245 offset:43008
  ds_read_b64_tr_b16 v[198:199], v245 offset:46080
  s_waitcnt lgkmcnt(10)
  v_mfma_f32_32x32x16_bf16 v[64:79], v[112:115], v[184:187], v[64:79]
  ds_read_b64_tr_b16 v[112:113], v240 offset:0
  ds_read_b64_tr_b16 v[114:115], v240 offset:3072
  s_waitcnt lgkmcnt(10)
  v_mfma_f32_32x32x16_bf16 v[80:95], v[116:119], v[184:187], v[80:95]
  ds_read_b64_tr_b16 v[116:117], v241 offset:0
  ds_read_b64_tr_b16 v[118:119], v241 offset:3072
  s_waitcnt lgkmcnt(10)
  v_mfma_f32_32x32x16_bf16 v[96:111], v[120:123], v[184:187], v[96:111]
  ds_read_b64_tr_b16 v[120:121], v242 offset:0
  ds_read_b64_tr_b16 v[122:123], v242 offset:3072
  s_waitcnt lgkmcnt(10)
  v_mfma_f32_32x32x16_bf16 v[64:79], v[124:127], v[188:191], v[64:79]
  ds_read_b64_tr_b16 v[124:125], v240 offset:6144
  ds_read_b64_tr_b16 v[126:127], v240 offset:9216
  s_waitcnt lgkmcnt(10)
  v_mfma_f32_32x32x16_bf16 v[80:95], v[192:195], v[188:191], v[80:95]
  ds_read_b64_tr_b16 v[192:193], v241 offset:6144
  ds_read_b64_tr_b16 v[194:195], v241 offset:9216
  s_waitcnt lgkmcnt(10)
  v_mfma_f32_32x32x16_bf16 v[96:111], v[196:199], v[188:191], v[96:111]
  ds_read_b64_tr_b16 v[196:197], v242 offset:6144
  ds_read_b64_tr_b16 v[198:199], v242 offset:9216
  s_waitcnt vmcnt(3)
  s_barrier
  s_waitcnt lgkmcnt(10)
  v_mfma_f32_32x32x16_bf16 v[64:79], v[112:115], v[32:35], v[64:79]
  ds_read_b64_tr_b16 v[112:113], v240 offset:12288
  ds_read_b64_tr_b16 v[114:115], v240 offset:15360
  s_waitcnt lgkmcnt(10)
  v_mfma_f32_32x32x16_bf16 v[80:95], v[116:119], v[32:35], v[80:95]
  ds_read_b64_tr_b16 v[116:117], v241 offset:12288
  ds_read_b64_tr_b16 v[118:119], v241 offset:15360
  s_add_u32 m0, s70, 73728
  s_add_u32 s60, s69, 74496
  s_add_u32 s60, s60, s3
  buffer_load_dwordx4 v246, s[32:35], s60 offen offset:0 lds
  buffer_load_dwordx4 v247, s[32:35], s60 offen offset:1024 lds
  buffer_load_dwordx4 v248, s[32:35], s60 offen offset:2048 lds
  s_waitcnt lgkmcnt(10)
  v_mfma_f32_32x32x16_bf16 v[96:111], v[120:123], v[32:35], v[96:111]
  ds_read_b64_tr_b16 v[120:121], v242 offset:12288
  ds_read_b64_tr_b16 v[122:123], v242 offset:15360
  s_waitcnt lgkmcnt(10)
  v_mfma_f32_32x32x16_bf16 v[64:79], v[124:127], v[36:39], v[64:79]
  ds_read_b64_tr_b16 v[124:125], v240 offset:18432
  ds_read_b64_tr_b16 v[126:127], v240 offset:21504
  s_waitcnt lgkmcnt(10)
  v_mfma_f32_32x32x16_bf16 v[80:95], v[192:195], v[36:39], v[80:95]
  ds_read_b64_tr_b16 v[192:193], v241 offset:18432
  ds_read_b64_tr_b16 v[194:195], v241 offset:21504
  s_waitcnt lgkmcnt(10)
  v_mfma_f32_32x32x16_bf16 v[96:111], v[196:199], v[36:39], v[96:111]
  ds_read_b64_tr_b16 v[196:197], v242 offset:18432
  ds_read_b64_tr_b16 v[198:199], v242 offset:21504
  s_waitcnt lgkmcnt(10)
  v_mfma_f32_32x32x16_bf16 v[64:79], v[112:115], v[40:43], v[64:79]
  ds_read_b64_tr_b16 v[112:113], v240 offset:24576
  ds_read_b64_tr_b16 v[114:115], v240 offset:27648
  s_waitcnt lgkmcnt(10)
  v_mfma_f32_32x32x16_bf16 v[80:95], v[116:119], v[40:43], v[80:95]
  ds_read_b64_tr_b16 v[116:117], v241 offset:24576
  ds_read_b64_tr_b16 v[118:119], v241 offset:27648
  s_waitcnt lgkmcnt(10)
  v_mfma_f32_32x32x16_bf16 v[96:111], v[120:123], v[40:43], v[96:111]
  ds_read_b64_tr_b16 v[120:121], v242 offset:24576
  ds_read_b64_tr_b16 v[122:123], v242 offset:27648
  s_waitcnt lgkmcnt(10)
  v_mfma_f32_32x32x16_bf16 v[64:79], v[124:127], v[44:47], v[64:79]
  ds_read_b64_tr_b16 v[124:125], v240 offset:30720
  ds_read_b64_tr_b16 v[126:127], v240 offset:33792
  s_waitcnt lgkmcnt(10)
  v_mfma_f32_32x32x16_bf16 v[80:95], v[192:195], v[44:47], v[80:95]
  ds_read_b64_tr_b16 v[192:193], v241 offset:30720
  ds_read_b64_tr_b16 v[194:195], v241 offset:33792
  s_waitcnt lgkmcnt(10)
  v_mfma_f32_32x32x16_bf16 v[96:111], v[196:199], v[44:47], v[96:111]
  ds_read_b64_tr_b16 v[196:197], v242 offset:30720
  ds_read_b64_tr_b16 v[198:199], v242 offset:33792
  s_waitcnt vmcnt(3)
  s_barrier
  s_waitcnt lgkmcnt(10)
  v_mfma_f32_32x32x16_bf16 v[64:79], v[112:115], v[48:51], v[64:79]
  ds_read_b64_tr_b16 v[112:113], v240 offset:36864
  ds_read_b64_tr_b16 v[114:115], v240 offset:39936
  s_waitcnt lgkmcnt(10)
  v_mfma_f32_32x32x16_bf16 v[80:95], v[116:119], v[48:51], v[80:95]
  ds_read_b64_tr_b16 v[116:117], v241 offset:36864
  ds_read_b64_tr_b16 v[118:119], v241 offset:39936
  s_add_u32 m0, s70, 0
  s_add_u32 s60, s69, 768
  s_sub_u32 s60, s60, s3
  s_add_u32 s60, s60, 147456
  buffer_load_dwordx4 v246, s[32:35], s60 offen offset:0 lds
  buffer_load_dwordx4 v247, s[32:35], s60 offen offset:1024 lds
  buffer_load_dwordx4 v248, s[32:35], s60 offen offset:2048 lds
  s_waitcnt lgkmcnt(10)
  v_mfma_f32_32x32x16_bf16 v[96:111], v[120:123], v[48:51], v[96:111]
  ds_read_b64_tr_b16 v[120:121], v242 offset:36864
  ds_read_b64_tr_b16 v[122:123], v242 offset:39936
  s_waitcnt lgkmcnt(10)
  v_mfma_f32_32x32x16_bf16 v[64:79], v[124:127], v[52:55], v[64:79]
  ds_read_b64_tr_b16 v[124:125], v240 offset:43008
  ds_read_b64_tr_b16 v[126:127], v240 offset:46080
  s_waitcnt lgkmcnt(10)
  v_mfma_f32_32x32x16_bf16 v[80:95], v[192:195], v[52:55], v[80:95]
  ds_read_b64_tr_b16 v[192:193], v241 offset:43008
  ds_read_b64_tr_b16 v[194:195], v241 offset:46080
  s_waitcnt lgkmcnt(10)
  v_mfma_f32_32x32x16_bf16 v[96:111], v[196:199], v[52:55], v[96:111]
  ds_read_b64_tr_b16 v[196:197], v242 offset:43008
  ds_read_b64_tr_b16 v[198:199], v242 offset:46080
  s_waitcnt lgkmcnt(10)
  v_mfma_f32_32x32x16_bf16 v[64:79], v[112:115], v[56:59], v[64:79]
  ds_read_b64_tr_b16 v[112:113], v243 offset:0
  ds_read_b64_tr_b16 v[114:115], v243 offset:3072
  s_waitcnt lgkmcnt(10)
  v_mfma_f32_32x32x16_bf16 v[80:95], v[116:119], v[56:59], v[80:95]
  ds_read_b64_tr_b16 v[116:117], v244 offset:0
  ds_read_b64_tr_b16 v[118:119], v244 offset:3072
  s_waitcnt lgkmcnt(10)
  v_mfma_f32_32x32x16_bf16 v[96:111], v[120:123], v[56:59], v[96:111]
  ds_read_b64_tr_b16 v[120:121], v245 offset:0
  ds_read_b64_tr_b16 v[122:123], v245 offset:3072
  s_waitcnt lgkmcnt(10)
  v_mfma_f32_32x32x16_bf16 v[64:79], v[124:127], v[60:63], v[64:79]
  ds_read_b64_tr_b16 v[124:125], v243 offset:6144
  ds_read_b64_tr_b16 v[126:127], v243 offset:9216
  s_waitcnt lgkmcnt(10)
  v_mfma_f32_32x32x16_bf16 v[80:95], v[192:195], v[60:63], v[80:95]
  ds_read_b64_tr_b16 v[192:193], v244 offset:6144
  ds_read_b64_tr_b16 v[194:195], v244 offset:9216
  s_waitcnt lgkmcnt(10)
  v_mfma_f32_32x32x16_bf16 v[96:111], v[196:199], v[60:63], v[96:111]
  ds_read_b64_tr_b16 v[196:197], v245 offset:6144
  ds_read_b64_tr_b16 v[198:199], v245 offset:9216
  s_nop 15
  s_nop 3
  v_cvt_pk_bf16_f32 v12, v64, v65
  v_cvt_pk_bf16_f32 v13, v66, v67
  v_cvt_pk_bf16_f32 v14, v68, v69
  v_cvt_pk_bf16_f32 v15, v70, v71
  v_cvt_pk_bf16_f32 v16, v72, v73
  v_cvt_pk_bf16_f32 v17, v74, v75
  v_cvt_pk_bf16_f32 v18, v76, v77
  v_cvt_pk_bf16_f32 v19, v78, v79
  s_add_u32 s60, s71, 36864
  buffer_store_dwordx4 v[12:15], v249, s[36:39], s60 offen offset:0 sc1
  buffer_store_dwordx4 v[16:19], v249, s[36:39], s60 offen offset:1024 sc1
  v_cvt_pk_bf16_f32 v20, v80, v81
  v_cvt_pk_bf16_f32 v21, v82, v83
  v_cvt_pk_bf16_f32 v22, v84, v85
  v_cvt_pk_bf16_f32 v23, v86, v87
  v_cvt_pk_bf16_f32 v24, v88, v89
  v_cvt_pk_bf16_f32 v25, v90, v91
  v_cvt_pk_bf16_f32 v26, v92, v93
  v_cvt_pk_bf16_f32 v27, v94, v95
  s_add_u32 s60, s71, 43008
  buffer_store_dwordx4 v[20:23], v249, s[36:39], s60 offen offset:0 sc1
  buffer_store_dwordx4 v[24:27], v249, s[36:39], s60 offen offset:1024 sc1
  v_cvt_pk_bf16_f32 v12, v96, v97
  v_cvt_pk_bf16_f32 v13, v98, v99
  v_cvt_pk_bf16_f32 v14, v100, v101
  v_cvt_pk_bf16_f32 v15, v102, v103
  v_cvt_pk_bf16_f32 v16, v104, v105
  v_cvt_pk_bf16_f32 v17, v106, v107
  v_cvt_pk_bf16_f32 v18, v108, v109
  v_cvt_pk_bf16_f32 v19, v110, v111
  s_add_u32 s60, s71, 49152
  buffer_store_dwordx4 v[12:15], v249, s[36:39], s60 offen offset:0 sc1
  buffer_store_dwordx4 v[16:19], v249, s[36:39], s60 offen offset:1024 sc1
  s_waitcnt vmcnt(9)
  s_barrier
  s_waitcnt lgkmcnt(10)
  v_mfma_f32_32x32x16_bf16 v[64:79], v[112:115], v[128:131], 0
  ds_read_b64_tr_b16 v[112:113], v243 offset:12288
  ds_read_b64_tr_b16 v[114:115], v243 offset:15360
  s_waitcnt lgkmcnt(10)
  v_mfma_f32_32x32x16_bf16 v[80:95], v[116:119], v[128:131], 0
  ds_read_b64_tr_b16 v[116:117], v244 offset:12288
  ds_read_b64_tr_b16 v[118:119], v244 offset:15360
  s_add_u32 m0, s70, 24576
  s_add_u32 s60, s69, 74496
  s_sub_u32 s60, s60, s3
  s_add_u32 s60, s60, 147456
  buffer_load_dwordx4 v246, s[32:35], s60 offen offset:0 lds
  buffer_load_dwordx4 v247, s[32:35], s60 offen offset:1024 lds
  buffer_load_dwordx4 v248, s[32:35], s60 offen offset:2048 lds
  s_waitcnt lgkmcnt(10)
  v_mfma_f32_32x32x16_bf16 v[96:111], v[120:123], v[128:131], 0
  ds_read_b64_tr_b16 v[120:121], v245 offset:12288
  ds_read_b64_tr_b16 v[122:123], v245 offset:15360
  s_waitcnt lgkmcnt(10)
  v_mfma_f32_32x32x16_bf16 v[64:79], v[124:127], v[132:135], v[64:79]
  ds_read_b64_tr_b16 v[124:125], v243 offset:18432
  ds_read_b64_tr_b16 v[126:127], v243 offset:21504
  s_waitcnt lgkmcnt(10)
  v_mfma_f32_32x32x16_bf16 v[80:95], v[192:195], v[132:135], v[80:95]
  ds_read_b64_tr_b16 v[192:193], v244 offset:18432
  ds_read_b64_tr_b16 v[194:195], v244 offset:21504
  s_waitcnt lgkmcnt(10)
  v_mfma_f32_32x32x16_bf16 v[96:111], v[196:199], v[132:135], v[96:111]
  ds_read_b64_tr_b16 v[196:197], v245 offset:18432
  ds_read_b64_tr_b16 v[198:199], v245 offset:21504
  s_waitcnt lgkmcnt(10)
  v_mfma_f32_32x32x16_bf16 v[64:79], v[112:115], v[136:139], v[64:79]
  ds_read_b64_tr_b16 v[112:113], v243 offset:24576
  ds_read_b64_tr_b16 v[114:115], v243 offset:27648
  s_waitcnt lgkmcnt(10)
  v_mfma_f32_32x32x16_bf16 v[80:95], v[116:119], v[136:139], v[80:95]
  ds_read_b64_tr_b16 v[116:117], v244 offset:24576
  ds_read_b64_tr_b16 v[118:119], v244 offset:27648
  s_waitcnt lgkmcnt(10)
  v_mfma_f32_32x32x16_bf16 v[96:111], v[120:123], v[136:139], v[96:111]
  ds_read_b64_tr_b16 v[120:121], v245 offset:24576
  ds_read_b64_tr_b16 v[122:123], v245 offset:27648
  s_waitcnt lgkmcnt(10)
  v_mfma_f32_32x32x16_bf16 v[64:79], v[124:127], v[140:143], v[64:79]
  ds_read_b64_tr_b16 v[124:125], v243 offset:30720
  ds_read_b64_tr_b16 v[126:127], v243 offset:33792
  s_waitcnt lgkmcnt(10)
  v_mfma_f32_32x32x16_bf16 v[80:95], v[192:195], v[140:143], v[80:95]
  ds_read_b64_tr_b16 v[192:193], v244 offset:30720
  ds_read_b64_tr_b16 v[194:195], v244 offset:33792
  s_waitcnt lgkmcnt(10)
  v_mfma_f32_32x32x16_bf16 v[96:111], v[196:199], v[140:143], v[96:111]
  ds_read_b64_tr_b16 v[196:197], v245 offset:30720
  ds_read_b64_tr_b16 v[198:199], v245 offset:33792
  s_waitcnt vmcnt(9)
  s_barrier
  s_waitcnt lgkmcnt(10)
  v_mfma_f32_32x32x16_bf16 v[64:79], v[112:115], v[144:147], v[64:79]
  ds_read_b64_tr_b16 v[112:113], v243 offset:36864
  ds_read_b64_tr_b16 v[114:115], v243 offset:39936
  s_waitcnt lgkmcnt(10)
  v_mfma_f32_32x32x16_bf16 v[80:95], v[116:119], v[144:147], v[80:95]
  ds_read_b64_tr_b16 v[116:117], v244 offset:36864
  ds_read_b64_tr_b16 v[118:119], v244 offset:39936
  s_add_u32 m0, s70, 49152
  s_add_u32 s60, s69, 768
  s_add_u32 s60, s60, s11
  s_add_u32 s60, s60, s3
  buffer_load_dwordx4 v246, s[32:35], s60 offen offset:0 lds
  buffer_load_dwordx4 v247, s[32:35], s60 offen offset:1024 lds
  buffer_load_dwordx4 v248, s[32:35], s60 offen offset:2048 lds
  s_waitcnt lgkmcnt(10)
  v_mfma_f32_32x32x16_bf16 v[96:111], v[120:123], v[144:147], v[96:111]
  ds_read_b64_tr_b16 v[120:121], v245 offset:36864
  ds_read_b64_tr_b16 v[122:123], v245 offset:39936
  s_waitcnt lgkmcnt(10)
  v_mfma_f32_32x32x16_bf16 v[64:79], v[124:127], v[148:151], v[64:79]
  ds_read_b64_tr_b16 v[124:125], v243 offset:43008
  ds_read_b64_tr_b16 v[126:127], v243 offset:46080
  s_waitcnt lgkmcnt(10)
  v_mfma_f32_32x32x16_bf16 v[80:95], v[192:195], v[148:151], v[80:95]
  ds_read_b64_tr_b16 v[192:193], v244 offset:43008
  ds_read_b64_tr_b16 v[194:195], v244 offset:46080
  s_waitcnt lgkmcnt(10)
  v_mfma_f32_32x32x16_bf16 v[96:111], v[196:199], v[148:151], v[96:111]
  ds_read_b64_tr_b16 v[196:197], v245 offset:43008
  ds_read_b64_tr_b16 v[198:199], v245 offset:46080
  s_waitcnt lgkmcnt(10)
  v_mfma_f32_32x32x16_bf16 v[64:79], v[112:115], v[152:155], v[64:79]
  ds_read_b64_tr_b16 v[112:113], v240 offset:0
  ds_read_b64_tr_b16 v[114:115], v240 offset:3072
  s_waitcnt lgkmcnt(10)
  v_mfma_f32_32x32x16_bf16 v[80:95], v[116:119], v[152:155], v[80:95]
  ds_read_b64_tr_b16 v[116:117], v241 offset:0
  ds_read_b64_tr_b16 v[118:119], v241 offset:3072
  s_waitcnt lgkmcnt(10)
  v_mfma_f32_32x32x16_bf16 v[96:111], v[120:123], v[152:155], v[96:111]
  ds_read_b64_tr_b16 v[120:121], v242 offset:0
  ds_read_b64_tr_b16 v[122:123], v242 offset:3072
  s_waitcnt lgkmcnt(10)
  v_mfma_f32_32x32x16_bf16 v[64:79], v[124:127], v[156:159], v[64:79]
  ds_read_b64_tr_b16 v[124:125], v240 offset:6144
  ds_read_b64_tr_b16 v[126:127], v240 offset:9216
  s_waitcnt lgkmcnt(10)
  v_mfma_f32_32x32x16_bf16 v[80:95], v[192:195], v[156:159], v[80:95]
  ds_read_b64_tr_b16 v[192:193], v241 offset:6144
  ds_read_b64_tr_b16 v[194:195], v241 offset:9216
  s_waitcnt lgkmcnt(10)
  v_mfma_f32_32x32x16_bf16 v[96:111], v[196:199], v[156:159], v[96:111]
  ds_read_b64_tr_b16 v[196:197], v242 offset:6144
  ds_read_b64_tr_b16 v[198:199], v242 offset:9216
  s_waitcnt vmcnt(3)
  s_barrier
  s_waitcnt lgkmcnt(10)
  v_mfma_f32_32x32x16_bf16 v[64:79], v[112:115], v[208:211], v[64:79]
  ds_read_b64_tr_b16 v[112:113], v240 offset:12288
  ds_read_b64_tr_b16 v[114:115], v240 offset:15360
  s_waitcnt lgkmcnt(10)
  v_mfma_f32_32x32x16_bf16 v[80:95], v[116:119], v[208:211], v[80:95]
  ds_read_b64_tr_b16 v[116:117], v241 offset:12288
  ds_read_b64_tr_b16 v[118:119], v241 offset:15360
  s_add_u32 m0, s70, 73728
  s_add_u32 s60, s69, 74496
  s_add_u32 s60, s60, s11
  s_add_u32 s60, s60, s3
  buffer_load_dwordx4 v246, s[32:35], s60 offen offset:0 lds
  buffer_load_dwordx4 v247, s[32:35], s60 offen offset:1024 lds
  buffer_load_dwordx4 v248, s[32:35], s60 offen offset:2048 lds
  s_cmp_lg_u32 s51, 6
  s_cbranch_scc1 L_noflag_L_op3a
  v_mov_b32 v5, 1
  s_lshl_b64 exec, 1, s50
  global_store_dword v254, v5, s[14:15] sc1
  s_mov_b64 exec, -1
L_noflag_L_op3a:
  s_waitcnt lgkmcnt(10)
  v_mfma_f32_32x32x16_bf16 v[96:111], v[120:123], v[208:211], v[96:111]
  ds_read_b64_tr_b16 v[120:121], v242 offset:12288
  ds_read_b64_tr_b16 v[122:123], v242 offset:15360
  s_waitcnt lgkmcnt(10)
  v_mfma_f32_32x32x16_bf16 v[64:79], v[124:127], v[212:215], v[64:79]
  ds_read_b64_tr_b16 v[124:125], v240 offset:18432
  ds_read_b64_tr_b16 v[126:127], v240 offset:21504
  s_waitcnt lgkmcnt(10)
  v_mfma_f32_32x32x16_bf16 v[80:95], v[192:195], v[212:215], v[80:95]
  ds_read_b64_tr_b16 v[192:193], v241 offset:18432
  ds_read_b64_tr_b16 v[194:195], v241 offset:21504
  s_waitcnt lgkmcnt(10)
  v_mfma_f32_32x32x16_bf16 v[96:111], v[196:199], v[212:215], v[96:111]
  ds_read_b64_tr_b16 v[196:197], v242 offset:18432
  ds_read_b64_tr_b16 v[198:199], v242 offset:21504
  s_waitcnt lgkmcnt(10)
  v_mfma_f32_32x32x16_bf16 v[64:79], v[112:115], v[216:219], v[64:79]
  ds_read_b64_tr_b16 v[112:113], v240 offset:24576
  ds_read_b64_tr_b16 v[114:115], v240 offset:27648
  s_waitcnt lgkmcnt(10)
  v_mfma_f32_32x32x16_bf16 v[80:95], v[116:119], v[216:219], v[80:95]
  ds_read_b64_tr_b16 v[116:117], v241 offset:24576
  ds_read_b64_tr_b16 v[118:119], v241 offset:27648
  s_waitcnt lgkmcnt(10)
  v_mfma_f32_32x32x16_bf16 v[96:111], v[120:123], v[216:219], v[96:111]
  ds_read_b64_tr_b16 v[120:121], v242 offset:24576
  ds_read_b64_tr_b16 v[122:123], v242 offset:27648
  s_waitcnt lgkmcnt(10)
  v_mfma_f32_32x32x16_bf16 v[64:79], v[124:127], v[220:223], v[64:79]
  ds_read_b64_tr_b16 v[124:125], v240 offset:30720
  ds_read_b64_tr_b16 v[126:127], v240 offset:33792
  s_waitcnt lgkmcnt(10)
  v_mfma_f32_32x32x16_bf16 v[80:95], v[192:195], v[220:223], v[80:95]
  ds_read_b64_tr_b16 v[192:193], v241 offset:30720
  ds_read_b64_tr_b16 v[194:195], v241 offset:33792
  s_waitcnt lgkmcnt(10)
  v_mfma_f32_32x32x16_bf16 v[96:111], v[196:199], v[220:223], v[96:111]
  ds_read_b64_tr_b16 v[196:197], v242 offset:30720
  ds_read_b64_tr_b16 v[198:199], v242 offset:33792
  s_waitcnt vmcnt(3)
  s_barrier
  s_waitcnt lgkmcnt(10)
  v_mfma_f32_32x32x16_bf16 v[64:79], v[112:115], v[224:227], v[64:79]
  ds_read_b64_tr_b16 v[112:113], v240 offset:36864
  ds_read_b64_tr_b16 v[114:115], v240 offset:39936
  s_waitcnt lgkmcnt(10)
  v_mfma_f32_32x32x16_bf16 v[80:95], v[116:119], v[224:227], v[80:95]
  ds_read_b64_tr_b16 v[116:117], v241 offset:36864
  ds_read_b64_tr_b16 v[118:119], v241 offset:39936
  s_add_u32 m0, s70, 0
  s_add_u32 s60, s69, 768
  s_add_u32 s60, s60, s11
  s_sub_u32 s60, s60, s3
  s_add_u32 s60, s60, 147456
  buffer_load_dwordx4 v246, s[32:35], s60 offen offset:0 lds
  buffer_load_dwordx4 v247, s[32:35], s60 offen offset:1024 lds
  buffer_load_dwordx4 v248, s[32:35], s60 offen offset:2048 lds
  s_waitcnt lgkmcnt(10)
  v_mfma_f32_32x32x16_bf16 v[96:111], v[120:123], v[224:227], v[96:111]
  ds_read_b64_tr_b16 v[120:121], v242 offset:36864
  ds_read_b64_tr_b16 v[122:123], v242 offset:39936
  s_waitcnt lgkmcnt(10)
  v_mfma_f32_32x32x16_bf16 v[64:79], v[124:127], v[228:231], v[64:79]
  ds_read_b64_tr_b16 v[124:125], v240 offset:43008
  ds_read_b64_tr_b16 v[126:127], v240 offset:46080
  s_waitcnt lgkmcnt(10)
  v_mfma_f32_32x32x16_bf16 v[80:95], v[192:195], v[228:231], v[80:95]
  ds_read_b64_tr_b16 v[192:193], v241 offset:43008
  ds_read_b64_tr_b16 v[194:195], v241 offset:46080
  s_waitcnt lgkmcnt(10)
  v_mfma_f32_32x32x16_bf16 v[96:111], v[196:199], v[228:231], v[96:111]
  ds_read_b64_tr_b16 v[196:197], v242 offset:43008
  ds_read_b64_tr_b16 v[198:199], v242 offset:46080
  s_waitcnt lgkmcnt(10)
  v_mfma_f32_32x32x16_bf16 v[64:79], v[112:115], v[232:235], v[64:79]
  ds_read_b64_tr_b16 v[112:113], v243 offset:0
  ds_read_b64_tr_b16 v[114:115], v243 offset:3072
  s_waitcnt lgkmcnt(10)
  v_mfma_f32_32x32x16_bf16 v[80:95], v[116:119], v[232:235], v[80:95]
  ds_read_b64_tr_b16 v[116:117], v244 offset:0
  ds_read_b64_tr_b16 v[118:119], v244 offset:3072
  s_waitcnt lgkmcnt(10)
  v_mfma_f32_32x32x16_bf16 v[96:111], v[120:123], v[232:235], v[96:111]
  ds_read_b64_tr_b16 v[120:121], v245 offset:0
  ds_read_b64_tr_b16 v[122:123], v245 offset:3072
  s_waitcnt lgkmcnt(10)
  v_mfma_f32_32x32x16_bf16 v[64:79], v[124:127], v[236:239], v[64:79]
  ds_read_b64_tr_b16 v[124:125], v243 offset:6144
  ds_read_b64_tr_b16 v[126:127], v243 offset:9216
  s_waitcnt lgkmcnt(10)
  v_mfma_f32_32x32x16_bf16 v[80:95], v[192:195], v[236:239], v[80:95]
  ds_read_b64_tr_b16 v[192:193], v244 offset:6144
  ds_read_b64_tr_b16 v[194:195], v244 offset:9216
  s_waitcnt lgkmcnt(10)
  v_mfma_f32_32x32x16_bf16 v[96:111], v[196:199], v[236:239], v[96:111]
  ds_read_b64_tr_b16 v[196:197], v245 offset:6144
  ds_read_b64_tr_b16 v[198:199], v245 offset:9216
  s_waitcnt vmcnt(3)
  s_barrier
  s_waitcnt lgkmcnt(10)
  v_mfma_f32_32x32x16_bf16 v[64:79], v[112:115], v[160:163], v[64:79]
  ds_read_b64_tr_b16 v[112:113], v243 offset:12288
  ds_read_b64_tr_b16 v[114:115], v243 offset:15360
  s_waitcnt lgkmcnt(10)
  v_mfma_f32_32x32x16_bf16 v[80:95], v[116:119], v[160:163], v[80:95]
  ds_read_b64_tr_b16 v[116:117], v244 offset:12288
  ds_read_b64_tr_b16 v[118:119], v244 offset:15360
  s_add_u32 m0, s70, 24576
  s_add_u32 s60, s69, 74496
  s_add_u32 s60, s60, s11
  s_sub_u32 s60, s60, s3
  s_add_u32 s60, s60, 147456
  buffer_load_dwordx4 v246, s[32:35], s60 offen offset:0 lds
  buffer_load_dwordx4 v247, s[32:35], s60 offen offset:1024 lds
  buffer_load_dwordx4 v248, s[32:35], s60 offen offset:2048 lds
  s_waitcnt lgkmcnt(10)
  v_mfma_f32_32x32x16_bf16 v[96:111], v[120:123], v[160:163], v[96:111]
  ds_read_b64_tr_b16 v[120:121], v245 offset:12288
  ds_read_b64_tr_b16 v[122:123], v245 offset:15360
  s_waitcnt lgkmcnt(10)
  v_mfma_f32_32x32x16_bf16 v[64:79], v[124:127], v[164:167], v[64:79]
  ds_read_b64_tr_b16 v[124:125], v243 offset:18432
  ds_read_b64_tr_b16 v[126:127], v243 offset:21504
  s_waitcnt lgkmcnt(10)
  v_mfma_f32_32x32x16_bf16 v[80:95], v[192:195], v[164:167], v[80:95]
  ds_read_b64_tr_b16 v[192:193], v244 offset:18432
  ds_read_b64_tr_b16 v[194:195], v244 offset:21504
  s_waitcnt lgkmcnt(10)
  v_mfma_f32_32x32x16_bf16 v[96:111], v[196:199], v[164:167], v[96:111]
  ds_read_b64_tr_b16 v[196:197], v245 offset:18432
  ds_read_b64_tr_b16 v[198:199], v245 offset:21504
  s_waitcnt lgkmcnt(10)
  v_mfma_f32_32x32x16_bf16 v[64:79], v[112:115], v[168:171], v[64:79]
  ds_read_b64_tr_b16 v[112:113], v243 offset:24576
  ds_read_b64_tr_b16 v[114:115], v243 offset:27648
  s_waitcnt lgkmcnt(10)
  v_mfma_f32_32x32x16_bf16 v[80:95], v[116:119], v[168:171], v[80:95]
  ds_read_b64_tr_b16 v[116:117], v244 offset:24576
  ds_read_b64_tr_b16 v[118:119], v244 offset:27648
  s_waitcnt lgkmcnt(10)
  v_mfma_f32_32x32x16_bf16 v[96:111], v[120:123], v[168:171], v[96:111]
  ds_read_b64_tr_b16 v[120:121], v245 offset:24576
  ds_read_b64_tr_b16 v[122:123], v245 offset:27648
  s_waitcnt lgkmcnt(10)
  v_mfma_f32_32x32x16_bf16 v[64:79], v[124:127], v[172:175], v[64:79]
  ds_read_b64_tr_b16 v[124:125], v243 offset:30720
  ds_read_b64_tr_b16 v[126:127], v243 offset:33792
  s_waitcnt lgkmcnt(10)
  v_mfma_f32_32x32x16_bf16 v[80:95], v[192:195], v[172:175], v[80:95]
  ds_read_b64_tr_b16 v[192:193], v244 offset:30720
  ds_read_b64_tr_b16 v[194:195], v244 offset:33792
  s_waitcnt lgkmcnt(10)
  v_mfma_f32_32x32x16_bf16 v[96:111], v[196:199], v[172:175], v[96:111]
  ds_read_b64_tr_b16 v[196:197], v245 offset:30720
  ds_read_b64_tr_b16 v[198:199], v245 offset:33792
  s_waitcnt vmcnt(3)
  s_barrier
  s_waitcnt lgkmcnt(10)
  v_mfma_f32_32x32x16_bf16 v[64:79], v[112:115], v[176:179], v[64:79]
  ds_read_b64_tr_b16 v[112:113], v243 offset:36864
  ds_read_b64_tr_b16 v[114:115], v243 offset:39936
  s_waitcnt lgkmcnt(10)
  v_mfma_f32_32x32x16_bf16 v[80:95], v[116:119], v[176:179], v[80:95]
  ds_read_b64_tr_b16 v[116:117], v244 offset:36864
  ds_read_b64_tr_b16 v[118:119], v244 offset:39936
  global_load_dword v252, v254, s[14:15] sc1
  s_waitcnt lgkmcnt(10)
  v_mfma_f32_32x32x16_bf16 v[96:111], v[120:123], v[176:179], v[96:111]
  ds_read_b64_tr_b16 v[120:121], v245 offset:36864
  ds_read_b64_tr_b16 v[122:123], v245 offset:39936
  s_waitcnt lgkmcnt(10)
  v_mfma_f32_32x32x16_bf16 v[64:79], v[124:127], v[180:183], v[64:79]
  ds_read_b64_tr_b16 v[124:125], v243 offset:43008
  ds_read_b64_tr_b16 v[126:127], v243 offset:46080
  s_waitcnt lgkmcnt(10)
  v_mfma_f32_32x32x16_bf16 v[80:95], v[192:195], v[180:183], v[80:95]
  ds_read_b64_tr_b16 v[192:193], v244 offset:43008
  ds_read_b64_tr_b16 v[194:195], v244 offset:46080
  s_waitcnt lgkmcnt(10)
  v_mfma_f32_32x32x16_bf16 v[96:111], v[196:199], v[180:183], v[96:111]
  ds_read_b64_tr_b16 v[196:197], v245 offset:43008
  ds_read_b64_tr_b16 v[198:199], v245 offset:46080
  s_waitcnt lgkmcnt(10)
  v_mfma_f32_32x32x16_bf16 v[64:79], v[112:115], v[184:187], v[64:79]
  ds_read_b64_tr_b16 v[112:113], v240 offset:0
  ds_read_b64_tr_b16 v[114:115], v240 offset:3072
  s_waitcnt lgkmcnt(10)
  v_mfma_f32_32x32x16_bf16 v[80:95], v[116:119], v[184:187], v[80:95]
  ds_read_b64_tr_b16 v[116:117], v241 offset:0
  ds_read_b64_tr_b16 v[118:119], v241 offset:3072
  s_waitcnt lgkmcnt(10)
  v_mfma_f32_32x32x16_bf16 v[96:111], v[120:123], v[184:187], v[96:111]
  ds_read_b64_tr_b16 v[120:121], v242 offset:0
  ds_read_b64_tr_b16 v[122:123], v242 offset:3072
  s_waitcnt lgkmcnt(10)
  v_mfma_f32_32x32x16_bf16 v[64:79], v[124:127], v[188:191], v[64:79]
  ds_read_b64_tr_b16 v[124:125], v240 offset:6144
  ds_read_b64_tr_b16 v[126:127], v240 offset:9216
  s_waitcnt lgkmcnt(10)
  v_mfma_f32_32x32x16_bf16 v[80:95], v[192:195], v[188:191], v[80:95]
  ds_read_b64_tr_b16 v[192:193], v241 offset:6144
  ds_read_b64_tr_b16 v[194:195], v241 offset:9216
  s_waitcnt lgkmcnt(10)
  v_mfma_f32_32x32x16_bf16 v[96:111], v[196:199], v[188:191], v[96:111]
  ds_read_b64_tr_b16 v[196:197], v242 offset:6144
  ds_read_b64_tr_b16 v[198:199], v242 offset:9216
  s_waitcnt vmcnt(1)
  s_barrier
  s_waitcnt lgkmcnt(10)
  v_mfma_f32_32x32x16_bf16 v[64:79], v[112:115], v[32:35], v[64:79]
  ds_read_b64_tr_b16 v[112:113], v240 offset:12288
  ds_read_b64_tr_b16 v[114:115], v240 offset:15360
  s_waitcnt lgkmcnt(10)
  v_mfma_f32_32x32x16_bf16 v[80:95], v[116:119], v[32:35], v[80:95]
  ds_read_b64_tr_b16 v[116:117], v241 offset:12288
  ds_read_b64_tr_b16 v[118:119], v241 offset:15360
  s_waitcnt lgkmcnt(10)
  v_mfma_f32_32x32x16_bf16 v[96:111], v[120:123], v[32:35], v[96:111]
  ds_read_b64_tr_b16 v[120:121], v242 offset:12288
  ds_read_b64_tr_b16 v[122:123], v242 offset:15360
  s_waitcnt lgkmcnt(10)
  v_mfma_f32_32x32x16_bf16 v[64:79], v[124:127], v[36:39], v[64:79]
  ds_read_b64_tr_b16 v[124:125], v240 offset:18432
  ds_read_b64_tr_b16 v[126:127], v240 offset:21504
  s_waitcnt lgkmcnt(10)
  v_mfma_f32_32x32x16_bf16 v[80:95], v[192:195], v[36:39], v[80:95]
  ds_read_b64_tr_b16 v[192:193], v241 offset:18432
  ds_read_b64_tr_b16 v[194:195], v241 offset:21504
  s_waitcnt lgkmcnt(10)
  v_mfma_f32_32x32x16_bf16 v[96:111], v[196:199], v[36:39], v[96:111]
  ds_read_b64_tr_b16 v[196:197], v242 offset:18432
  ds_read_b64_tr_b16 v[198:199], v242 offset:21504
  s_waitcnt lgkmcnt(10)
  v_mfma_f32_32x32x16_bf16 v[64:79], v[112:115], v[40:43], v[64:79]
  ds_read_b64_tr_b16 v[112:113], v240 offset:24576
  ds_read_b64_tr_b16 v[114:115], v240 offset:27648
  s_waitcnt lgkmcnt(10)
  v_mfma_f32_32x32x16_bf16 v[80:95], v[116:119], v[40:43], v[80:95]
  ds_read_b64_tr_b16 v[116:117], v241 offset:24576
  ds_read_b64_tr_b16 v[118:119], v241 offset:27648
  s_waitcnt lgkmcnt(10)
  v_mfma_f32_32x32x16_bf16 v[96:111], v[120:123], v[40:43], v[96:111]
  ds_read_b64_tr_b16 v[120:121], v242 offset:24576
  ds_read_b64_tr_b16 v[122:123], v242 offset:27648
  s_waitcnt lgkmcnt(10)
  v_mfma_f32_32x32x16_bf16 v[64:79], v[124:127], v[44:47], v[64:79]
  ds_read_b64_tr_b16 v[124:125], v240 offset:30720
  ds_read_b64_tr_b16 v[126:127], v240 offset:33792
  s_waitcnt lgkmcnt(10)
  v_mfma_f32_32x32x16_bf16 v[80:95], v[192:195], v[44:47], v[80:95]
  ds_read_b64_tr_b16 v[192:193], v241 offset:30720
  ds_read_b64_tr_b16 v[194:195], v241 offset:33792
  s_waitcnt lgkmcnt(10)
  v_mfma_f32_32x32x16_bf16 v[96:111], v[196:199], v[44:47], v[96:111]
  ds_read_b64_tr_b16 v[196:197], v242 offset:30720
  ds_read_b64_tr_b16 v[198:199], v242 offset:33792
  s_barrier
  s_waitcnt lgkmcnt(10)
  v_mfma_f32_32x32x16_bf16 v[64:79], v[112:115], v[48:51], v[64:79]
  ds_read_b64_tr_b16 v[112:113], v240 offset:36864
  ds_read_b64_tr_b16 v[114:115], v240 offset:39936
  s_waitcnt lgkmcnt(10)
  v_mfma_f32_32x32x16_bf16 v[80:95], v[116:119], v[48:51], v[80:95]
  ds_read_b64_tr_b16 v[116:117], v241 offset:36864
  ds_read_b64_tr_b16 v[118:119], v241 offset:39936
  s_waitcnt lgkmcnt(10)
  v_mfma_f32_32x32x16_bf16 v[96:111], v[120:123], v[48:51], v[96:111]
  ds_read_b64_tr_b16 v[120:121], v242 offset:36864
  ds_read_b64_tr_b16 v[122:123], v242 offset:39936
  s_waitcnt lgkmcnt(10)
  v_mfma_f32_32x32x16_bf16 v[64:79], v[124:127], v[52:55], v[64:79]
  ds_read_b64_tr_b16 v[124:125], v240 offset:43008
  ds_read_b64_tr_b16 v[126:127], v240 offset:46080
  s_waitcnt lgkmcnt(10)
  v_mfma_f32_32x32x16_bf16 v[80:95], v[192:195], v[52:55], v[80:95]
  ds_read_b64_tr_b16 v[192:193], v241 offset:43008
  ds_read_b64_tr_b16 v[194:195], v241 offset:46080
  s_waitcnt lgkmcnt(10)
  v_mfma_f32_32x32x16_bf16 v[96:111], v[196:199], v[52:55], v[96:111]
  ds_read_b64_tr_b16 v[196:197], v242 offset:43008
  ds_read_b64_tr_b16 v[198:199], v242 offset:46080
  s_waitcnt lgkmcnt(10)
  v_mfma_f32_32x32x16_bf16 v[64:79], v[112:115], v[56:59], v[64:79]
  s_waitcnt lgkmcnt(8)
  v_mfma_f32_32x32x16_bf16 v[80:95], v[116:119], v[56:59], v[80:95]
  s_waitcnt lgkmcnt(6)
  v_mfma_f32_32x32x16_bf16 v[96:111], v[120:123], v[56:59], v[96:111]
  s_waitcnt lgkmcnt(4)
  v_mfma_f32_32x32x16_bf16 v[64:79], v[124:127], v[60:63], v[64:79]
  s_waitcnt lgkmcnt(2)
  v_mfma_f32_32x32x16_bf16 v[80:95], v[192:195], v[60:63], v[80:95]
  s_waitcnt lgkmcnt(0)
  v_mfma_f32_32x32x16_bf16 v[96:111], v[196:199], v[60:63], v[96:111]
  s_nop 15
  s_nop 3
  v_cvt_pk_bf16_f32 v12, v64, v65
  v_cvt_pk_bf16_f32 v13, v66, v67
  v_cvt_pk_bf16_f32 v14, v68, v69
  v_cvt_pk_bf16_f32 v15, v70, v71
  v_cvt_pk_bf16_f32 v16, v72, v73
  v_cvt_pk_bf16_f32 v17, v74, v75
  v_cvt_pk_bf16_f32 v18, v76, v77
  v_cvt_pk_bf16_f32 v19, v78, v79
  s_add_u32 s60, s71, 73728
  buffer_store_dwordx4 v[12:15], v249, s[36:39], s60 offen offset:0 sc1
  buffer_store_dwordx4 v[16:19], v249, s[36:39], s60 offen offset:1024 sc1
  v_cvt_pk_bf16_f32 v20, v80, v81
  v_cvt_pk_bf16_f32 v21, v82, v83
  v_cvt_pk_bf16_f32 v22, v84, v85
  v_cvt_pk_bf16_f32 v23, v86, v87
  v_cvt_pk_bf16_f32 v24, v88, v89
  v_cvt_pk_bf16_f32 v25, v90, v91
  v_cvt_pk_bf16_f32 v26, v92, v93
  v_cvt_pk_bf16_f32 v27, v94, v95
  s_add_u32 s60, s71, 79872
  buffer_store_dwordx4 v[20:23], v249, s[36:39], s60 offen offset:0 sc1
  buffer_store_dwordx4 v[24:27], v249, s[36:39], s60 offen offset:1024 sc1
  v_cvt_pk_bf16_f32 v12, v96, v97
  v_cvt_pk_bf16_f32 v13, v98, v99
  v_cvt_pk_bf16_f32 v14, v100, v101
  v_cvt_pk_bf16_f32 v15, v102, v103
  v_cvt_pk_bf16_f32 v16, v104, v105
  v_cvt_pk_bf16_f32 v17, v106, v107
  v_cvt_pk_bf16_f32 v18, v108, v109
  v_cvt_pk_bf16_f32 v19, v110, v111
  s_add_u32 s60, s71, 86016
  buffer_store_dwordx4 v[12:15], v249, s[36:39], s60 offen offset:0 sc1
  buffer_store_dwordx4 v[16:19], v249, s[36:39], s60 offen offset:1024 sc1
  v_and_b32 v8, 31, v30
  v_mul_u32_u24 v8, 2304, v8
  v_lshrrev_b32 v9, 5, v30
  v_lshl_add_u32 v8, v9, 4, v8
  v_and_b32 v28, 7, v30
  v_cmp_eq_u32 vcc, s50, v28
  s_nop 1
  v_cndmask_b32 v28, 0, 3, vcc
  s_waitcnt vmcnt(6)
  v_or_b32 v252, v252, v28
  v_and_b32 v252, 1, v252
  v_cmp_ne_u32 vcc, 0, v252
  s_nop 3
  s_cmp_eq_u64 vcc, -1
  s_cbranch_scc1 L_pollok_L_op3a
L_poll_L_op3a:
  global_load_dword v252, v254, s[14:15] sc1
  s_waitcnt vmcnt(0)
  v_or_b32 v252, v252, v28
  v_and_b32 v252, 1, v252
  v_cmp_ne_u32 vcc, 0, v252
  s_nop 3
  s_cmp_eq_u64 vcc, -1
  s_cbranch_scc1 L_polldone_L_op3a
  s_sleep 2
  s_branch L_poll_L_op3a
L_polldone_L_op3a:
L_pollok_L_op3a:
  s_mul_i32 s73, s50, 9
  s_add_u32 s73, s73, s51
  s_mul_i32 s60, s72, 884736
  s_lshl_b32 s61, s73, 10
  s_add_u32 s60, s60, s61
  buffer_load_dwordx4 v[32:35], v249, s[36:39], s60 offen sc1
  s_add_u32 s60, s60, 110592
  buffer_load_dwordx4 v[36:39], v249, s[36:39], s60 offen sc1
  s_add_u32 s60, s60, 110592
  buffer_load_dwordx4 v[40:43], v249, s[36:39], s60 offen sc1
  s_add_u32 s60, s60, 110592
  buffer_load_dwordx4 v[44:47], v249, s[36:39], s60 offen sc1
  s_add_u32 s60, s60, 110592
  buffer_load_dwordx4 v[48:51], v249, s[36:39], s60 offen sc1
  s_add_u32 s60, s60, 110592
  buffer_load_dwordx4 v[52:55], v249, s[36:39], s60 offen sc1
  s_add_u32 s60, s60, 110592
  buffer_load_dwordx4 v[56:59], v249, s[36:39], s60 offen sc1
  s_add_u32 s60, s60, 110592
  buffer_load_dwordx4 v[60:63], v249, s[36:39], s60 offen sc1
  s_waitcnt vmcnt(8)
  s_barrier
  s_cmp_lg_u32 s51, 6
  s_cbranch_scc1 L_noflag_L_op3b
  v_mov_b32 v5, 3
  s_lshl_b64 exec, 1, s50
  global_store_dword v254, v5, s[14:15] sc1
  s_mov_b64 exec, -1
L_noflag_L_op3b:
  s_lshr_b32 s60, s73, 1
  s_mul_hi_u32 s61, s60, 0x55555556
  s_mul_i32 s62, s61, 3
  s_sub_u32 s62, s60, s62
  s_mul_i32 s60, s49, 96
  s_lshl_b32 s62, s62, 5
  s_add_u32 s60, s60, s62
  s_mul_i32 s60, s60, 2304
  s_mul_i32 s62, s48, 1152
  s_add_u32 s60, s60, s62
  s_lshl_b32 s61, s61, 6
  s_add_u32 s60, s60, s61
  s_and_b32 s61, s73, 1
  s_lshl_b32 s61, s61, 5
  s_add_u32 s60, s60, s61
  s_waitcnt vmcnt(7)
  v_lshlrev_b32 v64, 16, v32
  v_and_b32 v65, 0xffff0000, v32
  v_lshlrev_b32 v66, 16, v33
  v_and_b32 v67, 0xffff0000, v33
  v_lshlrev_b32 v68, 16, v34
  v_and_b32 v69, 0xffff0000, v34
  v_lshlrev_b32 v70, 16, v35
  v_and_b32 v71, 0xffff0000, v35
  s_waitcnt vmcnt(6)
  v_lshlrev_b32 v6, 16, v36
  v_and_b32 v7, 0xffff0000, v36
  v_add_f32 v64, v64, v6
  v_add_f32 v65, v65, v7
  v_lshlrev_b32 v6, 16, v37
  v_and_b32 v7, 0xffff0000, v37
  v_add_f32 v66, v66, v6
  v_add_f32 v67, v67, v7
  v_lshlrev_b32 v6, 16, v38
  v_and_b32 v7, 0xffff0000, v38
  v_add_f32 v68, v68, v6
  v_add_f32 v69, v69, v7
  v_lshlrev_b32 v6, 16, v39
  v_and_b32 v7, 0xffff0000, v39
  v_add_f32 v70, v70, v6
  v_add_f32 v71, v71, v7
  s_waitcnt vmcnt(5)
  v_lshlrev_b32 v6, 16, v40
  v_and_b32 v7, 0xffff0000, v40
  v_add_f32 v64, v64, v6
  v_add_f32 v65, v65, v7
  v_lshlrev_b32 v6, 16, v41
  v_and_b32 v7, 0xffff0000, v41
  v_add_f32 v66, v66, v6
  v_add_f32 v67, v67, v7
  v_lshlrev_b32 v6, 16, v42
  v_and_b32 v7, 0xffff0000, v42
  v_add_f32 v68, v68, v6
  v_add_f32 v69, v69, v7
  v_lshlrev_b32 v6, 16, v43
  v_and_b32 v7, 0xffff0000, v43
  v_add_f32 v70, v70, v6
  v_add_f32 v71, v71, v7
  s_waitcnt vmcnt(4)
  v_lshlrev_b32 v6, 16, v44
  v_and_b32 v7, 0xffff0000, v44
  v_add_f32 v64, v64, v6
  v_add_f32 v65, v65, v7
  v_lshlrev_b32 v6, 16, v45
  v_and_b32 v7, 0xffff0000, v45
  v_add_f32 v66, v66, v6
  v_add_f32 v67, v67, v7
  v_lshlrev_b32 v6, 16, v46
  v_and_b32 v7, 0xffff0000, v46
  v_add_f32 v68, v68, v6
  v_add_f32 v69, v69, v7
  v_lshlrev_b32 v6, 16, v47
  v_and_b32 v7, 0xffff0000, v47
  v_add_f32 v70, v70, v6
  v_add_f32 v71, v71, v7
  s_waitcnt vmcnt(3)
  v_lshlrev_b32 v6, 16, v48
  v_and_b32 v7, 0xffff0000, v48
  v_add_f32 v64, v64, v6
  v_add_f32 v65, v65, v7
  v_lshlrev_b32 v6, 16, v49
  v_and_b32 v7, 0xffff0000, v49
  v_add_f32 v66, v66, v6
  v_add_f32 v67, v67, v7
  v_lshlrev_b32 v6, 16, v50
  v_and_b32 v7, 0xffff0000, v50
  v_add_f32 v68, v68, v6
  v_add_f32 v69, v69, v7
  v_lshlrev_b32 v6, 16, v51
  v_and_b32 v7, 0xffff0000, v51
  v_add_f32 v70, v70, v6
  v_add_f32 v71, v71, v7
  s_waitcnt vmcnt(2)
  v_lshlrev_b32 v6, 16, v52
  v_and_b32 v7, 0xffff0000, v52
  v_add_f32 v64, v64, v6
  v_add_f32 v65, v65, v7
  v_lshlrev_b32 v6, 16, v53
  v_and_b32 v7, 0xffff0000, v53
  v_add_f32 v66, v66, v6
  v_add_f32 v67, v67, v7
  v_lshlrev_b32 v6, 16, v54
  v_and_b32 v7, 0xffff0000, v54
  v_add_f32 v68, v68, v6
  v_add_f32 v69, v69, v7
  v_lshlrev_b32 v6, 16, v55
  v_and_b32 v7, 0xffff0000, v55
  v_add_f32 v70, v70, v6
  v_add_f32 v71, v71, v7
  s_waitcnt vmcnt(1)
  v_lshlrev_b32 v6, 16, v56
  v_and_b32 v7, 0xffff0000, v56
  v_add_f32 v64, v64, v6
  v_add_f32 v65, v65, v7
  v_lshlrev_b32 v6, 16, v57
  v_and_b32 v7, 0xffff0000, v57
  v_add_f32 v66, v66, v6
  v_add_f32 v67, v67, v7
  v_lshlrev_b32 v6, 16, v58
  v_and_b32 v7, 0xffff0000, v58
  v_add_f32 v68, v68, v6
  v_add_f32 v69, v69, v7
  v_lshlrev_b32 v6, 16, v59
  v_and_b32 v7, 0xffff0000, v59
  v_add_f32 v70, v70, v6
  v_add_f32 v71, v71, v7
  s_waitcnt vmcnt(0)
  v_lshlrev_b32 v6, 16, v60
  v_and_b32 v7, 0xffff0000, v60
  v_add_f32 v64, v64, v6
  v_add_f32 v65, v65, v7
  v_lshlrev_b32 v6, 16, v61
  v_and_b32 v7, 0xffff0000, v61
  v_add_f32 v66, v66, v6
  v_add_f32 v67, v67, v7
  v_lshlrev_b32 v6, 16, v62
  v_and_b32 v7, 0xffff0000, v62
  v_add_f32 v68, v68, v6
  v_add_f32 v69, v69, v7
  v_lshlrev_b32 v6, 16, v63
  v_and_b32 v7, 0xffff0000, v63
  v_add_f32 v70, v70, v6
  v_add_f32 v71, v71, v7
  v_cvt_pk_bf16_f32 v32, v64, v65
  v_cvt_pk_bf16_f32 v33, v66, v67
  v_cvt_pk_bf16_f32 v34, v68, v69
  v_cvt_pk_bf16_f32 v35, v70, v71
  s_nop 1
  v_permlane32_swap_b32 v32, v34
  v_permlane32_swap_b32 v33, v35
  buffer_store_dwordx4 v[32:35], v8, s[40:43], s60 offen
  s_cmp_lg_u32 s51, 6
  s_cbranch_scc1 L_nopoll_L_op3
L_poll_L_op3b:
  global_load_dword v252, v254, s[14:15] sc1
  s_waitcnt vmcnt(0)
  v_or_b32 v252, v252, v28
  v_and_b32 v252, 2, v252
  v_cmp_ne_u32 vcc, 0, v252
  s_nop 3
  s_cmp_eq_u64 vcc, -1
  s_cbranch_scc1 L_polldone_L_op3b
  s_sleep 2
  s_branch L_poll_L_op3b
L_polldone_L_op3b:
L_nopoll_L_op3:
  s_barrier
  s_lshl_b32 s73, s51, 3
  s_add_u32 s73, s73, s50
  s_add_u32 s73, s73, 72
  s_mul_i32 s60, s50, 9
  s_add_u32 s60, s60, 8
  s_cmp_eq_u32 s51, 7
  s_cselect_b32 s73, s60, s73
  s_cmp_ge_u32 s73, 108
  s_cbranch_scc1 L_fin_L_op3
  s_mul_i32 s60, s72, 884736
  s_lshl_b32 s61, s73, 10
  s_add_u32 s60, s60, s61
  buffer_load_dwordx4 v[96:99], v249, s[36:39], s60 offen sc1
  s_add_u32 s60, s60, 110592
  buffer_load_dwordx4 v[100:103], v249, s[36:39], s60 offen sc1
  s_add_u32 s60, s60, 110592
  buffer_load_dwordx4 v[104:107], v249, s[36:39], s60 offen sc1
  s_add_u32 s60, s60, 110592
  buffer_load_dwordx4 v[108:111], v249, s[36:39], s60 offen sc1
  s_add_u32 s60, s60, 110592
  buffer_load_dwordx4 v[112:115], v249, s[36:39], s60 offen sc1
  s_add_u32 s60, s60, 110592
  buffer_load_dwordx4 v[116:119], v249, s[36:39], s60 offen sc1
  s_add_u32 s60, s60, 110592
  buffer_load_dwordx4 v[120:123], v249, s[36:39], s60 offen sc1
  s_add_u32 s60, s60, 110592
  buffer_load_dwordx4 v[124:127], v249, s[36:39], s60 offen sc1
  s_lshr_b32 s60, s73, 1
  s_mul_hi_u32 s61, s60, 0x55555556
  s_mul_i32 s62, s61, 3
  s_sub_u32 s62, s60, s62
  s_mul_i32 s60, s49, 96
  s_lshl_b32 s62, s62, 5
  s_add_u32 s60, s60, s62
  s_mul_i32 s60, s60, 2304
  s_mul_i32 s62, s48, 1152
  s_add_u32 s60, s60, s62
  s_lshl_b32 s61, s61, 6
  s_add_u32 s60, s60, s61
  s_and_b32 s61, s73, 1
  s_lshl_b32 s61, s61, 5
  s_add_u32 s60, s60, s61
  s_waitcnt vmcnt(7)
  v_lshlrev_b32 v128, 16, v96
  v_and_b32 v129, 0xffff0000, v96
  v_lshlrev_b32 v130, 16, v97
  v_and_b32 v131, 0xffff0000, v97
  v_lshlrev_b32 v132, 16, v98
  v_and_b32 v133, 0xffff0000, v98
  v_lshlrev_b32 v134, 16, v99
  v_and_b32 v135, 0xffff0000, v99
  s_waitcnt vmcnt(6)
  v_lshlrev_b32 v6, 16, v100
  v_and_b32 v7, 0xffff0000, v100
  v_add_f32 v128, v128, v6
  v_add_f32 v129, v129, v7
  v_lshlrev_b32 v6, 16, v101
  v_and_b32 v7, 0xffff0000, v101
  v_add_f32 v130, v130, v6
  v_add_f32 v131, v131, v7
  v_lshlrev_b32 v6, 16, v102
  v_and_b32 v7, 0xffff0000, v102
  v_add_f32 v132, v132, v6
  v_add_f32 v133, v133, v7
  v_lshlrev_b32 v6, 16, v103
  v_and_b32 v7, 0xffff0000, v103
  v_add_f32 v134, v134, v6
  v_add_f32 v135, v135, v7
  s_waitcnt vmcnt(5)
  v_lshlrev_b32 v6, 16, v104
  v_and_b32 v7, 0xffff0000, v104
  v_add_f32 v128, v128, v6
  v_add_f32 v129, v129, v7
  v_lshlrev_b32 v6, 16, v105
  v_and_b32 v7, 0xffff0000, v105
  v_add_f32 v130, v130, v6
  v_add_f32 v131, v131, v7
  v_lshlrev_b32 v6, 16, v106
  v_and_b32 v7, 0xffff0000, v106
  v_add_f32 v132, v132, v6
  v_add_f32 v133, v133, v7
  v_lshlrev_b32 v6, 16, v107
  v_and_b32 v7, 0xffff0000, v107
  v_add_f32 v134, v134, v6
  v_add_f32 v135, v135, v7
  s_waitcnt vmcnt(4)
  v_lshlrev_b32 v6, 16, v108
  v_and_b32 v7, 0xffff0000, v108
  v_add_f32 v128, v128, v6
  v_add_f32 v129, v129, v7
  v_lshlrev_b32 v6, 16, v109
  v_and_b32 v7, 0xffff0000, v109
  v_add_f32 v130, v130, v6
  v_add_f32 v131, v131, v7
  v_lshlrev_b32 v6, 16, v110
  v_and_b32 v7, 0xffff0000, v110
  v_add_f32 v132, v132, v6
  v_add_f32 v133, v133, v7
  v_lshlrev_b32 v6, 16, v111
  v_and_b32 v7, 0xffff0000, v111
  v_add_f32 v134, v134, v6
  v_add_f32 v135, v135, v7
  s_waitcnt vmcnt(3)
  v_lshlrev_b32 v6, 16, v112
  v_and_b32 v7, 0xffff0000, v112
  v_add_f32 v128, v128, v6
  v_add_f32 v129, v129, v7
  v_lshlrev_b32 v6, 16, v113
  v_and_b32 v7, 0xffff0000, v113
  v_add_f32 v130, v130, v6
  v_add_f32 v131, v131, v7
  v_lshlrev_b32 v6, 16, v114
  v_and_b32 v7, 0xffff0000, v114
  v_add_f32 v132, v132, v6
  v_add_f32 v133, v133, v7
  v_lshlrev_b32 v6, 16, v115
  v_and_b32 v7, 0xffff0000, v115
  v_add_f32 v134, v134, v6
  v_add_f32 v135, v135, v7
  s_waitcnt vmcnt(2)
  v_lshlrev_b32 v6, 16, v116
  v_and_b32 v7, 0xffff0000, v116
  v_add_f32 v128, v128, v6
  v_add_f32 v129, v129, v7
  v_lshlrev_b32 v6, 16, v117
  v_and_b32 v7, 0xffff0000, v117
  v_add_f32 v130, v130, v6
  v_add_f32 v131, v131, v7
  v_lshlrev_b32 v6, 16, v118
  v_and_b32 v7, 0xffff0000, v118
  v_add_f32 v132, v132, v6
  v_add_f32 v133, v133, v7
  v_lshlrev_b32 v6, 16, v119
  v_and_b32 v7, 0xffff0000, v119
  v_add_f32 v134, v134, v6
  v_add_f32 v135, v135, v7
  s_waitcnt vmcnt(1)
  v_lshlrev_b32 v6, 16, v120
  v_and_b32 v7, 0xffff0000, v120
  v_add_f32 v128, v128, v6
  v_add_f32 v129, v129, v7
  v_lshlrev_b32 v6, 16, v121
  v_and_b32 v7, 0xffff0000, v121
  v_add_f32 v130, v130, v6
  v_add_f32 v131, v131, v7
  v_lshlrev_b32 v6, 16, v122
  v_and_b32 v7, 0xffff0000, v122
  v_add_f32 v132, v132, v6
  v_add_f32 v133, v133, v7
  v_lshlrev_b32 v6, 16, v123
  v_and_b32 v7, 0xffff0000, v123
  v_add_f32 v134, v134, v6
  v_add_f32 v135, v135, v7
  s_waitcnt vmcnt(0)
  v_lshlrev_b32 v6, 16, v124
  v_and_b32 v7, 0xffff0000, v124
  v_add_f32 v128, v128, v6
  v_add_f32 v129, v129, v7
  v_lshlrev_b32 v6, 16, v125
  v_and_b32 v7, 0xffff0000, v125
  v_add_f32 v130, v130, v6
  v_add_f32 v131, v131, v7
  v_lshlrev_b32 v6, 16, v126
  v_and_b32 v7, 0xffff0000, v126
  v_add_f32 v132, v132, v6
  v_add_f32 v133, v133, v7
  v_lshlrev_b32 v6, 16, v127
  v_and_b32 v7, 0xffff0000, v127
  v_add_f32 v134, v134, v6
  v_add_f32 v135, v135, v7
  v_cvt_pk_bf16_f32 v96, v128, v129
  v_cvt_pk_bf16_f32 v97, v130, v131
  v_cvt_pk_bf16_f32 v98, v132, v133
  v_cvt_pk_bf16_f32 v99, v134, v135
  s_nop 1
  v_permlane32_swap_b32 v96, v98
  v_permlane32_swap_b32 v97, v99
  buffer_store_dwordx4 v[96:99], v8, s[40:43], s60 offen
L_fin_L_op3:
  s_endpgm
L_role_a:
  v_lshrrev_b32 v100, 5, v30
  v_and_b32 v101, 31, v30
  v_bfe_u32 v102, v30, 4, 1
  v_bfe_u32 v103, v30, 2, 2
  v_and_b32 v104, 3, v30
  v_and_b32 v105, 15, v101
  v_xor_b32 v105, v105, v100
  v_lshlrev_b32 v105, 4, v105
  v_lshl_add_u32 v105, v101, 8, v105
  v_xor_b32 v10, 0, v105
  v_xor_b32 v11, 32, v105
  v_xor_b32 v12, 64, v105
  v_xor_b32 v13, 96, v105
  v_xor_b32 v14, 128, v105
  v_xor_b32 v15, 160, v105
  v_xor_b32 v16, 192, v105
  v_xor_b32 v17, 224, v105
  v_lshl_add_u32 v105, v100, 2, v103
  v_lshlrev_b32 v105, 8, v105
  v_lshl_add_u32 v105, v102, 5, v105
  v_lshl_add_u32 v105, v104, 3, v105
  v_add_u32 v105, 32768, v105
  v_xor_b32 v106, 0, v103
  v_lshl_add_u32 v18, v106, 6, v105
  v_xor_b32 v106, 1, v103
  v_lshl_add_u32 v19, v106, 6, v105
  v_xor_b32 v106, 2, v103
  v_lshl_add_u32 v20, v106, 6, v105
  v_xor_b32 v106, 3, v103
  v_lshl_add_u32 v21, v106, 6, v105
  v_lshl_add_u32 v105, v100, 3, v103
  v_lshlrev_b32 v105, 8, v105
  v_lshl_add_u32 v105, v102, 5, v105
  v_and_b32 v106, 1, v104
  v_lshl_add_u32 v105, v106, 4, v105
  v_lshrrev_b32 v106, 1, v104
  v_lshl_add_u32 v105, v106, 3, v105
  v_add_u32 v105, 65536, v105
  v_xor_b32 v106, 0, v103
  v_lshl_add_u32 v22, v106, 6, v105
  v_xor_b32 v106, 1, v103
  v_lshl_add_u32 v23, v106, 6, v105
  v_xor_b32 v106, 2, v103
  v_lshl_add_u32 v24, v106, 6, v105
  v_xor_b32 v106, 3, v103
  v_lshl_add_u32 v25, v106, 6, v105
  s_lshl_b32 s60, s58, 12
  s_add_u32 s60, s60, 114688
  v_bfe_u32 v105, v101, 1, 3
  v_xor_b32 v105, v105, v100
  v_lshlrev_b32 v105, 4, v105
  v_lshl_add_u32 v105, v101, 7, v105
  v_xor_b32 v106, 0, v105
  v_add_u32 v26, s60, v106
  v_xor_b32 v106, 32, v105
  v_add_u32 v27, s60, v106
  v_xor_b32 v106, 64, v105
  v_add_u32 v28, s60, v106
  v_xor_b32 v106, 96, v105
  v_add_u32 v29, s60, v106
  s_mov_b32 s6, s52
  s_mov_b32 s7, s52
  v_lshrrev_b32 v100, 5, v30
  v_and_b32 v101, 31, v30
  v_bfe_u32 v102, v30, 4, 1
  v_bfe_u32 v103, v30, 2, 2
  v_and_b32 v104, 3, v30
  v_add_u32 v105, 0, v30
  v_mul_u32_u24 v106, 2731, v105
  v_lshrrev_b32 v106, 16, v106
  v_mul_u32_u24 v107, 24, v106
  v_sub_u32 v105, v105, v107
  v_bfe_u32 v107, v106, 1, 1
  v_lshlrev_b32 v107, 2, v107
  v_xor_b32 v105, v105, v107
  v_mul_u32_u24 v106, 1152, v106
  v_lshl_add_u32 v105, v105, 4, v106
  v_subrev_u32 v246, 0, v105
  v_add_u32 v105, 64, v30
  v_mul_u32_u24 v106, 2731, v105
  v_lshrrev_b32 v106, 16, v106
  v_mul_u32_u24 v107, 24, v106
  v_sub_u32 v105, v105, v107
  v_bfe_u32 v107, v106, 1, 1
  v_lshlrev_b32 v107, 2, v107
  v_xor_b32 v105, v105, v107
  v_mul_u32_u24 v106, 1152, v106
  v_lshl_add_u32 v105, v105, 4, v106
  v_subrev_u32 v247, 1024, v105
  v_add_u32 v105, 128, v30
  v_mul_u32_u24 v106, 2731, v105
  v_lshrrev_b32 v106, 16, v106
  v_mul_u32_u24 v107, 24, v106
  v_sub_u32 v105, v105, v107
  v_bfe_u32 v107, v106, 1, 1
  v_lshlrev_b32 v107, 2, v107
  v_xor_b32 v105, v105, v107
  v_mul_u32_u24 v106, 1152, v106
  v_lshl_add_u32 v105, v105, 4, v106
  v_subrev_u32 v248, 2048, v105
  s_mul_i32 s70, s51, 3072
  s_lshl_b32 s60, s8, 8
  s_lshl_b32 s61, s51, 3
  s_add_u32 s60, s60, s61
  s_mul_i32 s69, s60, 1152
  s_lshl_b32 s59, s57, 1
  s_mul_i32 s63, s57, 3
  s_cmp_eq_u32 s58, 2
  s_cselect_b32 s59, s63, s59
  v_lshl_add_u32 v105, v100, 2, v103
  v_mul_u32_u24 v105, 384, v105
  v_lshl_add_u32 v105, v102, 5, v105
  v_lshl_add_u32 v105, v104, 3, v105
  v_lshrrev_b32 v106, 1, v103
  s_add_u32 s63, s59, 0
  v_xor_b32 v107, s63, v106
  v_lshl_add_u32 v240, v107, 6, v105
  v_add_u32 v243, 49152, v240
  s_add_u32 s63, s59, 1
  v_xor_b32 v107, s63, v106
  v_lshl_add_u32 v241, v107, 6, v105
  v_add_u32 v244, 49152, v241
  s_add_u32 s63, s59, 2
  v_xor_b32 v107, s63, v106
  v_lshl_add_u32 v242, v107, 6, v105
  v_add_u32 v245, 49152, v242
  s_lshl_b32 s72, s48, 4
  s_add_u32 s72, s72, s49
  s_lshl_b32 s60, s72, 3
  v_mov_b32 v255, s60
  s_lshl_b32 s61, s72, 8
  s_add_u32 s61, s61, 0x2000000
  v_and_b32 v107, 7, v30
  v_lshlrev_b32 v107, 2, v107
  v_add_u32 v254, s61, v107
  s_add_u32 s60, s60, s50
  s_mul_i32 s75, s60, 49152
  s_lshl_b32 s61, s58, 13
  s_add_u32 s75, s75, s61
  s_add_u32 s75, s75, 0x2100000
  s_mul_i32 s71, s60, 110592
  s_mul_i32 s60, s59, 3
  s_add_u32 s60, s60, s58
  s_lshl_b32 s60, s60, 11
  s_add_u32 s71, s71, s60
  v_lshlrev_b32 v249, 4, v30
  s_lshl_b32 s60, s58, 13
  s_add_u32 s60, s60, 65536
  v_add_u32 v250, s60, v249
  v_add_u32 v251, 49152, v250
  s_cmp_eq_u32 s57, 0
  s_cbranch_scc1 L_a_start
  s_cmp_lg_u32 s51, 4
  s_cbranch_scc1 L_hs0
  v_mov_b32 v108, 0
  s_lshl_b64 exec, 1, s50
  global_store_dword v254, v108, s[14:15] sc1
  s_mov_b64 exec, -1
L_hs0:
  s_mov_b32 s55, 12
L_idle0:
  s_barrier
  s_sub_u32 s55, s55, 1
  s_cmp_lg_u32 s55, 0
  s_cbranch_scc1 L_idle0
  s_waitcnt vmcnt(0)
  s_mov_b32 s55, 6
L_idle0b:
  s_barrier
  s_sub_u32 s55, s55, 1
  s_cmp_lg_u32 s55, 0
  s_cbranch_scc1 L_idle0b
L_a_start:
  s_barrier
  s_mov_b32 s56, 2
L_pass:
  s_setprio 0
  ds_read_b128 v[160:163], v26 offset:0
  ds_read_b64_tr_b16 v[128:129], v22 offset:0
  ds_read_b64_tr_b16 v[130:131], v22 offset:1024
  ds_read_b64_tr_b16 v[132:133], v23 offset:0
  ds_read_b64_tr_b16 v[134:135], v23 offset:1024
  ds_read_b64_tr_b16 v[136:137], v24 offset:0
  ds_read_b64_tr_b16 v[138:139], v24 offset:1024
  ds_read_b64_tr_b16 v[140:141], v25 offset:0
  ds_read_b64_tr_b16 v[142:143], v25 offset:1024
  ds_read_b128 v[164:167], v27 offset:0
  ds_read_b64_tr_b16 v[144:145], v22 offset:4096
  ds_read_b64_tr_b16 v[146:147], v22 offset:5120
  ds_read_b64_tr_b16 v[148:149], v23 offset:4096
  ds_read_b64_tr_b16 v[150:151], v23 offset:5120
  ds_read_b64_tr_b16 v[152:153], v24 offset:4096
  ds_read_b64_tr_b16 v[154:155], v24 offset:5120
  ds_read_b64_tr_b16 v[156:157], v25 offset:4096
  ds_read_b64_tr_b16 v[158:159], v25 offset:5120
  s_waitcnt lgkmcnt(0)
  s_barrier
  v_mfma_f32_32x32x16_bf16 v[64:79], v[128:131], v[160:163], 0
  ds_read_b128 v[200:203], v28 offset:0
  ds_read_b64_tr_b16 v[168:169], v22 offset:8192
  ds_read_b64_tr_b16 v[170:171], v22 offset:9216
  v_mfma_f32_32x32x16_bf16 v[80:95], v[132:135], v[160:163], 0
  ds_read_b64_tr_b16 v[172:173], v23 offset:8192
  ds_read_b64_tr_b16 v[174:175], v23 offset:9216
  ds_read_b64_tr_b16 v[176:177], v24 offset:8192
  v_mfma_f32_32x32x16_bf16 v[96:111], v[136:139], v[160:163], 0
  ds_read_b64_tr_b16 v[178:179], v24 offset:9216
  ds_read_b64_tr_b16 v[180:181], v25 offset:8192
  ds_read_b64_tr_b16 v[182:183], v25 offset:9216
  v_mfma_f32_32x32x16_bf16 v[112:127], v[140:143], v[160:163], 0
  ds_read_b128 v[204:207], v29 offset:0
  ds_read_b64_tr_b16 v[184:185], v22 offset:12288
  ds_read_b64_tr_b16 v[186:187], v22 offset:13312
  v_mfma_f32_32x32x16_bf16 v[64:79], v[144:147], v[164:167], v[64:79]
  ds_read_b64_tr_b16 v[188:189], v23 offset:12288
  ds_read_b64_tr_b16 v[190:191], v23 offset:13312
  ds_read_b64_tr_b16 v[192:193], v24 offset:12288
  v_mfma_f32_32x32x16_bf16 v[80:95], v[148:151], v[164:167], v[80:95]
  ds_read_b64_tr_b16 v[194:195], v24 offset:13312
  ds_read_b64_tr_b16 v[196:197], v25 offset:12288
  ds_read_b64_tr_b16 v[198:199], v25 offset:13312
  v_mfma_f32_32x32x16_bf16 v[96:111], v[152:155], v[164:167], v[96:111]
  v_mfma_f32_32x32x16_bf16 v[112:127], v[156:159], v[164:167], v[112:127]
  s_waitcnt lgkmcnt(0)
  s_barrier
  s_mov_b32 s55, 3
L_qloop:
  v_mfma_f32_32x32x16_bf16 v[64:79], v[168:171], v[200:203], v[64:79]
  ds_read_b128 v[160:163], v26 offset:12288
  ds_read_b64_tr_b16 v[128:129], v22 offset:16384
  ds_read_b64_tr_b16 v[130:131], v22 offset:17408
  v_mfma_f32_32x32x16_bf16 v[80:95], v[172:175], v[200:203], v[80:95]
  ds_read_b64_tr_b16 v[132:133], v23 offset:16384
  ds_read_b64_tr_b16 v[134:135], v23 offset:17408
  ds_read_b64_tr_b16 v[136:137], v24 offset:16384
  v_mfma_f32_32x32x16_bf16 v[96:111], v[176:179], v[200:203], v[96:111]
  ds_read_b64_tr_b16 v[138:139], v24 offset:17408
  ds_read_b64_tr_b16 v[140:141], v25 offset:16384
  ds_read_b64_tr_b16 v[142:143], v25 offset:17408
  v_mfma_f32_32x32x16_bf16 v[112:127], v[180:183], v[200:203], v[112:127]
  ds_read_b128 v[164:167], v27 offset:12288
  ds_read_b64_tr_b16 v[144:145], v22 offset:20480
  ds_read_b64_tr_b16 v[146:147], v22 offset:21504
  v_mfma_f32_32x32x16_bf16 v[64:79], v[184:187], v[204:207], v[64:79]
  ds_read_b64_tr_b16 v[148:149], v23 offset:20480
  ds_read_b64_tr_b16 v[150:151], v23 offset:21504
  ds_read_b64_tr_b16 v[152:153], v24 offset:20480
  v_mfma_f32_32x32x16_bf16 v[80:95], v[188:191], v[204:207], v[80:95]
  ds_read_b64_tr_b16 v[154:155], v24 offset:21504
  ds_read_b64_tr_b16 v[156:157], v25 offset:20480
  ds_read_b64_tr_b16 v[158:159], v25 offset:21504
  v_mfma_f32_32x32x16_bf16 v[96:111], v[192:195], v[204:207], v[96:111]
  v_mfma_f32_32x32x16_bf16 v[112:127], v[196:199], v[204:207], v[112:127]
  s_waitcnt lgkmcnt(0)
  s_barrier
  v_mfma_f32_32x32x16_bf16 v[64:79], v[128:131], v[160:163], v[64:79]
  ds_read_b128 v[200:203], v28 offset:12288
  ds_read_b64_tr_b16 v[168:169], v22 offset:24576
  ds_read_b64_tr_b16 v[170:171], v22 offset:25600
  v_mfma_f32_32x32x16_bf16 v[80:95], v[132:135], v[160:163], v[80:95]
  ds_read_b64_tr_b16 v[172:173], v23 offset:24576
  ds_read_b64_tr_b16 v[174:175], v23 offset:25600
  ds_read_b64_tr_b16 v[176:177], v24 offset:24576
  v_mfma_f32_32x32x16_bf16 v[96:111], v[136:139], v[160:163], v[96:111]
  ds_read_b64_tr_b16 v[178:179], v24 offset:25600
  ds_read_b64_tr_b16 v[180:181], v25 offset:24576
  ds_read_b64_tr_b16 v[182:183], v25 offset:25600
  v_mfma_f32_32x32x16_bf16 v[112:127], v[140:143], v[160:163], v[112:127]
  ds_read_b128 v[204:207], v29 offset:12288
  ds_read_b64_tr_b16 v[184:185], v22 offset:28672
  ds_read_b64_tr_b16 v[186:187], v22 offset:29696
  v_mfma_f32_32x32x16_bf16 v[64:79], v[144:147], v[164:167], v[64:79]
  ds_read_b64_tr_b16 v[188:189], v23 offset:28672
  ds_read_b64_tr_b16 v[190:191], v23 offset:29696
  ds_read_b64_tr_b16 v[192:193], v24 offset:28672
  v_mfma_f32_32x32x16_bf16 v[80:95], v[148:151], v[164:167], v[80:95]
  ds_read_b64_tr_b16 v[194:195], v24 offset:29696
  ds_read_b64_tr_b16 v[196:197], v25 offset:28672
  ds_read_b64_tr_b16 v[198:199], v25 offset:29696
  v_mfma_f32_32x32x16_bf16 v[96:111], v[152:155], v[164:167], v[96:111]
  v_mfma_f32_32x32x16_bf16 v[112:127], v[156:159], v[164:167], v[112:127]
  s_waitcnt lgkmcnt(0)
  s_barrier
  v_mfma_f32_32x32x16_bf16 v[64:79], v[168:171], v[200:203], v[64:79]
  ds_read_b128 v[160:163], v26 offset:24576
  ds_read_b64_tr_b16 v[128:129], v22 offset:32768
  ds_read_b64_tr_b16 v[130:131], v22 offset:33792
  v_mfma_f32_32x32x16_bf16 v[80:95], v[172:175], v[200:203], v[80:95]
  ds_read_b64_tr_b16 v[132:133], v23 offset:32768
  ds_read_b64_tr_b16 v[134:135], v23 offset:33792
  ds_read_b64_tr_b16 v[136:137], v24 offset:32768
  v_mfma_f32_32x32x16_bf16 v[96:111], v[176:179], v[200:203], v[96:111]
  ds_read_b64_tr_b16 v[138:139], v24 offset:33792
  ds_read_b64_tr_b16 v[140:141], v25 offset:32768
  ds_read_b64_tr_b16 v[142:143], v25 offset:33792
  v_mfma_f32_32x32x16_bf16 v[112:127], v[180:183], v[200:203], v[112:127]
  ds_read_b128 v[164:167], v27 offset:24576
  ds_read_b64_tr_b16 v[144:145], v22 offset:36864
  ds_read_b64_tr_b16 v[146:147], v22 offset:37888
  v_mfma_f32_32x32x16_bf16 v[64:79], v[184:187], v[204:207], v[64:79]
  ds_read_b64_tr_b16 v[148:149], v23 offset:36864
  ds_read_b64_tr_b16 v[150:151], v23 offset:37888
  ds_read_b64_tr_b16 v[152:153], v24 offset:36864
  v_mfma_f32_32x32x16_bf16 v[80:95], v[188:191], v[204:207], v[80:95]
  ds_read_b64_tr_b16 v[154:155], v24 offset:37888
  ds_read_b64_tr_b16 v[156:157], v25 offset:36864
  ds_read_b64_tr_b16 v[158:159], v25 offset:37888
  v_mfma_f32_32x32x16_bf16 v[96:111], v[192:195], v[204:207], v[96:111]
  v_mfma_f32_32x32x16_bf16 v[112:127], v[196:199], v[204:207], v[112:127]
  s_waitcnt lgkmcnt(0)
  s_barrier
  v_mfma_f32_32x32x16_bf16 v[64:79], v[128:131], v[160:163], v[64:79]
  ds_read_b128 v[200:203], v28 offset:24576
  ds_read_b64_tr_b16 v[168:169], v22 offset:40960
  ds_read_b64_tr_b16 v[170:171], v22 offset:41984
  v_mfma_f32_32x32x16_bf16 v[80:95], v[132:135], v[160:163], v[80:95]
  ds_read_b64_tr_b16 v[172:173], v23 offset:40960
  ds_read_b64_tr_b16 v[174:175], v23 offset:41984
  ds_read_b64_tr_b16 v[176:177], v24 offset:40960
  v_mfma_f32_32x32x16_bf16 v[96:111], v[136:139], v[160:163], v[96:111]
  ds_read_b64_tr_b16 v[178:179], v24 offset:41984
  ds_read_b64_tr_b16 v[180:181], v25 offset:40960
  ds_read_b64_tr_b16 v[182:183], v25 offset:41984
  v_mfma_f32_32x32x16_bf16 v[112:127], v[140:143], v[160:163], v[112:127]
  ds_read_b128 v[204:207], v29 offset:24576
  ds_read_b64_tr_b16 v[184:185], v22 offset:45056
  ds_read_b64_tr_b16 v[186:187], v22 offset:46080
  v_mfma_f32_32x32x16_bf16 v[64:79], v[144:147], v[164:167], v[64:79]
  ds_read_b64_tr_b16 v[188:189], v23 offset:45056
  ds_read_b64_tr_b16 v[190:191], v23 offset:46080
  ds_read_b64_tr_b16 v[192:193], v24 offset:45056
  v_mfma_f32_32x32x16_bf16 v[80:95], v[148:151], v[164:167], v[80:95]
  ds_read_b64_tr_b16 v[194:195], v24 offset:46080
  ds_read_b64_tr_b16 v[196:197], v25 offset:45056
  ds_read_b64_tr_b16 v[198:199], v25 offset:46080
  v_mfma_f32_32x32x16_bf16 v[96:111], v[152:155], v[164:167], v[96:111]
  v_mfma_f32_32x32x16_bf16 v[112:127], v[156:159], v[164:167], v[112:127]
  s_waitcnt lgkmcnt(0)
  s_barrier
  s_sub_u32 s55, s55, 1
  s_cmp_eq_u32 s55, 0
  s_cbranch_scc1 L_qdone
  v_mfma_f32_32x32x16_bf16 v[64:79], v[168:171], v[200:203], v[64:79]
  ds_read_b128 v[160:163], v26 offset:0
  ds_read_b64_tr_b16 v[128:129], v22 offset:0
  ds_read_b64_tr_b16 v[130:131], v22 offset:1024
  v_mfma_f32_32x32x16_bf16 v[80:95], v[172:175], v[200:203], v[80:95]
  ds_read_b64_tr_b16 v[132:133], v23 offset:0
  ds_read_b64_tr_b16 v[134:135], v23 offset:1024
  ds_read_b64_tr_b16 v[136:137], v24 offset:0
  v_mfma_f32_32x32x16_bf16 v[96:111], v[176:179], v[200:203], v[96:111]
  ds_read_b64_tr_b16 v[138:139], v24 offset:1024
  ds_read_b64_tr_b16 v[140:141], v25 offset:0
  ds_read_b64_tr_b16 v[142:143], v25 offset:1024
  v_mfma_f32_32x32x16_bf16 v[112:127], v[180:183], v[200:203], v[112:127]
  ds_read_b128 v[164:167], v27 offset:0
  ds_read_b64_tr_b16 v[144:145], v22 offset:4096
  ds_read_b64_tr_b16 v[146:147], v22 offset:5120
  v_mfma_f32_32x32x16_bf16 v[64:79], v[184:187], v[204:207], v[64:79]
  ds_read_b64_tr_b16 v[148:149], v23 offset:4096
  ds_read_b64_tr_b16 v[150:151], v23 offset:5120
  ds_read_b64_tr_b16 v[152:153], v24 offset:4096
  v_mfma_f32_32x32x16_bf16 v[80:95], v[188:191], v[204:207], v[80:95]
  ds_read_b64_tr_b16 v[154:155], v24 offset:5120
  ds_read_b64_tr_b16 v[156:157], v25 offset:4096
  ds_read_b64_tr_b16 v[158:159], v25 offset:5120
  v_mfma_f32_32x32x16_bf16 v[96:111], v[192:195], v[204:207], v[96:111]
  v_mfma_f32_32x32x16_bf16 v[112:127], v[196:199], v[204:207], v[112:127]
  s_waitcnt lgkmcnt(0)
  s_barrier
  v_mfma_f32_32x32x16_bf16 v[64:79], v[128:131], v[160:163], v[64:79]
  ds_read_b128 v[200:203], v28 offset:0
  ds_read_b64_tr_b16 v[168:169], v22 offset:8192
  ds_read_b64_tr_b16 v[170:171], v22 offset:9216
  v_mfma_f32_32x32x16_bf16 v[80:95], v[132:135], v[160:163], v[80:95]
  ds_read_b64_tr_b16 v[172:173], v23 offset:8192
  ds_read_b64_tr_b16 v[174:175], v23 offset:9216
  ds_read_b64_tr_b16 v[176:177], v24 offset:8192
  v_mfma_f32_32x32x16_bf16 v[96:111], v[136:139], v[160:163], v[96:111]
  ds_read_b64_tr_b16 v[178:179], v24 offset:9216
  ds_read_b64_tr_b16 v[180:181], v25 offset:8192
  ds_read_b64_tr_b16 v[182:183], v25 offset:9216
  v_mfma_f32_32x32x16_bf16 v[112:127], v[140:143], v[160:163], v[112:127]
  ds_read_b128 v[204:207], v29 offset:0
  ds_read_b64_tr_b16 v[184:185], v22 offset:12288
  ds_read_b64_tr_b16 v[186:187], v22 offset:13312
  v_mfma_f32_32x32x16_bf16 v[64:79], v[144:147], v[164:167], v[64:79]
  ds_read_b64_tr_b16 v[188:189], v23 offset:12288
  ds_read_b64_tr_b16 v[190:191], v23 offset:13312
  ds_read_b64_tr_b16 v[192:193], v24 offset:12288
  v_mfma_f32_32x32x16_bf16 v[80:95], v[148:151], v[164:167], v[80:95]
  ds_read_b64_tr_b16 v[194:195], v24 offset:13312
  ds_read_b64_tr_b16 v[196:197], v25 offset:12288
  ds_read_b64_tr_b16 v[198:199], v25 offset:13312
  v_mfma_f32_32x32x16_bf16 v[96:111], v[152:155], v[164:167], v[96:111]
  v_mfma_f32_32x32x16_bf16 v[112:127], v[156:159], v[164:167], v[112:127]
  s_waitcnt lgkmcnt(0)
  s_barrier
  s_branch L_qloop
L_qdone:
  s_setprio 2
  v_mfma_f32_32x32x16_bf16 v[64:79], v[168:171], v[200:203], v[64:79]
  v_mfma_f32_32x32x16_bf16 v[80:95], v[172:175], v[200:203], v[80:95]
  v_mfma_f32_32x32x16_bf16 v[96:111], v[176:179], v[200:203], v[96:111]
  v_mfma_f32_32x32x16_bf16 v[112:127], v[180:183], v[200:203], v[112:127]
  v_mfma_f32_32x32x16_bf16 v[64:79], v[184:187], v[204:207], v[64:79]
  v_mfma_f32_32x32x16_bf16 v[80:95], v[188:191], v[204:207], v[80:95]
  v_mfma_f32_32x32x16_bf16 v[96:111], v[192:195], v[204:207], v[96:111]
  v_mfma_f32_32x32x16_bf16 v[112:127], v[196:199], v[204:207], v[112:127]
  ds_read_b128 v[176:179], v10 offset:0
  ds_read_b128 v[180:183], v11 offset:0
  ds_read_b128 v[184:187], v12 offset:0
  ds_read_b128 v[188:191], v13 offset:0
  s_mov_b32 s54, 0
  s_nop 7
  v_pk_mul_f32 v[64:65], v[64:65], s[6:7]
  v_pk_mul_f32 v[66:67], v[66:67], s[6:7]
  v_pk_mul_f32 v[68:69], v[68:69], s[6:7]
  v_pk_mul_f32 v[70:71], v[70:71], s[6:7]
  v_cvt_pk_bf16_f32 v32, v64, v65
  v_cvt_pk_bf16_f32 v33, v66, v67
  v_cvt_pk_bf16_f32 v34, v68, v69
  v_cvt_pk_bf16_f32 v35, v70, v71
  v_pk_mul_f32 v[72:73], v[72:73], s[6:7]
  v_pk_mul_f32 v[74:75], v[74:75], s[6:7]
  v_pk_mul_f32 v[76:77], v[76:77], s[6:7]
  v_pk_mul_f32 v[78:79], v[78:79], s[6:7]
  v_cvt_pk_bf16_f32 v36, v72, v73
  v_cvt_pk_bf16_f32 v37, v74, v75
  v_cvt_pk_bf16_f32 v38, v76, v77
  v_cvt_pk_bf16_f32 v39, v78, v79
  s_waitcnt lgkmcnt(3)
  v_mfma_f32_32x32x16_bf16 v[128:143], v[176:179], v[32:35], 0
  ds_read_b128 v[176:179], v14 offset:0
  v_pk_mul_f32 v[80:81], v[80:81], s[6:7]
  v_pk_mul_f32 v[82:83], v[82:83], s[6:7]
  v_pk_mul_f32 v[84:85], v[84:85], s[6:7]
  v_pk_mul_f32 v[86:87], v[86:87], s[6:7]
  v_cvt_pk_bf16_f32 v40, v80, v81
  v_cvt_pk_bf16_f32 v41, v82, v83
  v_cvt_pk_bf16_f32 v42, v84, v85
  v_cvt_pk_bf16_f32 v43, v86, v87
  s_waitcnt lgkmcnt(3)
  v_mfma_f32_32x32x16_bf16 v[128:143], v[180:183], v[36:39], v[128:143]
  ds_read_b128 v[180:183], v15 offset:0
  v_pk_mul_f32 v[88:89], v[88:89], s[6:7]
  v_pk_mul_f32 v[90:91], v[90:91], s[6:7]
  v_pk_mul_f32 v[92:93], v[92:93], s[6:7]
  v_pk_mul_f32 v[94:95], v[94:95], s[6:7]
  v_cvt_pk_bf16_f32 v44, v88, v89
  v_cvt_pk_bf16_f32 v45, v90, v91
  v_cvt_pk_bf16_f32 v46, v92, v93
  v_cvt_pk_bf16_f32 v47, v94, v95
  s_waitcnt lgkmcnt(3)
  v_mfma_f32_32x32x16_bf16 v[128:143], v[184:187], v[40:43], v[128:143]
  ds_read_b128 v[184:187], v16 offset:0
  v_pk_mul_f32 v[96:97], v[96:97], s[6:7]
  v_pk_mul_f32 v[98:99], v[98:99], s[6:7]
  v_pk_mul_f32 v[100:101], v[100:101], s[6:7]
  v_pk_mul_f32 v[102:103], v[102:103], s[6:7]
  v_cvt_pk_bf16_f32 v48, v96, v97
  v_cvt_pk_bf16_f32 v49, v98, v99
  v_cvt_pk_bf16_f32 v50, v100, v101
  v_cvt_pk_bf16_f32 v51, v102, v103
  s_waitcnt lgkmcnt(3)
  v_mfma_f32_32x32x16_bf16 v[128:143], v[188:191], v[44:47], v[128:143]
  ds_read_b128 v[188:191], v17 offset:0
  v_pk_mul_f32 v[104:105], v[104:105], s[6:7]
  v_pk_mul_f32 v[106:107], v[106:107], s[6:7]
  v_pk_mul_f32 v[108:109], v[108:109], s[6:7]
  v_pk_mul_f32 v[110:111], v[110:111], s[6:7]
  v_cvt_pk_bf16_f32 v52, v104, v105
  v_cvt_pk_bf16_f32 v53, v106, v107
  v_cvt_pk_bf16_f32 v54, v108, v109
  v_cvt_pk_bf16_f32 v55, v110, v111
  s_waitcnt lgkmcnt(3)
  v_mfma_f32_32x32x16_bf16 v[128:143], v[176:179], v[48:51], v[128:143]
  s_waitcnt lgkmcnt(0)
  s_barrier
  ds_read_b128 v[176:179], v10 offset:8192
  v_pk_mul_f32 v[112:113], v[112:113], s[6:7]
  v_pk_mul_f32 v[114:115], v[114:115], s[6:7]
  v_pk_mul_f32 v[116:117], v[116:117], s[6:7]
  v_pk_mul_f32 v[118:119], v[118:119], s[6:7]
  v_cvt_pk_bf16_f32 v56, v112, v113
  v_cvt_pk_bf16_f32 v57, v114, v115
  v_cvt_pk_bf16_f32 v58, v116, v117
  v_cvt_pk_bf16_f32 v59, v118, v119
  v_mfma_f32_32x32x16_bf16 v[128:143], v[180:183], v[52:55], v[128:143]
  ds_read_b128 v[180:183], v11 offset:8192
  v_pk_mul_f32 v[120:121], v[120:121], s[6:7]
  v_pk_mul_f32 v[122:123], v[122:123], s[6:7]
  v_pk_mul_f32 v[124:125], v[124:125], s[6:7]
  v_pk_mul_f32 v[126:127], v[126:127], s[6:7]
  v_cvt_pk_bf16_f32 v60, v120, v121
  v_cvt_pk_bf16_f32 v61, v122, v123
  v_cvt_pk_bf16_f32 v62, v124, v125
  v_cvt_pk_bf16_f32 v63, v126, v127
  v_mfma_f32_32x32x16_bf16 v[128:143], v[184:187], v[56:59], v[128:143]
  ds_read_b128 v[184:187], v12 offset:8192
  s_nop 0
  v_mfma_f32_32x32x16_bf16 v[128:143], v[188:191], v[60:63], v[128:143]
  ds_read_b128 v[188:191], v13 offset:8192
  s_cmp_lg_u32 s56, 1
  s_cbranch_scc1 L_nodump1
  s_cmp_lg_u32 s57, 1
  s_cbranch_scc1 L_nodump1
  s_lshl_b32 s60, s58, 13
  s_add_u32 s60, s60, 65536
  v_lshlrev_b32 v6, 4, v30
  v_add_u32 v6, s60, v6
  ds_write_b128 v6, v[208:211] offset:24576
  ds_write_b128 v6, v[212:215] offset:25600
  ds_write_b128 v6, v[216:219] offset:26624
  ds_write_b128 v6, v[220:223] offset:27648
  ds_write_b128 v6, v[224:227] offset:28672
  ds_write_b128 v6, v[228:231] offset:29696
  ds_write_b128 v6, v[232:235] offset:30720
  ds_write_b128 v6, v[236:239] offset:31744
  s_waitcnt lgkmcnt(0)
L_nodump1:
  s_waitcnt lgkmcnt(3)
  v_mfma_f32_32x32x16_bf16 v[144:159], v[176:179], v[32:35], 0
  ds_read_b128 v[176:179], v14 offset:8192
  s_waitcnt lgkmcnt(3)
  v_mfma_f32_32x32x16_bf16 v[144:159], v[180:183], v[36:39], v[144:159]
  ds_read_b128 v[180:183], v15 offset:8192
  s_nop 5
  v_max3_f32 v0, v128, v129, v130
  v_max3_f32 v1, v131, v132, v133
  v_max3_f32 v8, v134, v135, v136
  v_max3_f32 v9, v137, v138, v139
  v_max3_f32 v31, v140, v141, v142
  v_max3_f32 v0, v0, v1, v143
  v_max3_f32 v8, v8, v9, v31
  v_max_f32 v0, v0, v8
  v_mov_b32 v1, v0
  s_nop 1
  v_permlane32_swap_b32 v0, v1
  v_max_f32 v0, v0, v1
  v_add_f32 v3, s53, v0
  s_waitcnt lgkmcnt(3)
  v_mfma_f32_32x32x16_bf16 v[144:159], v[184:187], v[40:43], v[144:159]
  ds_read_b128 v[184:187], v16 offset:8192
  v_sub_f32 v128, v128, v3
  v_sub_f32 v129, v129, v3
  v_sub_f32 v130, v130, v3
  v_sub_f32 v131, v131, v3
  v_sub_f32 v132, v132, v3
  v_sub_f32 v133, v133, v3
  v_sub_f32 v134, v134, v3
  v_sub_f32 v135, v135, v3
  v_sub_f32 v136, v136, v3
  v_sub_f32 v137, v137, v3
  v_sub_f32 v138, v138, v3
  v_sub_f32 v139, v139, v3
  s_waitcnt lgkmcnt(3)
  v_mfma_f32_32x32x16_bf16 v[144:159], v[188:191], v[44:47], v[144:159]
  ds_read_b128 v[188:191], v17 offset:8192
  v_sub_f32 v140, v140, v3
  v_sub_f32 v141, v141, v3
  v_sub_f32 v142, v142, v3
  v_sub_f32 v143, v143, v3
  v_exp_f32 v0, v128
  v_exp_f32 v1, v129
  v_exp_f32 v8, v130
  v_exp_f32 v9, v131
  v_cvt_pk_bf16_f32 v160, v0, v1
  v_add_f32 v5, v0, v1
  v_exp_f32 v0, v132
  v_exp_f32 v1, v133
  s_waitcnt lgkmcnt(3)
  v_mfma_f32_32x32x16_bf16 v[144:159], v[176:179], v[48:51], v[144:159]
  v_cvt_pk_bf16_f32 v161, v8, v9
  v_add_f32 v5, v5, v8
  v_add_f32 v5, v5, v9
  v_exp_f32 v8, v134
  v_exp_f32 v9, v135
  v_cvt_pk_bf16_f32 v162, v0, v1
  v_add_f32 v5, v5, v0
  v_add_f32 v5, v5, v1
  v_exp_f32 v0, v136
  v_exp_f32 v1, v137
  v_cvt_pk_bf16_f32 v163, v8, v9
  v_add_f32 v5, v5, v8
  v_add_f32 v5, v5, v9
  s_waitcnt lgkmcnt(0)
  s_barrier
  ds_read_b128 v[176:179], v10 offset:16384
  ds_read_b64_tr_b16 v[192:193], v18 offset:0
  ds_read_b64_tr_b16 v[194:195], v18 offset:2048
  v_mfma_f32_32x32x16_bf16 v[144:159], v[180:183], v[52:55], v[144:159]
  ds_read_b128 v[180:183], v11 offset:16384
  ds_read_b64_tr_b16 v[196:197], v19 offset:0
  ds_read_b64_tr_b16 v[198:199], v19 offset:2048
  v_exp_f32 v8, v138
  v_exp_f32 v9, v139
  v_cvt_pk_bf16_f32 v164, v0, v1
  v_add_f32 v5, v5, v0
  v_add_f32 v5, v5, v1
  v_exp_f32 v0, v140
  v_exp_f32 v1, v141
  v_cvt_pk_bf16_f32 v165, v8, v9
  v_add_f32 v5, v5, v8
  v_add_f32 v5, v5, v9
  v_exp_f32 v8, v142
  v_exp_f32 v9, v143
  v_mfma_f32_32x32x16_bf16 v[144:159], v[184:187], v[56:59], v[144:159]
  ds_read_b128 v[184:187], v12 offset:16384
  ds_read_b64_tr_b16 v[200:201], v20 offset:0
  ds_read_b64_tr_b16 v[202:203], v20 offset:2048
  v_cvt_pk_bf16_f32 v166, v0, v1
  v_add_f32 v5, v5, v0
  v_add_f32 v5, v5, v1
  s_nop 0
  v_cvt_pk_bf16_f32 v167, v8, v9
  v_add_f32 v5, v5, v8
  v_add_f32 v5, v5, v9
  v_sub_f32 v240, 0, v3
  v_sub_f32 v241, 0, v3
  v_sub_f32 v242, 0, v3
  v_sub_f32 v243, 0, v3
  v_sub_f32 v244, 0, v3
  v_mfma_f32_32x32x16_bf16 v[144:159], v[188:191], v[60:63], v[144:159]
  ds_read_b128 v[188:191], v13 offset:16384
  ds_read_b64_tr_b16 v[204:205], v21 offset:0
  ds_read_b64_tr_b16 v[206:207], v21 offset:2048
  v_sub_f32 v245, 0, v3
  v_sub_f32 v246, 0, v3
  v_sub_f32 v247, 0, v3
  v_sub_f32 v248, 0, v3
  v_sub_f32 v249, 0, v3
  v_sub_f32 v250, 0, v3
  v_sub_f32 v251, 0, v3
  v_sub_f32 v252, 0, v3
  v_sub_f32 v253, 0, v3
  v_sub_f32 v254, 0, v3
  v_sub_f32 v255, 0, v3
  v_mov_b32 v4, v5
  s_waitcnt lgkmcnt(9)
  v_mfma_f32_32x32x16_bf16 v[128:143], v[176:179], v[32:35], v[240:255]
  ds_read_b128 v[176:179], v14 offset:16384
  v_mfma_f32_32x32x16_bf16 v[64:79], v[192:195], v[160:163], 0
  ds_read_b64_tr_b16 v[192:193], v18 offset:4096
  ds_read_b64_tr_b16 v[194:195], v18 offset:6144
  s_waitcnt lgkmcnt(9)
  v_mfma_f32_32x32x16_bf16 v[128:143], v[180:183], v[36:39], v[128:143]
  ds_read_b128 v[180:183], v15 offset:16384
  s_nop 2
  v_sub_f32 v144, v144, v3
  v_sub_f32 v145, v145, v3
  v_sub_f32 v146, v146, v3
  v_sub_f32 v147, v147, v3
  v_sub_f32 v148, v148, v3
  v_mfma_f32_32x32x16_bf16 v[80:95], v[196:199], v[160:163], 0
  ds_read_b64_tr_b16 v[196:197], v19 offset:4096
  ds_read_b64_tr_b16 v[198:199], v19 offset:6144
  v_sub_f32 v149, v149, v3
  v_sub_f32 v150, v150, v3
  v_sub_f32 v151, v151, v3
  v_sub_f32 v152, v152, v3
  v_sub_f32 v153, v153, v3
  s_waitcnt lgkmcnt(9)
  v_mfma_f32_32x32x16_bf16 v[128:143], v[184:187], v[40:43], v[128:143]
  ds_read_b128 v[184:187], v16 offset:16384
  v_sub_f32 v154, v154, v3
  v_sub_f32 v155, v155, v3
  v_sub_f32 v156, v156, v3
  v_sub_f32 v157, v157, v3
  v_mfma_f32_32x32x16_bf16 v[96:111], v[200:203], v[160:163], 0
  ds_read_b64_tr_b16 v[200:201], v20 offset:4096
  ds_read_b64_tr_b16 v[202:203], v20 offset:6144
  v_sub_f32 v158, v158, v3
  v_sub_f32 v159, v159, v3
  v_exp_f32 v0, v144
  v_exp_f32 v1, v145
  v_exp_f32 v8, v146
  s_waitcnt lgkmcnt(9)
  v_mfma_f32_32x32x16_bf16 v[128:143], v[188:191], v[44:47], v[128:143]
  ds_read_b128 v[188:191], v17 offset:16384
  v_exp_f32 v9, v147
  v_cvt_pk_bf16_f32 v168, v0, v1
  v_add_f32 v5, v0, v1
  v_exp_f32 v0, v148
  v_exp_f32 v1, v149
  v_mfma_f32_32x32x16_bf16 v[112:127], v[204:207], v[160:163], 0
  ds_read_b64_tr_b16 v[204:205], v21 offset:4096
  ds_read_b64_tr_b16 v[206:207], v21 offset:6144
  v_cvt_pk_bf16_f32 v169, v8, v9
  v_add_f32 v5, v5, v8
  v_add_f32 v5, v5, v9
  v_exp_f32 v8, v150
  s_waitcnt lgkmcnt(9)
  v_mfma_f32_32x32x16_bf16 v[128:143], v[176:179], v[48:51], v[128:143]
  v_exp_f32 v9, v151
  v_cvt_pk_bf16_f32 v170, v0, v1
  v_add_f32 v5, v5, v0
  v_add_f32 v5, v5, v1
  v_exp_f32 v0, v152
  v_mfma_f32_32x32x16_bf16 v[64:79], v[192:195], v[164:167], v[64:79]
  v_exp_f32 v1, v153
  v_cvt_pk_bf16_f32 v171, v8, v9
  v_add_f32 v5, v5, v8
  v_add_f32 v5, v5, v9
  v_exp_f32 v8, v154
  s_waitcnt lgkmcnt(0)
  s_barrier
  ds_read_b128 v[176:179], v10 offset:24576
  ds_read_b64_tr_b16 v[192:193], v18 offset:8192
  ds_read_b64_tr_b16 v[194:195], v18 offset:10240
  v_mfma_f32_32x32x16_bf16 v[128:143], v[180:183], v[52:55], v[128:143]
  ds_read_b128 v[180:183], v11 offset:24576
  v_exp_f32 v9, v155
  v_cvt_pk_bf16_f32 v172, v0, v1
  v_add_f32 v5, v5, v0
  v_add_f32 v5, v5, v1
  v_mfma_f32_32x32x16_bf16 v[80:95], v[196:199], v[164:167], v[80:95]
  ds_read_b64_tr_b16 v[196:197], v19 offset:8192
  ds_read_b64_tr_b16 v[198:199], v19 offset:10240
  v_exp_f32 v0, v156
  v_exp_f32 v1, v157
  v_cvt_pk_bf16_f32 v173, v8, v9
  v_add_f32 v5, v5, v8
  v_add_f32 v5, v5, v9
  v_mfma_f32_32x32x16_bf16 v[128:143], v[184:187], v[56:59], v[128:143]
  ds_read_b128 v[184:187], v12 offset:24576
  v_exp_f32 v8, v158
  v_exp_f32 v9, v159
  v_cvt_pk_bf16_f32 v174, v0, v1
  v_add_f32 v5, v5, v0
  v_add_f32 v5, v5, v1
  v_mfma_f32_32x32x16_bf16 v[96:111], v[200:203], v[164:167], v[96:111]
  ds_read_b64_tr_b16 v[200:201], v20 offset:8192
  ds_read_b64_tr_b16 v[202:203], v20 offset:10240
  s_nop 0
  v_cvt_pk_bf16_f32 v175, v8, v9
  v_add_f32 v5, v5, v8
  v_add_f32 v5, v5, v9
  v_mfma_f32_32x32x16_bf16 v[128:143], v[188:191], v[60:63], v[128:143]
  ds_read_b128 v[188:191], v13 offset:24576
  v_or3_b32 v31, v168, v169, v170
  v_or3_b32 v6, v171, v172, v173
  v_or3_b32 v31, v31, v174, v175
  v_or_b32 v31, v31, v6
  v_and_b32 v31, s100, v31
  v_mfma_f32_32x32x16_bf16 v[112:127], v[204:207], v[164:167], v[112:127]
  ds_read_b64_tr_b16 v[204:205], v21 offset:8192
  ds_read_b64_tr_b16 v[206:207], v21 offset:10240
  v_cmp_ne_u32 vcc, 0, v31
  s_cbranch_vccnz L_slow_t2
L_slowret_t2:
  v_add_f32 v4, v4, v5
  s_mov_b32 s55, 3
L_attloop:
  s_cmp_lg_u32 s54, 0
  s_cbranch_scc1 L_resc_l3
L_rescret_l3:
  s_waitcnt lgkmcnt(9)
  v_mfma_f32_32x32x16_bf16 v[144:159], v[176:179], v[32:35], v[240:255]
  ds_read_b128 v[176:179], v14 offset:24576
  v_mfma_f32_32x32x16_bf16 v[64:79], v[192:195], v[168:171], v[64:79]
  ds_read_b64_tr_b16 v[192:193], v18 offset:12288
  ds_read_b64_tr_b16 v[194:195], v18 offset:14336
  s_waitcnt lgkmcnt(9)
  v_mfma_f32_32x32x16_bf16 v[144:159], v[180:183], v[36:39], v[144:159]
  ds_read_b128 v[180:183], v15 offset:24576
  s_nop 2
  v_exp_f32 v0, v128
  v_exp_f32 v1, v129
  v_exp_f32 v8, v130
  v_exp_f32 v9, v131
  v_mfma_f32_32x32x16_bf16 v[80:95], v[196:199], v[168:171], v[80:95]
  ds_read_b64_tr_b16 v[196:197], v19 offset:12288
  ds_read_b64_tr_b16 v[198:199], v19 offset:14336
  v_cvt_pk_bf16_f32 v160, v0, v1
  v_add_f32 v5, v0, v1
  v_exp_f32 v0, v132
  s_waitcnt lgkmcnt(9)
  v_mfma_f32_32x32x16_bf16 v[144:159], v[184:187], v[40:43], v[144:159]
  ds_read_b128 v[184:187], v16 offset:24576
  v_exp_f32 v1, v133
  v_cvt_pk_bf16_f32 v161, v8, v9
  v_add_f32 v5, v5, v8
  v_add_f32 v5, v5, v9
  v_mfma_f32_32x32x16_bf16 v[96:111], v[200:203], v[168:171], v[96:111]
  ds_read_b64_tr_b16 v[200:201], v20 offset:12288
  ds_read_b64_tr_b16 v[202:203], v20 offset:14336
  v_exp_f32 v8, v134
  v_exp_f32 v9, v135
  v_cvt_pk_bf16_f32 v162, v0, v1
  s_waitcnt lgkmcnt(9)
  v_mfma_f32_32x32x16_bf16 v[144:159], v[188:191], v[44:47], v[144:159]
  ds_read_b128 v[188:191], v17 offset:24576
  v_add_f32 v5, v5, v0
  v_add_f32 v5, v5, v1
  v_exp_f32 v0, v136
  v_exp_f32 v1, v137
  v_mfma_f32_32x32x16_bf16 v[112:127], v[204:207], v[168:171], v[112:127]
  ds_read_b64_tr_b16 v[204:205], v21 offset:12288
  ds_read_b64_tr_b16 v[206:207], v21 offset:14336
  v_cvt_pk_bf16_f32 v163, v8, v9
  v_add_f32 v5, v5, v8
  v_add_f32 v5, v5, v9
  s_waitcnt lgkmcnt(9)
  v_mfma_f32_32x32x16_bf16 v[144:159], v[176:179], v[48:51], v[144:159]
  v_exp_f32 v8, v138
  v_exp_f32 v9, v139
  v_cvt_pk_bf16_f32 v164, v0, v1
  v_add_f32 v5, v5, v0
  v_mfma_f32_32x32x16_bf16 v[64:79], v[192:195], v[172:175], v[64:79]
  v_add_f32 v5, v5, v1
  v_exp_f32 v0, v140
  v_exp_f32 v1, v141
  s_waitcnt lgkmcnt(0)
  s_barrier
  ds_read_b128 v[176:179], v10 offset:0
  ds_read_b64_tr_b16 v[192:193], v18 offset:16384
  ds_read_b64_tr_b16 v[194:195], v18 offset:18432
  v_mfma_f32_32x32x16_bf16 v[144:159], v[180:183], v[52:55], v[144:159]
  ds_read_b128 v[180:183], v11 offset:0
  v_cvt_pk_bf16_f32 v165, v8, v9
  v_add_f32 v5, v5, v8
  v_add_f32 v5, v5, v9
  v_exp_f32 v8, v142
  v_mfma_f32_32x32x16_bf16 v[80:95], v[196:199], v[172:175], v[80:95]
  ds_read_b64_tr_b16 v[196:197], v19 offset:16384
  ds_read_b64_tr_b16 v[198:199], v19 offset:18432
  v_exp_f32 v9, v143
  v_cvt_pk_bf16_f32 v166, v0, v1
  v_add_f32 v5, v5, v0
  v_mfma_f32_32x32x16_bf16 v[144:159], v[184:187], v[56:59], v[144:159]
  ds_read_b128 v[184:187], v12 offset:0
  v_add_f32 v5, v5, v1
  s_nop 0
  v_cvt_pk_bf16_f32 v167, v8, v9
  v_add_f32 v5, v5, v8
  v_mfma_f32_32x32x16_bf16 v[96:111], v[200:203], v[172:175], v[96:111]
  ds_read_b64_tr_b16 v[200:201], v20 offset:16384
  ds_read_b64_tr_b16 v[202:203], v20 offset:18432
  v_add_f32 v5, v5, v9
  v_or3_b32 v31, v160, v161, v162
  v_or3_b32 v6, v163, v164, v165
  v_mfma_f32_32x32x16_bf16 v[144:159], v[188:191], v[60:63], v[144:159]
  ds_read_b128 v[188:191], v13 offset:0
  v_or3_b32 v31, v31, v166, v167
  v_or_b32 v31, v31, v6
  v_and_b32 v31, s100, v31
  v_cmp_ne_u32 vcc, 0, v31
  v_mfma_f32_32x32x16_bf16 v[112:127], v[204:207], v[172:175], v[112:127]
  ds_read_b64_tr_b16 v[204:205], v21 offset:16384
  ds_read_b64_tr_b16 v[206:207], v21 offset:18432
  s_cbranch_vccnz L_slow_l3
L_slowret_l3:
  v_add_f32 v4, v4, v5
  s_cmp_lg_u32 s54, 0
  s_cbranch_scc1 L_resc_l0
L_rescret_l0:
  s_waitcnt lgkmcnt(9)
  v_mfma_f32_32x32x16_bf16 v[128:143], v[176:179], v[32:35], v[240:255]
  ds_read_b128 v[176:179], v14 offset:0
  v_mfma_f32_32x32x16_bf16 v[64:79], v[192:195], v[160:163], v[64:79]
  ds_read_b64_tr_b16 v[192:193], v18 offset:20480
  ds_read_b64_tr_b16 v[194:195], v18 offset:22528
  s_waitcnt lgkmcnt(9)
  v_mfma_f32_32x32x16_bf16 v[128:143], v[180:183], v[36:39], v[128:143]
  ds_read_b128 v[180:183], v15 offset:0
  s_nop 2
  v_exp_f32 v0, v144
  v_exp_f32 v1, v145
  v_exp_f32 v8, v146
  v_exp_f32 v9, v147
  v_mfma_f32_32x32x16_bf16 v[80:95], v[196:199], v[160:163], v[80:95]
  ds_read_b64_tr_b16 v[196:197], v19 offset:20480
  ds_read_b64_tr_b16 v[198:199], v19 offset:22528
  v_cvt_pk_bf16_f32 v168, v0, v1
  v_add_f32 v5, v0, v1
  v_exp_f32 v0, v148
  s_waitcnt lgkmcnt(9)
  v_mfma_f32_32x32x16_bf16 v[128:143], v[184:187], v[40:43], v[128:143]
  ds_read_b128 v[184:187], v16 offset:0
  v_exp_f32 v1, v149
  v_cvt_pk_bf16_f32 v169, v8, v9
  v_add_f32 v5, v5, v8
  v_add_f32 v5, v5, v9
  v_mfma_f32_32x32x16_bf16 v[96:111], v[200:203], v[160:163], v[96:111]
  ds_read_b64_tr_b16 v[200:201], v20 offset:20480
  ds_read_b64_tr_b16 v[202:203], v20 offset:22528
  v_exp_f32 v8, v150
  v_exp_f32 v9, v151
  v_cvt_pk_bf16_f32 v170, v0, v1
  s_waitcnt lgkmcnt(9)
  v_mfma_f32_32x32x16_bf16 v[128:143], v[188:191], v[44:47], v[128:143]
  ds_read_b128 v[188:191], v17 offset:0
  v_add_f32 v5, v5, v0
  v_add_f32 v5, v5, v1
  v_exp_f32 v0, v152
  v_exp_f32 v1, v153
  v_mfma_f32_32x32x16_bf16 v[112:127], v[204:207], v[160:163], v[112:127]
  ds_read_b64_tr_b16 v[204:205], v21 offset:20480
  ds_read_b64_tr_b16 v[206:207], v21 offset:22528
  v_cvt_pk_bf16_f32 v171, v8, v9
  v_add_f32 v5, v5, v8
  v_add_f32 v5, v5, v9
  s_waitcnt lgkmcnt(9)
  v_mfma_f32_32x32x16_bf16 v[128:143], v[176:179], v[48:51], v[128:143]
  v_exp_f32 v8, v154
  v_exp_f32 v9, v155
  v_cvt_pk_bf16_f32 v172, v0, v1
  v_add_f32 v5, v5, v0
  v_mfma_f32_32x32x16_bf16 v[64:79], v[192:195], v[164:167], v[64:79]
  v_add_f32 v5, v5, v1
  v_exp_f32 v0, v156
  v_exp_f32 v1, v157
  s_waitcnt lgkmcnt(0)
  s_barrier
  ds_read_b128 v[176:179], v10 offset:8192
  ds_read_b64_tr_b16 v[192:193], v18 offset:24576
  ds_read_b64_tr_b16 v[194:195], v18 offset:26624
  v_mfma_f32_32x32x16_bf16 v[128:143], v[180:183], v[52:55], v[128:143]
  ds_read_b128 v[180:183], v11 offset:8192
  v_cvt_pk_bf16_f32 v173, v8, v9
  v_add_f32 v5, v5, v8
  v_add_f32 v5, v5, v9
  v_exp_f32 v8, v158
  v_mfma_f32_32x32x16_bf16 v[80:95], v[196:199], v[164:167], v[80:95]
  ds_read_b64_tr_b16 v[196:197], v19 offset:24576
  ds_read_b64_tr_b16 v[198:199], v19 offset:26624
  v_exp_f32 v9, v159
  v_cvt_pk_bf16_f32 v174, v0, v1
  v_add_f32 v5, v5, v0
  v_mfma_f32_32x32x16_bf16 v[128:143], v[184:187], v[56:59], v[128:143]
  ds_read_b128 v[184:187], v12 offset:8192
  v_add_f32 v5, v5, v1
  s_nop 0
  v_cvt_pk_bf16_f32 v175, v8, v9
  v_add_f32 v5, v5, v8
  v_mfma_f32_32x32x16_bf16 v[96:111], v[200:203], v[164:167], v[96:111]
  ds_read_b64_tr_b16 v[200:201], v20 offset:24576
  ds_read_b64_tr_b16 v[202:203], v20 offset:26624
  v_add_f32 v5, v5, v9
  v_or3_b32 v31, v168, v169, v170
  v_or3_b32 v6, v171, v172, v173
  v_mfma_f32_32x32x16_bf16 v[128:143], v[188:191], v[60:63], v[128:143]
  ds_read_b128 v[188:191], v13 offset:8192
  v_or3_b32 v31, v31, v174, v175
  v_or_b32 v31, v31, v6
  v_and_b32 v31, s100, v31
  v_cmp_ne_u32 vcc, 0, v31
  v_mfma_f32_32x32x16_bf16 v[112:127], v[204:207], v[164:167], v[112:127]
  ds_read_b64_tr_b16 v[204:205], v21 offset:24576
  ds_read_b64_tr_b16 v[206:207], v21 offset:26624
  s_cbranch_vccnz L_slow_l0
L_slowret_l0:
  v_add_f32 v4, v4, v5
  s_cmp_lg_u32 s54, 0
  s_cbranch_scc1 L_resc_l1
L_rescret_l1:
  s_waitcnt lgkmcnt(9)
  v_mfma_f32_32x32x16_bf16 v[144:159], v[176:179], v[32:35], v[240:255]
  ds_read_b128 v[176:179], v14 offset:8192
  v_mfma_f32_32x32x16_bf16 v[64:79], v[192:195], v[168:171], v[64:79]
  ds_read_b64_tr_b16 v[192:193], v18 offset:28672
  ds_read_b64_tr_b16 v[194:195], v18 offset:30720
  s_waitcnt lgkmcnt(9)
  v_mfma_f32_32x32x16_bf16 v[144:159], v[180:183], v[36:39], v[144:159]
  ds_read_b128 v[180:183], v15 offset:8192
  s_nop 2
  v_exp_f32 v0, v128
  v_exp_f32 v1, v129
  v_exp_f32 v8, v130
  v_exp_f32 v9, v131
  v_mfma_f32_32x32x16_bf16 v[80:95], v[196:199], v[168:171], v[80:95]
  ds_read_b64_tr_b16 v[196:197], v19 offset:28672
  ds_read_b64_tr_b16 v[198:199], v19 offset:30720
  v_cvt_pk_bf16_f32 v160, v0, v1
  v_add_f32 v5, v0, v1
  v_exp_f32 v0, v132
  s_waitcnt lgkmcnt(9)
  v_mfma_f32_32x32x16_bf16 v[144:159], v[184:187], v[40:43], v[144:159]
  ds_read_b128 v[184:187], v16 offset:8192
  v_exp_f32 v1, v133
  v_cvt_pk_bf16_f32 v161, v8, v9
  v_add_f32 v5, v5, v8
  v_add_f32 v5, v5, v9
  v_mfma_f32_32x32x16_bf16 v[96:111], v[200:203], v[168:171], v[96:111]
  ds_read_b64_tr_b16 v[200:201], v20 offset:28672
  ds_read_b64_tr_b16 v[202:203], v20 offset:30720
  v_exp_f32 v8, v134
  v_exp_f32 v9, v135
  v_cvt_pk_bf16_f32 v162, v0, v1
  s_waitcnt lgkmcnt(9)
  v_mfma_f32_32x32x16_bf16 v[144:159], v[188:191], v[44:47], v[144:159]
  ds_read_b128 v[188:191], v17 offset:8192
  v_add_f32 v5, v5, v0
  v_add_f32 v5, v5, v1
  v_exp_f32 v0, v136
  v_exp_f32 v1, v137
  v_mfma_f32_32x32x16_bf16 v[112:127], v[204:207], v[168:171], v[112:127]
  ds_read_b64_tr_b16 v[204:205], v21 offset:28672
  ds_read_b64_tr_b16 v[206:207], v21 offset:30720
  v_cvt_pk_bf16_f32 v163, v8, v9
  v_add_f32 v5, v5, v8
  v_add_f32 v5, v5, v9
  s_waitcnt lgkmcnt(9)
  v_mfma_f32_32x32x16_bf16 v[144:159], v[176:179], v[48:51], v[144:159]
  v_exp_f32 v8, v138
  v_exp_f32 v9, v139
  v_cvt_pk_bf16_f32 v164, v0, v1
  v_add_f32 v5, v5, v0
  v_mfma_f32_32x32x16_bf16 v[64:79], v[192:195], v[172:175], v[64:79]
  v_add_f32 v5, v5, v1
  v_exp_f32 v0, v140
  v_exp_f32 v1, v141
  s_waitcnt lgkmcnt(0)
  s_barrier
  ds_read_b128 v[176:179], v10 offset:16384
  ds_read_b64_tr_b16 v[192:193], v18 offset:0
  ds_read_b64_tr_b16 v[194:195], v18 offset:2048
  v_mfma_f32_32x32x16_bf16 v[144:159], v[180:183], v[52:55], v[144:159]
  ds_read_b128 v[180:183], v11 offset:16384
  v_cvt_pk_bf16_f32 v165, v8, v9
  v_add_f32 v5, v5, v8
  v_add_f32 v5, v5, v9
  v_exp_f32 v8, v142
  v_mfma_f32_32x32x16_bf16 v[80:95], v[196:199], v[172:175], v[80:95]
  ds_read_b64_tr_b16 v[196:197], v19 offset:0
  ds_read_b64_tr_b16 v[198:199], v19 offset:2048
  v_exp_f32 v9, v143
  v_cvt_pk_bf16_f32 v166, v0, v1
  v_add_f32 v5, v5, v0
  v_mfma_f32_32x32x16_bf16 v[144:159], v[184:187], v[56:59], v[144:159]
  ds_read_b128 v[184:187], v12 offset:16384
  v_add_f32 v5, v5, v1
  s_nop 0
  v_cvt_pk_bf16_f32 v167, v8, v9
  v_add_f32 v5, v5, v8
  v_mfma_f32_32x32x16_bf16 v[96:111], v[200:203], v[172:175], v[96:111]
  ds_read_b64_tr_b16 v[200:201], v20 offset:0
  ds_read_b64_tr_b16 v[202:203], v20 offset:2048
  v_add_f32 v5, v5, v9
  v_or3_b32 v31, v160, v161, v162
  v_or3_b32 v6, v163, v164, v165
  v_mfma_f32_32x32x16_bf16 v[144:159], v[188:191], v[60:63], v[144:159]
  ds_read_b128 v[188:191], v13 offset:16384
  v_or3_b32 v31, v31, v166, v167
  v_or_b32 v31, v31, v6
  v_and_b32 v31, s100, v31
  v_cmp_ne_u32 vcc, 0, v31
  v_mfma_f32_32x32x16_bf16 v[112:127], v[204:207], v[172:175], v[112:127]
  ds_read_b64_tr_b16 v[204:205], v21 offset:0
  ds_read_b64_tr_b16 v[206:207], v21 offset:2048
  s_cbranch_vccnz L_slow_l1
L_slowret_l1:
  v_add_f32 v4, v4, v5
  s_cmp_lg_u32 s54, 0
  s_cbranch_scc1 L_resc_l2
L_rescret_l2:
  s_waitcnt lgkmcnt(9)
  v_mfma_f32_32x32x16_bf16 v[128:143], v[176:179], v[32:35], v[240:255]
  ds_read_b128 v[176:179], v14 offset:16384
  v_mfma_f32_32x32x16_bf16 v[64:79], v[192:195], v[160:163], v[64:79]
  ds_read_b64_tr_b16 v[192:193], v18 offset:4096
  ds_read_b64_tr_b16 v[194:195], v18 offset:6144
  s_waitcnt lgkmcnt(9)
  v_mfma_f32_32x32x16_bf16 v[128:143], v[180:183], v[36:39], v[128:143]
  ds_read_b128 v[180:183], v15 offset:16384
  s_nop 2
  v_exp_f32 v0, v144
  v_exp_f32 v1, v145
  v_exp_f32 v8, v146
  v_exp_f32 v9, v147
  v_mfma_f32_32x32x16_bf16 v[80:95], v[196:199], v[160:163], v[80:95]
  ds_read_b64_tr_b16 v[196:197], v19 offset:4096
  ds_read_b64_tr_b16 v[198:199], v19 offset:6144
  v_cvt_pk_bf16_f32 v168, v0, v1
  v_add_f32 v5, v0, v1
  v_exp_f32 v0, v148
  s_waitcnt lgkmcnt(9)
  v_mfma_f32_32x32x16_bf16 v[128:143], v[184:187], v[40:43], v[128:143]
  ds_read_b128 v[184:187], v16 offset:16384
  v_exp_f32 v1, v149
  v_cvt_pk_bf16_f32 v169, v8, v9
  v_add_f32 v5, v5, v8
  v_add_f32 v5, v5, v9
  v_mfma_f32_32x32x16_bf16 v[96:111], v[200:203], v[160:163], v[96:111]
  ds_read_b64_tr_b16 v[200:201], v20 offset:4096
  ds_read_b64_tr_b16 v[202:203], v20 offset:6144
  v_exp_f32 v8, v150
  v_exp_f32 v9, v151
  v_cvt_pk_bf16_f32 v170, v0, v1
  s_waitcnt lgkmcnt(9)
  v_mfma_f32_32x32x16_bf16 v[128:143], v[188:191], v[44:47], v[128:143]
  ds_read_b128 v[188:191], v17 offset:16384
  v_add_f32 v5, v5, v0
  v_add_f32 v5, v5, v1
  v_exp_f32 v0, v152
  v_exp_f32 v1, v153
  v_mfma_f32_32x32x16_bf16 v[112:127], v[204:207], v[160:163], v[112:127]
  ds_read_b64_tr_b16 v[204:205], v21 offset:4096
  ds_read_b64_tr_b16 v[206:207], v21 offset:6144
  v_cvt_pk_bf16_f32 v171, v8, v9
  v_add_f32 v5, v5, v8
  v_add_f32 v5, v5, v9
  s_waitcnt lgkmcnt(9)
  v_mfma_f32_32x32x16_bf16 v[128:143], v[176:179], v[48:51], v[128:143]
  v_exp_f32 v8, v154
  v_exp_f32 v9, v155
  v_cvt_pk_bf16_f32 v172, v0, v1
  v_add_f32 v5, v5, v0
  v_mfma_f32_32x32x16_bf16 v[64:79], v[192:195], v[164:167], v[64:79]
  v_add_f32 v5, v5, v1
  v_exp_f32 v0, v156
  v_exp_f32 v1, v157
  s_waitcnt lgkmcnt(0)
  s_barrier
  ds_read_b128 v[176:179], v10 offset:24576
  ds_read_b64_tr_b16 v[192:193], v18 offset:8192
  ds_read_b64_tr_b16 v[194:195], v18 offset:10240
  v_mfma_f32_32x32x16_bf16 v[128:143], v[180:183], v[52:55], v[128:143]
  ds_read_b128 v[180:183], v11 offset:24576
  v_cvt_pk_bf16_f32 v173, v8, v9
  v_add_f32 v5, v5, v8
  v_add_f32 v5, v5, v9
  v_exp_f32 v8, v158
  v_mfma_f32_32x32x16_bf16 v[80:95], v[196:199], v[164:167], v[80:95]
  ds_read_b64_tr_b16 v[196:197], v19 offset:8192
  ds_read_b64_tr_b16 v[198:199], v19 offset:10240
  v_exp_f32 v9, v159
  v_cvt_pk_bf16_f32 v174, v0, v1
  v_add_f32 v5, v5, v0
  v_mfma_f32_32x32x16_bf16 v[128:143], v[184:187], v[56:59], v[128:143]
  ds_read_b128 v[184:187], v12 offset:24576
  v_add_f32 v5, v5, v1
  s_nop 0
  v_cvt_pk_bf16_f32 v175, v8, v9
  v_add_f32 v5, v5, v8
  v_mfma_f32_32x32x16_bf16 v[96:111], v[200:203], v[164:167], v[96:111]
  ds_read_b64_tr_b16 v[200:201], v20 offset:8192
  ds_read_b64_tr_b16 v[202:203], v20 offset:10240
  v_add_f32 v5, v5, v9
  v_or3_b32 v31, v168, v169, v170
  v_or3_b32 v6, v171, v172, v173
  v_mfma_f32_32x32x16_bf16 v[128:143], v[188:191], v[60:63], v[128:143]
  ds_read_b128 v[188:191], v13 offset:24576
  v_or3_b32 v31, v31, v174, v175
  v_or_b32 v31, v31, v6
  v_and_b32 v31, s100, v31
  v_cmp_ne_u32 vcc, 0, v31
  v_mfma_f32_32x32x16_bf16 v[112:127], v[204:207], v[164:167], v[112:127]
  ds_read_b64_tr_b16 v[204:205], v21 offset:8192
  ds_read_b64_tr_b16 v[206:207], v21 offset:10240
  s_cbranch_vccnz L_slow_l2
L_slowret_l2:
  v_add_f32 v4, v4, v5
  s_sub_u32 s55, s55, 1
  s_cmp_lg_u32 s55, 0
  s_cbranch_scc1 L_attloop
  s_cmp_lg_u32 s54, 0
  s_cbranch_scc1 L_resc_t15
L_rescret_t15:
  s_waitcnt lgkmcnt(9)
  v_mfma_f32_32x32x16_bf16 v[144:159], v[176:179], v[32:35], v[240:255]
  ds_read_b128 v[176:179], v14 offset:24576
  v_mfma_f32_32x32x16_bf16 v[64:79], v[192:195], v[168:171], v[64:79]
  ds_read_b64_tr_b16 v[192:193], v18 offset:12288
  ds_read_b64_tr_b16 v[194:195], v18 offset:14336
  s_waitcnt lgkmcnt(9)
  v_mfma_f32_32x32x16_bf16 v[144:159], v[180:183], v[36:39], v[144:159]
  ds_read_b128 v[180:183], v15 offset:24576
  s_nop 2
  v_exp_f32 v0, v128
  v_exp_f32 v1, v129
  v_exp_f32 v8, v130
  v_exp_f32 v9, v131
  v_mfma_f32_32x32x16_bf16 v[80:95], v[196:199], v[168:171], v[80:95]
  ds_read_b64_tr_b16 v[196:197], v19 offset:12288
  ds_read_b64_tr_b16 v[198:199], v19 offset:14336
  v_cvt_pk_bf16_f32 v160, v0, v1
  v_add_f32 v5, v0, v1
  v_exp_f32 v0, v132
  s_waitcnt lgkmcnt(9)
  v_mfma_f32_32x32x16_bf16 v[144:159], v[184:187], v[40:43], v[144:159]
  ds_read_b128 v[184:187], v16 offset:24576
  v_exp_f32 v1, v133
  v_cvt_pk_bf16_f32 v161, v8, v9
  v_add_f32 v5, v5, v8
  v_add_f32 v5, v5, v9
  v_mfma_f32_32x32x16_bf16 v[96:111], v[200:203], v[168:171], v[96:111]
  ds_read_b64_tr_b16 v[200:201], v20 offset:12288
  ds_read_b64_tr_b16 v[202:203], v20 offset:14336
  v_exp_f32 v8, v134
  v_exp_f32 v9, v135
  v_cvt_pk_bf16_f32 v162, v0, v1
  s_waitcnt lgkmcnt(9)
  v_mfma_f32_32x32x16_bf16 v[144:159], v[188:191], v[44:47], v[144:159]
  ds_read_b128 v[188:191], v17 offset:24576
  v_add_f32 v5, v5, v0
  v_add_f32 v5, v5, v1
  v_exp_f32 v0, v136
  v_exp_f32 v1, v137
  v_mfma_f32_32x32x16_bf16 v[112:127], v[204:207], v[168:171], v[112:127]
  ds_read_b64_tr_b16 v[204:205], v21 offset:12288
  ds_read_b64_tr_b16 v[206:207], v21 offset:14336
  v_cvt_pk_bf16_f32 v163, v8, v9
  v_add_f32 v5, v5, v8
  v_add_f32 v5, v5, v9
  s_waitcnt lgkmcnt(9)
  v_mfma_f32_32x32x16_bf16 v[144:159], v[176:179], v[48:51], v[144:159]
  v_exp_f32 v8, v138
  v_exp_f32 v9, v139
  v_cvt_pk_bf16_f32 v164, v0, v1
  v_add_f32 v5, v5, v0
  v_mfma_f32_32x32x16_bf16 v[64:79], v[192:195], v[172:175], v[64:79]
  v_add_f32 v5, v5, v1
  v_exp_f32 v0, v140
  v_exp_f32 v1, v141
  s_waitcnt lgkmcnt(0)
  s_barrier
  ds_read_b64_tr_b16 v[192:193], v18 offset:16384
  ds_read_b64_tr_b16 v[194:195], v18 offset:18432
  v_mfma_f32_32x32x16_bf16 v[144:159], v[180:183], v[52:55], v[144:159]
  v_cvt_pk_bf16_f32 v165, v8, v9
  v_add_f32 v5, v5, v8
  v_add_f32 v5, v5, v9
  v_exp_f32 v8, v142
  v_mfma_f32_32x32x16_bf16 v[80:95], v[196:199], v[172:175], v[80:95]
  ds_read_b64_tr_b16 v[196:197], v19 offset:16384
  ds_read_b64_tr_b16 v[198:199], v19 offset:18432
  v_exp_f32 v9, v143
  v_cvt_pk_bf16_f32 v166, v0, v1
  v_add_f32 v5, v5, v0
  v_mfma_f32_32x32x16_bf16 v[144:159], v[184:187], v[56:59], v[144:159]
  v_add_f32 v5, v5, v1
  s_nop 0
  v_cvt_pk_bf16_f32 v167, v8, v9
  v_add_f32 v5, v5, v8
  v_mfma_f32_32x32x16_bf16 v[96:111], v[200:203], v[172:175], v[96:111]
  ds_read_b64_tr_b16 v[200:201], v20 offset:16384
  ds_read_b64_tr_b16 v[202:203], v20 offset:18432
  v_add_f32 v5, v5, v9
  v_or3_b32 v31, v160, v161, v162
  v_or3_b32 v6, v163, v164, v165
  v_mfma_f32_32x32x16_bf16 v[144:159], v[188:191], v[60:63], v[144:159]
  v_or3_b32 v31, v31, v166, v167
  v_or_b32 v31, v31, v6
  v_and_b32 v31, s100, v31
  v_cmp_ne_u32 vcc, 0, v31
  v_mfma_f32_32x32x16_bf16 v[112:127], v[204:207], v[172:175], v[112:127]
  ds_read_b64_tr_b16 v[204:205], v21 offset:16384
  ds_read_b64_tr_b16 v[206:207], v21 offset:18432
  s_cbranch_vccnz L_slow_t15
L_slowret_t15:
  v_add_f32 v4, v4, v5
  s_cmp_lg_u32 s54, 0
  s_cbranch_scc1 L_resc_t16
L_rescret_t16:
  s_waitcnt lgkmcnt(6)
  v_mfma_f32_32x32x16_bf16 v[64:79], v[192:195], v[160:163], v[64:79]
  ds_read_b64_tr_b16 v[192:193], v18 offset:20480
  ds_read_b64_tr_b16 v[194:195], v18 offset:22528
  s_waitcnt lgkmcnt(6)
  v_mfma_f32_32x32x16_bf16 v[80:95], v[196:199], v[160:163], v[80:95]
  ds_read_b64_tr_b16 v[196:197], v19 offset:20480
  ds_read_b64_tr_b16 v[198:199], v19 offset:22528
  s_nop 3
  v_exp_f32 v0, v144
  v_exp_f32 v1, v145
  v_exp_f32 v8, v146
  v_exp_f32 v9, v147
  v_cvt_pk_bf16_f32 v168, v0, v1
  v_add_f32 v5, v0, v1
  v_exp_f32 v0, v148
  s_waitcnt lgkmcnt(6)
  v_mfma_f32_32x32x16_bf16 v[96:111], v[200:203], v[160:163], v[96:111]
  ds_read_b64_tr_b16 v[200:201], v20 offset:20480
  ds_read_b64_tr_b16 v[202:203], v20 offset:22528
  v_exp_f32 v1, v149
  v_cvt_pk_bf16_f32 v169, v8, v9
  v_add_f32 v5, v5, v8
  v_add_f32 v5, v5, v9
  v_exp_f32 v8, v150
  v_exp_f32 v9, v151
  v_cvt_pk_bf16_f32 v170, v0, v1
  s_waitcnt lgkmcnt(6)
  v_mfma_f32_32x32x16_bf16 v[112:127], v[204:207], v[160:163], v[112:127]
  ds_read_b64_tr_b16 v[204:205], v21 offset:20480
  ds_read_b64_tr_b16 v[206:207], v21 offset:22528
  v_add_f32 v5, v5, v0
  v_add_f32 v5, v5, v1
  v_exp_f32 v0, v152
  v_exp_f32 v1, v153
  v_cvt_pk_bf16_f32 v171, v8, v9
  v_add_f32 v5, v5, v8
  v_add_f32 v5, v5, v9
  s_waitcnt lgkmcnt(6)
  v_mfma_f32_32x32x16_bf16 v[64:79], v[192:195], v[164:167], v[64:79]
  v_exp_f32 v8, v154
  v_exp_f32 v9, v155
  v_cvt_pk_bf16_f32 v172, v0, v1
  v_add_f32 v5, v5, v0
  v_add_f32 v5, v5, v1
  v_exp_f32 v0, v156
  v_exp_f32 v1, v157
  s_waitcnt lgkmcnt(0)
  s_barrier
  ds_read_b64_tr_b16 v[192:193], v18 offset:24576
  ds_read_b64_tr_b16 v[194:195], v18 offset:26624
  v_mfma_f32_32x32x16_bf16 v[80:95], v[196:199], v[164:167], v[80:95]
  ds_read_b64_tr_b16 v[196:197], v19 offset:24576
  ds_read_b64_tr_b16 v[198:199], v19 offset:26624
  v_cvt_pk_bf16_f32 v173, v8, v9
  v_add_f32 v5, v5, v8
  v_add_f32 v5, v5, v9
  v_exp_f32 v8, v158
  v_exp_f32 v9, v159
  v_cvt_pk_bf16_f32 v174, v0, v1
  v_add_f32 v5, v5, v0
  v_mfma_f32_32x32x16_bf16 v[96:111], v[200:203], v[164:167], v[96:111]
  ds_read_b64_tr_b16 v[200:201], v20 offset:24576
  ds_read_b64_tr_b16 v[202:203], v20 offset:26624
  v_add_f32 v5, v5, v1
  s_nop 0
  v_cvt_pk_bf16_f32 v175, v8, v9
  v_add_f32 v5, v5, v8
  v_add_f32 v5, v5, v9
  v_or3_b32 v31, v168, v169, v170
  v_or3_b32 v6, v171, v172, v173
  v_mfma_f32_32x32x16_bf16 v[112:127], v[204:207], v[164:167], v[112:127]
  ds_read_b64_tr_b16 v[204:205], v21 offset:24576
  ds_read_b64_tr_b16 v[206:207], v21 offset:26624
  v_or3_b32 v31, v31, v174, v175
  v_or_b32 v31, v31, v6
  v_and_b32 v31, s100, v31
  v_cmp_ne_u32 vcc, 0, v31
  s_cbranch_vccnz L_slow_t16
L_slowret_t16:
  v_add_f32 v4, v4, v5
  s_lshl_b32 s60, s58, 13
  s_add_u32 s60, s60, 65536
  v_lshlrev_b32 v6, 4, v30
  v_add_u32 v6, s60, v6
  s_cmp_lg_u32 s54, 0
  s_cbranch_scc1 L_resc_t17
L_rescret_t17:
  s_waitcnt lgkmcnt(6)
  v_mfma_f32_32x32x16_bf16 v[64:79], v[192:195], v[168:171], v[64:79]
  ds_read_b64_tr_b16 v[192:193], v18 offset:28672
  ds_read_b64_tr_b16 v[194:195], v18 offset:30720
  ds_read_b128 v[128:131], v6 offset:0
  ds_read_b128 v[132:135], v6 offset:1024
  ds_read_b128 v[136:139], v6 offset:2048
  ds_read_b128 v[140:143], v6 offset:3072
  s_waitcnt lgkmcnt(10)
  v_mfma_f32_32x32x16_bf16 v[80:95], v[196:199], v[168:171], v[80:95]
  ds_read_b64_tr_b16 v[196:197], v19 offset:28672
  ds_read_b64_tr_b16 v[198:199], v19 offset:30720
  ds_read_b128 v[144:147], v6 offset:4096
  ds_read_b128 v[148:151], v6 offset:5120
  ds_read_b128 v[152:155], v6 offset:6144
  ds_read_b128 v[156:159], v6 offset:7168
  s_waitcnt lgkmcnt(14)
  v_mfma_f32_32x32x16_bf16 v[96:111], v[200:203], v[168:171], v[96:111]
  ds_read_b64_tr_b16 v[200:201], v20 offset:28672
  ds_read_b64_tr_b16 v[202:203], v20 offset:30720
  s_waitcnt lgkmcnt(14)
  v_mfma_f32_32x32x16_bf16 v[112:127], v[204:207], v[168:171], v[112:127]
  ds_read_b64_tr_b16 v[204:205], v21 offset:28672
  ds_read_b64_tr_b16 v[206:207], v21 offset:30720
  s_waitcnt lgkmcnt(14)
  v_mfma_f32_32x32x16_bf16 v[64:79], v[192:195], v[172:175], v[64:79]
  s_waitcnt lgkmcnt(0)
  s_barrier
  v_mfma_f32_32x32x16_bf16 v[80:95], v[196:199], v[172:175], v[80:95]
  v_mfma_f32_32x32x16_bf16 v[96:111], v[200:203], v[172:175], v[96:111]
  v_mfma_f32_32x32x16_bf16 v[112:127], v[204:207], v[172:175], v[112:127]
  v_mov_b32 v1, v4
  s_nop 1
  v_permlane32_swap_b32 v4, v1
  v_add_f32 v4, v4, v1
  v_rcp_f32 v0, v4
  s_nop 4
  v_mov_b32 v1, v0
  s_cmp_eq_u32 s56, 1
  s_cbranch_scc1 L_epi2
  v_pk_mul_f32 v[64:65], v[64:65], v[0:1]
  v_pk_mul_f32 v[66:67], v[66:67], v[0:1]
  v_pk_mul_f32 v[68:69], v[68:69], v[0:1]
  v_pk_mul_f32 v[70:71], v[70:71], v[0:1]
  v_pk_mul_f32 v[72:73], v[72:73], v[0:1]
  v_pk_mul_f32 v[74:75], v[74:75], v[0:1]
  v_pk_mul_f32 v[76:77], v[76:77], v[0:1]
  v_pk_mul_f32 v[78:79], v[78:79], v[0:1]
  v_cvt_pk_bf16_f32 v208, v64, v65
  v_cvt_pk_bf16_f32 v209, v66, v67
  v_cvt_pk_bf16_f32 v210, v68, v69
  v_cvt_pk_bf16_f32 v211, v70, v71
  v_cvt_pk_bf16_f32 v212, v72, v73
  v_cvt_pk_bf16_f32 v213, v74, v75
  v_cvt_pk_bf16_f32 v214, v76, v77
  v_cvt_pk_bf16_f32 v215, v78, v79
  v_pk_mul_f32 v[80:81], v[80:81], v[0:1]
  v_pk_mul_f32 v[82:83], v[82:83], v[0:1]
  v_pk_mul_f32 v[84:85], v[84:85], v[0:1]
  v_pk_mul_f32 v[86:87], v[86:87], v[0:1]
  v_pk_mul_f32 v[88:89], v[88:89], v[0:1]
  v_pk_mul_f32 v[90:91], v[90:91], v[0:1]
  v_pk_mul_f32 v[92:93], v[92:93], v[0:1]
  v_pk_mul_f32 v[94:95], v[94:95], v[0:1]
  v_cvt_pk_bf16_f32 v216, v80, v81
  v_cvt_pk_bf16_f32 v217, v82, v83
  v_cvt_pk_bf16_f32 v218, v84, v85
  v_cvt_pk_bf16_f32 v219, v86, v87
  v_cvt_pk_bf16_f32 v220, v88, v89
  v_cvt_pk_bf16_f32 v221, v90, v91
  v_cvt_pk_bf16_f32 v222, v92, v93
  v_cvt_pk_bf16_f32 v223, v94, v95
  v_pk_mul_f32 v[96:97], v[96:97], v[0:1]
  v_pk_mul_f32 v[98:99], v[98:99], v[0:1]
  v_pk_mul_f32 v[100:101], v[100:101], v[0:1]
  v_pk_mul_f32 v[102:103], v[102:103], v[0:1]
  v_pk_mul_f32 v[104:105], v[104:105], v[0:1]
  v_pk_mul_f32 v[106:107], v[106:107], v[0:1]
  v_pk_mul_f32 v[108:109], v[108:109], v[0:1]
  v_pk_mul_f32 v[110:111], v[110:111], v[0:1]
  v_cvt_pk_bf16_f32 v224, v96, v97
  v_cvt_pk_bf16_f32 v225, v98, v99
  v_cvt_pk_bf16_f32 v226, v100, v101
  v_cvt_pk_bf16_f32 v227, v102, v103
  v_cvt_pk_bf16_f32 v228, v104, v105
  v_cvt_pk_bf16_f32 v229, v106, v107
  v_cvt_pk_bf16_f32 v230, v108, v109
  v_cvt_pk_bf16_f32 v231, v110, v111
  v_pk_mul_f32 v[112:113], v[112:113], v[0:1]
  v_pk_mul_f32 v[114:115], v[114:115], v[0:1]
  v_pk_mul_f32 v[116:117], v[116:117], v[0:1]
  v_pk_mul_f32 v[118:119], v[118:119], v[0:1]
  v_pk_mul_f32 v[120:121], v[120:121], v[0:1]
  v_pk_mul_f32 v[122:123], v[122:123], v[0:1]
  v_pk_mul_f32 v[124:125], v[124:125], v[0:1]
  v_pk_mul_f32 v[126:127], v[126:127], v[0:1]
  v_cvt_pk_bf16_f32 v232, v112, v113
  v_cvt_pk_bf16_f32 v233, v114, v115
  v_cvt_pk_bf16_f32 v234, v116, v117
  v_cvt_pk_bf16_f32 v235, v118, v119
  v_cvt_pk_bf16_f32 v236, v120, v121
  v_cvt_pk_bf16_f32 v237, v122, v123
  v_cvt_pk_bf16_f32 v238, v124, v125
  v_cvt_pk_bf16_f32 v239, v126, v127
  s_branch L_epid
L_epi2:
  v_pk_mul_f32 v[64:65], v[64:65], v[0:1]
  v_pk_mul_f32 v[66:67], v[66:67], v[0:1]
  v_pk_mul_f32 v[68:69], v[68:69], v[0:1]
  v_pk_mul_f32 v[70:71], v[70:71], v[0:1]
  v_pk_mul_f32 v[72:73], v[72:73], v[0:1]
  v_pk_mul_f32 v[74:75], v[74:75], v[0:1]
  v_pk_mul_f32 v[76:77], v[76:77], v[0:1]
  v_pk_mul_f32 v[78:79], v[78:79], v[0:1]
  v_cvt_pk_bf16_f32 v32, v64, v65
  v_cvt_pk_bf16_f32 v33, v66, v67
  v_cvt_pk_bf16_f32 v34, v68, v69
  v_cvt_pk_bf16_f32 v35, v70, v71
  v_cvt_pk_bf16_f32 v36, v72, v73
  v_cvt_pk_bf16_f32 v37, v74, v75
  v_cvt_pk_bf16_f32 v38, v76, v77
  v_cvt_pk_bf16_f32 v39, v78, v79
  v_pk_mul_f32 v[80:81], v[80:81], v[0:1]
  v_pk_mul_f32 v[82:83], v[82:83], v[0:1]
  v_pk_mul_f32 v[84:85], v[84:85], v[0:1]
  v_pk_mul_f32 v[86:87], v[86:87], v[0:1]
  v_pk_mul_f32 v[88:89], v[88:89], v[0:1]
  v_pk_mul_f32 v[90:91], v[90:91], v[0:1]
  v_pk_mul_f32 v[92:93], v[92:93], v[0:1]
  v_pk_mul_f32 v[94:95], v[94:95], v[0:1]
  v_cvt_pk_bf16_f32 v40, v80, v81
  v_cvt_pk_bf16_f32 v41, v82, v83
  v_cvt_pk_bf16_f32 v42, v84, v85
  v_cvt_pk_bf16_f32 v43, v86, v87
  v_cvt_pk_bf16_f32 v44, v88, v89
  v_cvt_pk_bf16_f32 v45, v90, v91
  v_cvt_pk_bf16_f32 v46, v92, v93
  v_cvt_pk_bf16_f32 v47, v94, v95
  v_pk_mul_f32 v[96:97], v[96:97], v[0:1]
  v_pk_mul_f32 v[98:99], v[98:99], v[0:1]
  v_pk_mul_f32 v[100:101], v[100:101], v[0:1]
  v_pk_mul_f32 v[102:103], v[102:103], v[0:1]
  v_pk_mul_f32 v[104:105], v[104:105], v[0:1]
  v_pk_mul_f32 v[106:107], v[106:107], v[0:1]
  v_pk_mul_f32 v[108:109], v[108:109], v[0:1]
  v_pk_mul_f32 v[110:111], v[110:111], v[0:1]
  v_cvt_pk_bf16_f32 v48, v96, v97
  v_cvt_pk_bf16_f32 v49, v98, v99
  v_cvt_pk_bf16_f32 v50, v100, v101
  v_cvt_pk_bf16_f32 v51, v102, v103
  v_cvt_pk_bf16_f32 v52, v104, v105
  v_cvt_pk_bf16_f32 v53, v106, v107
  v_cvt_pk_bf16_f32 v54, v108, v109
  v_cvt_pk_bf16_f32 v55, v110, v111
  v_pk_mul_f32 v[112:113], v[112:113], v[0:1]
  v_pk_mul_f32 v[114:115], v[114:115], v[0:1]
  v_pk_mul_f32 v[116:117], v[116:117], v[0:1]
  v_pk_mul_f32 v[118:119], v[118:119], v[0:1]
  v_pk_mul_f32 v[120:121], v[120:121], v[0:1]
  v_pk_mul_f32 v[122:123], v[122:123], v[0:1]
  v_pk_mul_f32 v[124:125], v[124:125], v[0:1]
  v_pk_mul_f32 v[126:127], v[126:127], v[0:1]
  v_cvt_pk_bf16_f32 v56, v112, v113
  v_cvt_pk_bf16_f32 v57, v114, v115
  v_cvt_pk_bf16_f32 v58, v116, v117
  v_cvt_pk_bf16_f32 v59, v118, v119
  v_cvt_pk_bf16_f32 v60, v120, v121
  v_cvt_pk_bf16_f32 v61, v122, v123
  v_cvt_pk_bf16_f32 v62, v124, v125
  v_cvt_pk_bf16_f32 v63, v126, v127
L_epid:
  s_waitcnt lgkmcnt(0)
  s_sub_u32 s56, s56, 1
  s_cmp_lg_u32 s56, 0
  s_cbranch_scc1 L_pass
  s_cmp_lg_u32 s57, 0
  s_cbranch_scc1 L_y_end
  v_lshrrev_b32 v100, 5, v30
  v_and_b32 v101, 31, v30
  v_bfe_u32 v102, v30, 4, 1
  v_bfe_u32 v103, v30, 2, 2
  v_and_b32 v104, 3, v30
  v_add_u32 v105, 0, v30
  v_mul_u32_u24 v106, 2731, v105
  v_lshrrev_b32 v106, 16, v106
  v_mul_u32_u24 v107, 24, v106
  v_sub_u32 v105, v105, v107
  v_bfe_u32 v107, v106, 1, 1
  v_lshlrev_b32 v107, 2, v107
  v_xor_b32 v105, v105, v107
  v_mul_u32_u24 v106, 1152, v106
  v_lshl_add_u32 v105, v105, 4, v106
  v_subrev_u32 v246, 0, v105
  v_add_u32 v105, 64, v30
  v_mul_u32_u24 v106, 2731, v105
  v_lshrrev_b32 v106, 16, v106
  v_mul_u32_u24 v107, 24, v106
  v_sub_u32 v105, v105, v107
  v_bfe_u32 v107, v106, 1, 1
  v_lshlrev_b32 v107, 2, v107
  v_xor_b32 v105, v105, v107
  v_mul_u32_u24 v106, 1152, v106
  v_lshl_add_u32 v105, v105, 4, v106
  v_subrev_u32 v247, 1024, v105
  v_add_u32 v105, 128, v30
  v_mul_u32_u24 v106, 2731, v105
  v_lshrrev_b32 v106, 16, v106
  v_mul_u32_u24 v107, 24, v106
  v_sub_u32 v105, v105, v107
  v_bfe_u32 v107, v106, 1, 1
  v_lshlrev_b32 v107, 2, v107
  v_xor_b32 v105, v105, v107
  v_mul_u32_u24 v106, 1152, v106
  v_lshl_add_u32 v105, v105, 4, v106
  v_subrev_u32 v248, 2048, v105
  s_mul_i32 s70, s51, 3072
  s_lshl_b32 s60, s8, 8
  s_lshl_b32 s61, s51, 3
  s_add_u32 s60, s60, s61
  s_mul_i32 s69, s60, 1152
  s_lshl_b32 s59, s57, 1
  s_mul_i32 s63, s57, 3
  s_cmp_eq_u32 s58, 2
  s_cselect_b32 s59, s63, s59
  v_lshl_add_u32 v105, v100, 2, v103
  v_mul_u32_u24 v105, 384, v105
  v_lshl_add_u32 v105, v102, 5, v105
  v_lshl_add_u32 v105, v104, 3, v105
  v_lshrrev_b32 v106, 1, v103
  s_add_u32 s63, s59, 0
  v_xor_b32 v107, s63, v106
  v_lshl_add_u32 v240, v107, 6, v105
  v_add_u32 v243, 49152, v240
  s_add_u32 s63, s59, 1
  v_xor_b32 v107, s63, v106
  v_lshl_add_u32 v241, v107, 6, v105
  v_add_u32 v244, 49152, v241
  s_add_u32 s63, s59, 2
  v_xor_b32 v107, s63, v106
  v_lshl_add_u32 v242, v107, 6, v105
  v_add_u32 v245, 49152, v242
  s_lshl_b32 s72, s48, 4
  s_add_u32 s72, s72, s49
  s_lshl_b32 s60, s72, 3
  v_mov_b32 v255, s60
  s_lshl_b32 s61, s72, 8
  s_add_u32 s61, s61, 0x2000000
  v_and_b32 v107, 7, v30
  v_lshlrev_b32 v107, 2, v107
  v_add_u32 v254, s61, v107
  s_add_u32 s60, s60, s50
  s_mul_i32 s75, s60, 49152
  s_lshl_b32 s61, s58, 13
  s_add_u32 s75, s75, s61
  s_add_u32 s75, s75, 0x2100000
  s_mul_i32 s71, s60, 110592
  s_mul_i32 s60, s59, 3
  s_add_u32 s60, s60, s58
  s_lshl_b32 s60, s60, 11
  s_add_u32 s71, s71, s60
  v_lshlrev_b32 v249, 4, v30
  s_lshl_b32 s60, s58, 13
  s_add_u32 s60, s60, 65536
  v_add_u32 v250, s60, v249
  v_add_u32 v251, 49152, v250
  ds_write_b128 v250, v[208:211] offset:0
  ds_write_b128 v250, v[212:215] offset:1024
  ds_write_b128 v250, v[216:219] offset:2048
  ds_write_b128 v250, v[220:223] offset:3072
  ds_write_b128 v250, v[224:227] offset:4096
  ds_write_b128 v250, v[228:231] offset:5120
  ds_write_b128 v250, v[232:235] offset:6144
  ds_write_b128 v250, v[236:239] offset:7168
  ds_write_b128 v251, v[32:35] offset:0
  ds_write_b128 v251, v[36:39] offset:1024
  ds_write_b128 v251, v[40:43] offset:2048
  ds_write_b128 v251, v[44:47] offset:3072
  ds_write_b128 v251, v[48:51] offset:4096
  ds_write_b128 v251, v[52:55] offset:5120
  ds_write_b128 v251, v[56:59] offset:6144
  ds_write_b128 v251, v[60:63] offset:7168
  s_waitcnt lgkmcnt(0)
  s_setprio 0
  v_add_u32 v28, 139264, v240
  v_add_u32 v29, 139264, v241
  s_mov_b32 s55, 2
L_idle1a:
  s_barrier
  s_sub_u32 s55, s55, 1
  s_cmp_lg_u32 s55, 0
  s_cbranch_scc1 L_idle1a
  ds_read_b128 v[128:131], v250 offset:0
  ds_read_b128 v[132:135], v250 offset:1024
  ds_read_b128 v[136:139], v250 offset:2048
  ds_read_b128 v[140:143], v250 offset:3072
  ds_read_b128 v[144:147], v250 offset:4096
  ds_read_b128 v[148:151], v250 offset:5120
  ds_read_b128 v[152:155], v250 offset:6144
  ds_read_b128 v[156:159], v250 offset:7168
  s_waitcnt lgkmcnt(0)
  ds_read_b128 v[208:211], v250 offset:24576
  ds_read_b128 v[212:215], v250 offset:25600
  ds_read_b128 v[216:219], v250 offset:26624
  ds_read_b128 v[220:223], v250 offset:27648
  ds_read_b128 v[224:227], v250 offset:28672
  ds_read_b128 v[228:231], v250 offset:29696
  ds_read_b128 v[232:235], v250 offset:30720
  ds_read_b128 v[236:239], v250 offset:31744
  s_waitcnt lgkmcnt(0)
  ds_read_b128 v[160:163], v251 offset:0
  ds_read_b128 v[164:167], v251 offset:1024
  ds_read_b128 v[168:171], v251 offset:2048
  ds_read_b128 v[172:175], v251 offset:3072
  ds_read_b128 v[176:179], v251 offset:4096
  ds_read_b128 v[180:183], v251 offset:5120
  ds_read_b128 v[184:187], v251 offset:6144
  ds_read_b128 v[188:191], v251 offset:7168
  s_waitcnt lgkmcnt(0)
  s_barrier
  s_barrier
  ds_read_b64_tr_b16 v[32:33], v28 offset:0
  ds_read_b64_tr_b16 v[34:35], v28 offset:3072
  ds_read_b64_tr_b16 v[36:37], v29 offset:0
  ds_read_b64_tr_b16 v[38:39], v29 offset:3072
  ds_read_b64_tr_b16 v[40:41], v28 offset:128
  ds_read_b64_tr_b16 v[42:43], v28 offset:3200
  ds_read_b64_tr_b16 v[44:45], v29 offset:128
  ds_read_b64_tr_b16 v[46:47], v29 offset:3200
  ds_read_b64_tr_b16 v[48:49], v28 offset:256
  ds_read_b64_tr_b16 v[50:51], v28 offset:3328
  ds_read_b64_tr_b16 v[52:53], v29 offset:256
  ds_read_b64_tr_b16 v[54:55], v29 offset:3328
  ds_read_b64_tr_b16 v[56:57], v28 offset:6144
  ds_read_b64_tr_b16 v[58:59], v28 offset:9216
  ds_read_b64_tr_b16 v[60:61], v29 offset:6144
  ds_read_b64_tr_b16 v[62:63], v29 offset:9216
  s_waitcnt lgkmcnt(14)
  v_mfma_f32_32x32x16_bf16 v[64:79], v[32:35], v[128:131], 0
  ds_read_b64_tr_b16 v[32:33], v28 offset:6272
  ds_read_b64_tr_b16 v[34:35], v28 offset:9344
  s_waitcnt lgkmcnt(14)
  v_mfma_f32_32x32x16_bf16 v[80:95], v[36:39], v[128:131], 0
  ds_read_b64_tr_b16 v[36:37], v29 offset:6272
  ds_read_b64_tr_b16 v[38:39], v29 offset:9344
  s_waitcnt lgkmcnt(14)
  v_mfma_f32_32x32x16_bf16 v[96:111], v[40:43], v[128:131], 0
  ds_read_b64_tr_b16 v[40:41], v28 offset:6400
  ds_read_b64_tr_b16 v[42:43], v28 offset:9472
  s_waitcnt lgkmcnt(14)
  v_mfma_f32_32x32x16_bf16 v[112:127], v[44:47], v[128:131], 0
  ds_read_b64_tr_b16 v[44:45], v29 offset:6400
  ds_read_b64_tr_b16 v[46:47], v29 offset:9472
  s_waitcnt lgkmcnt(14)
  v_mfma_f32_32x32x16_bf16 v[192:207], v[48:51], v[128:131], 0
  s_waitcnt lgkmcnt(12)
  v_mfma_f32_32x32x16_bf16 v[12:27], v[52:55], v[128:131], 0
  s_waitcnt lgkmcnt(0)
  s_barrier
  ds_read_b64_tr_b16 v[48:49], v28 offset:12288
  ds_read_b64_tr_b16 v[50:51], v28 offset:15360
  ds_read_b64_tr_b16 v[52:53], v29 offset:12288
  ds_read_b64_tr_b16 v[54:55], v29 offset:15360
  v_mfma_f32_32x32x16_bf16 v[64:79], v[56:59], v[132:135], v[64:79]
  ds_read_b64_tr_b16 v[56:57], v28 offset:12416
  ds_read_b64_tr_b16 v[58:59], v28 offset:15488
  v_mfma_f32_32x32x16_bf16 v[80:95], v[60:63], v[132:135], v[80:95]
  ds_read_b64_tr_b16 v[60:61], v29 offset:12416
  ds_read_b64_tr_b16 v[62:63], v29 offset:15488
  v_mfma_f32_32x32x16_bf16 v[96:111], v[32:35], v[132:135], v[96:111]
  ds_read_b64_tr_b16 v[32:33], v28 offset:12544
  ds_read_b64_tr_b16 v[34:35], v28 offset:15616
  v_mfma_f32_32x32x16_bf16 v[112:127], v[36:39], v[132:135], v[112:127]
  ds_read_b64_tr_b16 v[36:37], v29 offset:12544
  ds_read_b64_tr_b16 v[38:39], v29 offset:15616
  v_mfma_f32_32x32x16_bf16 v[192:207], v[40:43], v[132:135], v[192:207]
  ds_read_b64_tr_b16 v[40:41], v28 offset:18432
  ds_read_b64_tr_b16 v[42:43], v28 offset:21504
  v_mfma_f32_32x32x16_bf16 v[12:27], v[44:47], v[132:135], v[12:27]
  ds_read_b64_tr_b16 v[44:45], v29 offset:18432
  ds_read_b64_tr_b16 v[46:47], v29 offset:21504
  s_waitcnt lgkmcnt(14)
  v_mfma_f32_32x32x16_bf16 v[64:79], v[48:51], v[136:139], v[64:79]
  ds_read_b64_tr_b16 v[48:49], v28 offset:18560
  ds_read_b64_tr_b16 v[50:51], v28 offset:21632
  s_waitcnt lgkmcnt(14)
  v_mfma_f32_32x32x16_bf16 v[80:95], v[52:55], v[136:139], v[80:95]
  ds_read_b64_tr_b16 v[52:53], v29 offset:18560
  ds_read_b64_tr_b16 v[54:55], v29 offset:21632
  s_waitcnt lgkmcnt(14)
  v_mfma_f32_32x32x16_bf16 v[96:111], v[56:59], v[136:139], v[96:111]
  ds_read_b64_tr_b16 v[56:57], v28 offset:18688
  ds_read_b64_tr_b16 v[58:59], v28 offset:21760
  s_waitcnt lgkmcnt(14)
  v_mfma_f32_32x32x16_bf16 v[112:127], v[60:63], v[136:139], v[112:127]
  ds_read_b64_tr_b16 v[60:61], v29 offset:18688
  ds_read_b64_tr_b16 v[62:63], v29 offset:21760
  s_waitcnt lgkmcnt(14)
  v_mfma_f32_32x32x16_bf16 v[192:207], v[32:35], v[136:139], v[192:207]
  s_waitcnt lgkmcnt(12)
  v_mfma_f32_32x32x16_bf16 v[12:27], v[36:39], v[136:139], v[12:27]
  s_waitcnt lgkmcnt(0)
  s_barrier
  ds_read_b64_tr_b16 v[32:33], v243 offset:40960
  ds_read_b64_tr_b16 v[34:35], v243 offset:44032
  ds_read_b64_tr_b16 v[36:37], v244 offset:40960
  ds_read_b64_tr_b16 v[38:39], v244 offset:44032
  v_mfma_f32_32x32x16_bf16 v[64:79], v[40:43], v[140:143], v[64:79]
  ds_read_b64_tr_b16 v[40:41], v243 offset:41088
  ds_read_b64_tr_b16 v[42:43], v243 offset:44160
  v_mfma_f32_32x32x16_bf16 v[80:95], v[44:47], v[140:143], v[80:95]
  ds_read_b64_tr_b16 v[44:45], v244 offset:41088
  ds_read_b64_tr_b16 v[46:47], v244 offset:44160
  v_mfma_f32_32x32x16_bf16 v[96:111], v[48:51], v[140:143], v[96:111]
  ds_read_b64_tr_b16 v[48:49], v243 offset:41216
  ds_read_b64_tr_b16 v[50:51], v243 offset:44288
  v_mfma_f32_32x32x16_bf16 v[112:127], v[52:55], v[140:143], v[112:127]
  ds_read_b64_tr_b16 v[52:53], v244 offset:41216
  ds_read_b64_tr_b16 v[54:55], v244 offset:44288
  v_mfma_f32_32x32x16_bf16 v[192:207], v[56:59], v[140:143], v[192:207]
  ds_read_b64_tr_b16 v[56:57], v243 offset:47104
  ds_read_b64_tr_b16 v[58:59], v243 offset:50176
  v_mfma_f32_32x32x16_bf16 v[12:27], v[60:63], v[140:143], v[12:27]
  ds_read_b64_tr_b16 v[60:61], v244 offset:47104
  ds_read_b64_tr_b16 v[62:63], v244 offset:50176
  s_waitcnt lgkmcnt(14)
  v_mfma_f32_32x32x16_bf16 v[64:79], v[32:35], v[144:147], v[64:79]
  ds_read_b64_tr_b16 v[32:33], v243 offset:47232
  ds_read_b64_tr_b16 v[34:35], v243 offset:50304
  s_waitcnt lgkmcnt(14)
  v_mfma_f32_32x32x16_bf16 v[80:95], v[36:39], v[144:147], v[80:95]
  ds_read_b64_tr_b16 v[36:37], v244 offset:47232
  ds_read_b64_tr_b16 v[38:39], v244 offset:50304
  s_waitcnt lgkmcnt(14)
  v_mfma_f32_32x32x16_bf16 v[96:111], v[40:43], v[144:147], v[96:111]
  ds_read_b64_tr_b16 v[40:41], v243 offset:47360
  ds_read_b64_tr_b16 v[42:43], v243 offset:50432
  s_waitcnt lgkmcnt(14)
  v_mfma_f32_32x32x16_bf16 v[112:127], v[44:47], v[144:147], v[112:127]
  ds_read_b64_tr_b16 v[44:45], v244 offset:47360
  ds_read_b64_tr_b16 v[46:47], v244 offset:50432
  s_waitcnt lgkmcnt(14)
  v_mfma_f32_32x32x16_bf16 v[192:207], v[48:51], v[144:147], v[192:207]
  s_waitcnt lgkmcnt(12)
  v_mfma_f32_32x32x16_bf16 v[12:27], v[52:55], v[144:147], v[12:27]
  s_waitcnt lgkmcnt(0)
  s_barrier
  ds_read_b64_tr_b16 v[48:49], v243 offset:53248
  ds_read_b64_tr_b16 v[50:51], v243 offset:56320
  ds_read_b64_tr_b16 v[52:53], v244 offset:53248
  ds_read_b64_tr_b16 v[54:55], v244 offset:56320
  v_mfma_f32_32x32x16_bf16 v[64:79], v[56:59], v[148:151], v[64:79]
  ds_read_b64_tr_b16 v[56:57], v243 offset:53376
  ds_read_b64_tr_b16 v[58:59], v243 offset:56448
  v_mfma_f32_32x32x16_bf16 v[80:95], v[60:63], v[148:151], v[80:95]
  ds_read_b64_tr_b16 v[60:61], v244 offset:53376
  ds_read_b64_tr_b16 v[62:63], v244 offset:56448
  v_mfma_f32_32x32x16_bf16 v[96:111], v[32:35], v[148:151], v[96:111]
  ds_read_b64_tr_b16 v[32:33], v243 offset:53504
  ds_read_b64_tr_b16 v[34:35], v243 offset:56576
  v_mfma_f32_32x32x16_bf16 v[112:127], v[36:39], v[148:151], v[112:127]
  ds_read_b64_tr_b16 v[36:37], v244 offset:53504
  ds_read_b64_tr_b16 v[38:39], v244 offset:56576
  v_mfma_f32_32x32x16_bf16 v[192:207], v[40:43], v[148:151], v[192:207]
  ds_read_b64_tr_b16 v[40:41], v243 offset:59392
  ds_read_b64_tr_b16 v[42:43], v243 offset:62464
  v_mfma_f32_32x32x16_bf16 v[12:27], v[44:47], v[148:151], v[12:27]
  ds_read_b64_tr_b16 v[44:45], v244 offset:59392
  ds_read_b64_tr_b16 v[46:47], v244 offset:62464
  s_waitcnt lgkmcnt(14)
  v_mfma_f32_32x32x16_bf16 v[64:79], v[48:51], v[152:155], v[64:79]
  ds_read_b64_tr_b16 v[48:49], v243 offset:59520
  ds_read_b64_tr_b16 v[50:51], v243 offset:62592
  s_waitcnt lgkmcnt(14)
  v_mfma_f32_32x32x16_bf16 v[80:95], v[52:55], v[152:155], v[80:95]
  ds_read_b64_tr_b16 v[52:53], v244 offset:59520
  ds_read_b64_tr_b16 v[54:55], v244 offset:62592
  s_waitcnt lgkmcnt(14)
  v_mfma_f32_32x32x16_bf16 v[96:111], v[56:59], v[152:155], v[96:111]
  ds_read_b64_tr_b16 v[56:57], v243 offset:59648
  ds_read_b64_tr_b16 v[58:59], v243 offset:62720
  s_waitcnt lgkmcnt(14)
  v_mfma_f32_32x32x16_bf16 v[112:127], v[60:63], v[152:155], v[112:127]
  ds_read_b64_tr_b16 v[60:61], v244 offset:59648
  ds_read_b64_tr_b16 v[62:63], v244 offset:62720
  s_waitcnt lgkmcnt(14)
  v_mfma_f32_32x32x16_bf16 v[192:207], v[32:35], v[152:155], v[192:207]
  s_waitcnt lgkmcnt(12)
  v_mfma_f32_32x32x16_bf16 v[12:27], v[36:39], v[152:155], v[12:27]
  s_waitcnt lgkmcnt(0)
  s_barrier
  ds_read_b64_tr_b16 v[32:33], v28 offset:0
  ds_read_b64_tr_b16 v[34:35], v28 offset:3072
  ds_read_b64_tr_b16 v[36:37], v29 offset:0
  ds_read_b64_tr_b16 v[38:39], v29 offset:3072
  v_mfma_f32_32x32x16_bf16 v[64:79], v[40:43], v[156:159], v[64:79]
  ds_read_b64_tr_b16 v[40:41], v28 offset:128
  ds_read_b64_tr_b16 v[42:43], v28 offset:3200
  v_mfma_f32_32x32x16_bf16 v[80:95], v[44:47], v[156:159], v[80:95]
  ds_read_b64_tr_b16 v[44:45], v29 offset:128
  ds_read_b64_tr_b16 v[46:47], v29 offset:3200
  v_mfma_f32_32x32x16_bf16 v[96:111], v[48:51], v[156:159], v[96:111]
  ds_read_b64_tr_b16 v[48:49], v28 offset:256
  ds_read_b64_tr_b16 v[50:51], v28 offset:3328
  v_mfma_f32_32x32x16_bf16 v[112:127], v[52:55], v[156:159], v[112:127]
  ds_read_b64_tr_b16 v[52:53], v29 offset:256
  ds_read_b64_tr_b16 v[54:55], v29 offset:3328
  v_mfma_f32_32x32x16_bf16 v[192:207], v[56:59], v[156:159], v[192:207]
  ds_read_b64_tr_b16 v[56:57], v28 offset:6144
  ds_read_b64_tr_b16 v[58:59], v28 offset:9216
  v_mfma_f32_32x32x16_bf16 v[12:27], v[60:63], v[156:159], v[12:27]
  ds_read_b64_tr_b16 v[60:61], v29 offset:6144
  ds_read_b64_tr_b16 v[62:63], v29 offset:9216
  s_waitcnt lgkmcnt(14)
  v_mfma_f32_32x32x16_bf16 v[64:79], v[32:35], v[208:211], v[64:79]
  ds_read_b64_tr_b16 v[32:33], v28 offset:6272
  ds_read_b64_tr_b16 v[34:35], v28 offset:9344
  s_waitcnt lgkmcnt(14)
  v_mfma_f32_32x32x16_bf16 v[80:95], v[36:39], v[208:211], v[80:95]
  ds_read_b64_tr_b16 v[36:37], v29 offset:6272
  ds_read_b64_tr_b16 v[38:39], v29 offset:9344
  s_waitcnt lgkmcnt(14)
  v_mfma_f32_32x32x16_bf16 v[96:111], v[40:43], v[208:211], v[96:111]
  ds_read_b64_tr_b16 v[40:41], v28 offset:6400
  ds_read_b64_tr_b16 v[42:43], v28 offset:9472
  s_waitcnt lgkmcnt(14)
  v_mfma_f32_32x32x16_bf16 v[112:127], v[44:47], v[208:211], v[112:127]
  ds_read_b64_tr_b16 v[44:45], v29 offset:6400
  ds_read_b64_tr_b16 v[46:47], v29 offset:9472
  s_waitcnt lgkmcnt(14)
  v_mfma_f32_32x32x16_bf16 v[192:207], v[48:51], v[208:211], v[192:207]
  s_waitcnt lgkmcnt(12)
  v_mfma_f32_32x32x16_bf16 v[12:27], v[52:55], v[208:211], v[12:27]
  s_waitcnt lgkmcnt(0)
  s_barrier
  ds_read_b64_tr_b16 v[48:49], v28 offset:12288
  ds_read_b64_tr_b16 v[50:51], v28 offset:15360
  ds_read_b64_tr_b16 v[52:53], v29 offset:12288
  ds_read_b64_tr_b16 v[54:55], v29 offset:15360
  v_mfma_f32_32x32x16_bf16 v[64:79], v[56:59], v[212:215], v[64:79]
  ds_read_b64_tr_b16 v[56:57], v28 offset:12416
  ds_read_b64_tr_b16 v[58:59], v28 offset:15488
  v_mfma_f32_32x32x16_bf16 v[80:95], v[60:63], v[212:215], v[80:95]
  ds_read_b64_tr_b16 v[60:61], v29 offset:12416
  ds_read_b64_tr_b16 v[62:63], v29 offset:15488
  v_mfma_f32_32x32x16_bf16 v[96:111], v[32:35], v[212:215], v[96:111]
  ds_read_b64_tr_b16 v[32:33], v28 offset:12544
  ds_read_b64_tr_b16 v[34:35], v28 offset:15616
  v_mfma_f32_32x32x16_bf16 v[112:127], v[36:39], v[212:215], v[112:127]
  ds_read_b64_tr_b16 v[36:37], v29 offset:12544
  ds_read_b64_tr_b16 v[38:39], v29 offset:15616
  v_mfma_f32_32x32x16_bf16 v[192:207], v[40:43], v[212:215], v[192:207]
  ds_read_b64_tr_b16 v[40:41], v28 offset:18432
  ds_read_b64_tr_b16 v[42:43], v28 offset:21504
  v_mfma_f32_32x32x16_bf16 v[12:27], v[44:47], v[212:215], v[12:27]
  ds_read_b64_tr_b16 v[44:45], v29 offset:18432
  ds_read_b64_tr_b16 v[46:47], v29 offset:21504
  s_waitcnt lgkmcnt(14)
  v_mfma_f32_32x32x16_bf16 v[64:79], v[48:51], v[216:219], v[64:79]
  ds_read_b64_tr_b16 v[48:49], v28 offset:18560
  ds_read_b64_tr_b16 v[50:51], v28 offset:21632
  s_waitcnt lgkmcnt(14)
  v_mfma_f32_32x32x16_bf16 v[80:95], v[52:55], v[216:219], v[80:95]
  ds_read_b64_tr_b16 v[52:53], v29 offset:18560
  ds_read_b64_tr_b16 v[54:55], v29 offset:21632
  s_waitcnt lgkmcnt(14)
  v_mfma_f32_32x32x16_bf16 v[96:111], v[56:59], v[216:219], v[96:111]
  ds_read_b64_tr_b16 v[56:57], v28 offset:18688
  ds_read_b64_tr_b16 v[58:59], v28 offset:21760
  s_waitcnt lgkmcnt(14)
  v_mfma_f32_32x32x16_bf16 v[112:127], v[60:63], v[216:219], v[112:127]
  ds_read_b64_tr_b16 v[60:61], v29 offset:18688
  ds_read_b64_tr_b16 v[62:63], v29 offset:21760
  s_waitcnt lgkmcnt(14)
  v_mfma_f32_32x32x16_bf16 v[192:207], v[32:35], v[216:219], v[192:207]
  s_waitcnt lgkmcnt(12)
  v_mfma_f32_32x32x16_bf16 v[12:27], v[36:39], v[216:219], v[12:27]
  s_waitcnt lgkmcnt(0)
  s_barrier
  ds_read_b64_tr_b16 v[32:33], v243 offset:40960
  ds_read_b64_tr_b16 v[34:35], v243 offset:44032
  ds_read_b64_tr_b16 v[36:37], v244 offset:40960
  ds_read_b64_tr_b16 v[38:39], v244 offset:44032
  v_mfma_f32_32x32x16_bf16 v[64:79], v[40:43], v[220:223], v[64:79]
  ds_read_b64_tr_b16 v[40:41], v243 offset:41088
  ds_read_b64_tr_b16 v[42:43], v243 offset:44160
  v_mfma_f32_32x32x16_bf16 v[80:95], v[44:47], v[220:223], v[80:95]
  ds_read_b64_tr_b16 v[44:45], v244 offset:41088
  ds_read_b64_tr_b16 v[46:47], v244 offset:44160
  v_mfma_f32_32x32x16_bf16 v[96:111], v[48:51], v[220:223], v[96:111]
  ds_read_b64_tr_b16 v[48:49], v243 offset:41216
  ds_read_b64_tr_b16 v[50:51], v243 offset:44288
  v_mfma_f32_32x32x16_bf16 v[112:127], v[52:55], v[220:223], v[112:127]
  ds_read_b64_tr_b16 v[52:53], v244 offset:41216
  ds_read_b64_tr_b16 v[54:55], v244 offset:44288
  v_mfma_f32_32x32x16_bf16 v[192:207], v[56:59], v[220:223], v[192:207]
  ds_read_b64_tr_b16 v[56:57], v243 offset:47104
  ds_read_b64_tr_b16 v[58:59], v243 offset:50176
  v_mfma_f32_32x32x16_bf16 v[12:27], v[60:63], v[220:223], v[12:27]
  ds_read_b64_tr_b16 v[60:61], v244 offset:47104
  ds_read_b64_tr_b16 v[62:63], v244 offset:50176
  s_waitcnt lgkmcnt(14)
  v_mfma_f32_32x32x16_bf16 v[64:79], v[32:35], v[224:227], v[64:79]
  ds_read_b64_tr_b16 v[32:33], v243 offset:47232
  ds_read_b64_tr_b16 v[34:35], v243 offset:50304
  s_waitcnt lgkmcnt(14)
  v_mfma_f32_32x32x16_bf16 v[80:95], v[36:39], v[224:227], v[80:95]
  ds_read_b64_tr_b16 v[36:37], v244 offset:47232
  ds_read_b64_tr_b16 v[38:39], v244 offset:50304
  s_waitcnt lgkmcnt(14)
  v_mfma_f32_32x32x16_bf16 v[96:111], v[40:43], v[224:227], v[96:111]
  ds_read_b64_tr_b16 v[40:41], v243 offset:47360
  ds_read_b64_tr_b16 v[42:43], v243 offset:50432
  s_waitcnt lgkmcnt(14)
  v_mfma_f32_32x32x16_bf16 v[112:127], v[44:47], v[224:227], v[112:127]
  ds_read_b64_tr_b16 v[44:45], v244 offset:47360
  ds_read_b64_tr_b16 v[46:47], v244 offset:50432
  s_waitcnt lgkmcnt(14)
  v_mfma_f32_32x32x16_bf16 v[192:207], v[48:51], v[224:227], v[192:207]
  s_waitcnt lgkmcnt(12)
  v_mfma_f32_32x32x16_bf16 v[12:27], v[52:55], v[224:227], v[12:27]
  s_waitcnt lgkmcnt(0)
  s_barrier
  ds_read_b64_tr_b16 v[48:49], v243 offset:53248
  ds_read_b64_tr_b16 v[50:51], v243 offset:56320
  ds_read_b64_tr_b16 v[52:53], v244 offset:53248
  ds_read_b64_tr_b16 v[54:55], v244 offset:56320
  v_mfma_f32_32x32x16_bf16 v[64:79], v[56:59], v[228:231], v[64:79]
  ds_read_b64_tr_b16 v[56:57], v243 offset:53376
  ds_read_b64_tr_b16 v[58:59], v243 offset:56448
  v_mfma_f32_32x32x16_bf16 v[80:95], v[60:63], v[228:231], v[80:95]
  ds_read_b64_tr_b16 v[60:61], v244 offset:53376
  ds_read_b64_tr_b16 v[62:63], v244 offset:56448
  v_mfma_f32_32x32x16_bf16 v[96:111], v[32:35], v[228:231], v[96:111]
  ds_read_b64_tr_b16 v[32:33], v243 offset:53504
  ds_read_b64_tr_b16 v[34:35], v243 offset:56576
  v_mfma_f32_32x32x16_bf16 v[112:127], v[36:39], v[228:231], v[112:127]
  ds_read_b64_tr_b16 v[36:37], v244 offset:53504
  ds_read_b64_tr_b16 v[38:39], v244 offset:56576
  v_mfma_f32_32x32x16_bf16 v[192:207], v[40:43], v[228:231], v[192:207]
  ds_read_b64_tr_b16 v[40:41], v243 offset:59392
  ds_read_b64_tr_b16 v[42:43], v243 offset:62464
  v_mfma_f32_32x32x16_bf16 v[12:27], v[44:47], v[228:231], v[12:27]
  ds_read_b64_tr_b16 v[44:45], v244 offset:59392
  ds_read_b64_tr_b16 v[46:47], v244 offset:62464
  s_waitcnt lgkmcnt(14)
  v_mfma_f32_32x32x16_bf16 v[64:79], v[48:51], v[232:235], v[64:79]
  ds_read_b64_tr_b16 v[48:49], v243 offset:59520
  ds_read_b64_tr_b16 v[50:51], v243 offset:62592
  s_waitcnt lgkmcnt(14)
  v_mfma_f32_32x32x16_bf16 v[80:95], v[52:55], v[232:235], v[80:95]
  ds_read_b64_tr_b16 v[52:53], v244 offset:59520
  ds_read_b64_tr_b16 v[54:55], v244 offset:62592
  s_waitcnt lgkmcnt(14)
  v_mfma_f32_32x32x16_bf16 v[96:111], v[56:59], v[232:235], v[96:111]
  ds_read_b64_tr_b16 v[56:57], v243 offset:59648
  ds_read_b64_tr_b16 v[58:59], v243 offset:62720
  s_waitcnt lgkmcnt(14)
  v_mfma_f32_32x32x16_bf16 v[112:127], v[60:63], v[232:235], v[112:127]
  ds_read_b64_tr_b16 v[60:61], v244 offset:59648
  ds_read_b64_tr_b16 v[62:63], v244 offset:62720
  s_waitcnt lgkmcnt(14)
  v_mfma_f32_32x32x16_bf16 v[192:207], v[32:35], v[232:235], v[192:207]
  s_waitcnt lgkmcnt(12)
  v_mfma_f32_32x32x16_bf16 v[12:27], v[36:39], v[232:235], v[12:27]
  s_waitcnt lgkmcnt(0)
  s_barrier
  ds_read_b64_tr_b16 v[32:33], v28 offset:0
  ds_read_b64_tr_b16 v[34:35], v28 offset:3072
  ds_read_b64_tr_b16 v[36:37], v29 offset:0
  ds_read_b64_tr_b16 v[38:39], v29 offset:3072
  v_mfma_f32_32x32x16_bf16 v[64:79], v[40:43], v[236:239], v[64:79]
  ds_read_b64_tr_b16 v[40:41], v28 offset:128
  ds_read_b64_tr_b16 v[42:43], v28 offset:3200
  v_mfma_f32_32x32x16_bf16 v[80:95], v[44:47], v[236:239], v[80:95]
  ds_read_b64_tr_b16 v[44:45], v29 offset:128
  ds_read_b64_tr_b16 v[46:47], v29 offset:3200
  v_mfma_f32_32x32x16_bf16 v[96:111], v[48:51], v[236:239], v[96:111]
  ds_read_b64_tr_b16 v[48:49], v28 offset:256
  ds_read_b64_tr_b16 v[50:51], v28 offset:3328
  v_mfma_f32_32x32x16_bf16 v[112:127], v[52:55], v[236:239], v[112:127]
  ds_read_b64_tr_b16 v[52:53], v29 offset:256
  ds_read_b64_tr_b16 v[54:55], v29 offset:3328
  v_mfma_f32_32x32x16_bf16 v[192:207], v[56:59], v[236:239], v[192:207]
  ds_read_b64_tr_b16 v[56:57], v28 offset:6144
  ds_read_b64_tr_b16 v[58:59], v28 offset:9216
  v_mfma_f32_32x32x16_bf16 v[12:27], v[60:63], v[236:239], v[12:27]
  ds_read_b64_tr_b16 v[60:61], v29 offset:6144
  ds_read_b64_tr_b16 v[62:63], v29 offset:9216
  s_waitcnt lgkmcnt(14)
  v_mfma_f32_32x32x16_bf16 v[64:79], v[32:35], v[160:163], v[64:79]
  ds_read_b64_tr_b16 v[32:33], v28 offset:6272
  ds_read_b64_tr_b16 v[34:35], v28 offset:9344
  s_waitcnt lgkmcnt(14)
  v_mfma_f32_32x32x16_bf16 v[80:95], v[36:39], v[160:163], v[80:95]
  ds_read_b64_tr_b16 v[36:37], v29 offset:6272
  ds_read_b64_tr_b16 v[38:39], v29 offset:9344
  s_waitcnt lgkmcnt(14)
  v_mfma_f32_32x32x16_bf16 v[96:111], v[40:43], v[160:163], v[96:111]
  ds_read_b64_tr_b16 v[40:41], v28 offset:6400
  ds_read_b64_tr_b16 v[42:43], v28 offset:9472
  s_waitcnt lgkmcnt(14)
  v_mfma_f32_32x32x16_bf16 v[112:127], v[44:47], v[160:163], v[112:127]
  ds_read_b64_tr_b16 v[44:45], v29 offset:6400
  ds_read_b64_tr_b16 v[46:47], v29 offset:9472
  s_waitcnt lgkmcnt(14)
  v_mfma_f32_32x32x16_bf16 v[192:207], v[48:51], v[160:163], v[192:207]
  s_waitcnt lgkmcnt(12)
  v_mfma_f32_32x32x16_bf16 v[12:27], v[52:55], v[160:163], v[12:27]
  s_waitcnt lgkmcnt(0)
  s_barrier
  ds_read_b64_tr_b16 v[48:49], v28 offset:12288
  ds_read_b64_tr_b16 v[50:51], v28 offset:15360
  ds_read_b64_tr_b16 v[52:53], v29 offset:12288
  ds_read_b64_tr_b16 v[54:55], v29 offset:15360
  v_mfma_f32_32x32x16_bf16 v[64:79], v[56:59], v[164:167], v[64:79]
  ds_read_b64_tr_b16 v[56:57], v28 offset:12416
  ds_read_b64_tr_b16 v[58:59], v28 offset:15488
  v_mfma_f32_32x32x16_bf16 v[80:95], v[60:63], v[164:167], v[80:95]
  ds_read_b64_tr_b16 v[60:61], v29 offset:12416
  ds_read_b64_tr_b16 v[62:63], v29 offset:15488
  v_mfma_f32_32x32x16_bf16 v[96:111], v[32:35], v[164:167], v[96:111]
  ds_read_b64_tr_b16 v[32:33], v28 offset:12544
  ds_read_b64_tr_b16 v[34:35], v28 offset:15616
  v_mfma_f32_32x32x16_bf16 v[112:127], v[36:39], v[164:167], v[112:127]
  ds_read_b64_tr_b16 v[36:37], v29 offset:12544
  ds_read_b64_tr_b16 v[38:39], v29 offset:15616
  v_mfma_f32_32x32x16_bf16 v[192:207], v[40:43], v[164:167], v[192:207]
  ds_read_b64_tr_b16 v[40:41], v28 offset:18432
  ds_read_b64_tr_b16 v[42:43], v28 offset:21504
  v_mfma_f32_32x32x16_bf16 v[12:27], v[44:47], v[164:167], v[12:27]
  ds_read_b64_tr_b16 v[44:45], v29 offset:18432
  ds_read_b64_tr_b16 v[46:47], v29 offset:21504
  s_waitcnt lgkmcnt(14)
  v_mfma_f32_32x32x16_bf16 v[64:79], v[48:51], v[168:171], v[64:79]
  ds_read_b64_tr_b16 v[48:49], v28 offset:18560
  ds_read_b64_tr_b16 v[50:51], v28 offset:21632
  s_waitcnt lgkmcnt(14)
  v_mfma_f32_32x32x16_bf16 v[80:95], v[52:55], v[168:171], v[80:95]
  ds_read_b64_tr_b16 v[52:53], v29 offset:18560
  ds_read_b64_tr_b16 v[54:55], v29 offset:21632
  s_waitcnt lgkmcnt(14)
  v_mfma_f32_32x32x16_bf16 v[96:111], v[56:59], v[168:171], v[96:111]
  ds_read_b64_tr_b16 v[56:57], v28 offset:18688
  ds_read_b64_tr_b16 v[58:59], v28 offset:21760
  s_waitcnt lgkmcnt(14)
  v_mfma_f32_32x32x16_bf16 v[112:127], v[60:63], v[168:171], v[112:127]
  ds_read_b64_tr_b16 v[60:61], v29 offset:18688
  ds_read_b64_tr_b16 v[62:63], v29 offset:21760
  s_waitcnt lgkmcnt(14)
  v_mfma_f32_32x32x16_bf16 v[192:207], v[32:35], v[168:171], v[192:207]
  s_waitcnt lgkmcnt(12)
  v_mfma_f32_32x32x16_bf16 v[12:27], v[36:39], v[168:171], v[12:27]
  s_waitcnt lgkmcnt(0)
  s_barrier
  ds_read_b64_tr_b16 v[32:33], v243 offset:40960
  ds_read_b64_tr_b16 v[34:35], v243 offset:44032
  ds_read_b64_tr_b16 v[36:37], v244 offset:40960
  ds_read_b64_tr_b16 v[38:39], v244 offset:44032
  v_mfma_f32_32x32x16_bf16 v[64:79], v[40:43], v[172:175], v[64:79]
  ds_read_b64_tr_b16 v[40:41], v243 offset:41088
  ds_read_b64_tr_b16 v[42:43], v243 offset:44160
  v_mfma_f32_32x32x16_bf16 v[80:95], v[44:47], v[172:175], v[80:95]
  ds_read_b64_tr_b16 v[44:45], v244 offset:41088
  ds_read_b64_tr_b16 v[46:47], v244 offset:44160
  v_mfma_f32_32x32x16_bf16 v[96:111], v[48:51], v[172:175], v[96:111]
  ds_read_b64_tr_b16 v[48:49], v243 offset:41216
  ds_read_b64_tr_b16 v[50:51], v243 offset:44288
  v_mfma_f32_32x32x16_bf16 v[112:127], v[52:55], v[172:175], v[112:127]
  ds_read_b64_tr_b16 v[52:53], v244 offset:41216
  ds_read_b64_tr_b16 v[54:55], v244 offset:44288
  v_mfma_f32_32x32x16_bf16 v[192:207], v[56:59], v[172:175], v[192:207]
  ds_read_b64_tr_b16 v[56:57], v243 offset:47104
  ds_read_b64_tr_b16 v[58:59], v243 offset:50176
  v_mfma_f32_32x32x16_bf16 v[12:27], v[60:63], v[172:175], v[12:27]
  ds_read_b64_tr_b16 v[60:61], v244 offset:47104
  ds_read_b64_tr_b16 v[62:63], v244 offset:50176
  s_waitcnt lgkmcnt(14)
  v_mfma_f32_32x32x16_bf16 v[64:79], v[32:35], v[176:179], v[64:79]
  ds_read_b64_tr_b16 v[32:33], v243 offset:47232
  ds_read_b64_tr_b16 v[34:35], v243 offset:50304
  s_waitcnt lgkmcnt(14)
  v_mfma_f32_32x32x16_bf16 v[80:95], v[36:39], v[176:179], v[80:95]
  ds_read_b64_tr_b16 v[36:37], v244 offset:47232
  ds_read_b64_tr_b16 v[38:39], v244 offset:50304
  s_waitcnt lgkmcnt(14)
  v_mfma_f32_32x32x16_bf16 v[96:111], v[40:43], v[176:179], v[96:111]
  ds_read_b64_tr_b16 v[40:41], v243 offset:47360
  ds_read_b64_tr_b16 v[42:43], v243 offset:50432
  s_waitcnt lgkmcnt(14)
  v_mfma_f32_32x32x16_bf16 v[112:127], v[44:47], v[176:179], v[112:127]
  ds_read_b64_tr_b16 v[44:45], v244 offset:47360
  ds_read_b64_tr_b16 v[46:47], v244 offset:50432
  s_waitcnt lgkmcnt(14)
  v_mfma_f32_32x32x16_bf16 v[192:207], v[48:51], v[176:179], v[192:207]
  s_waitcnt lgkmcnt(12)
  v_mfma_f32_32x32x16_bf16 v[12:27], v[52:55], v[176:179], v[12:27]
  s_waitcnt lgkmcnt(0)
  s_barrier
  ds_read_b64_tr_b16 v[48:49], v243 offset:53248
  ds_read_b64_tr_b16 v[50:51], v243 offset:56320
  ds_read_b64_tr_b16 v[52:53], v244 offset:53248
  ds_read_b64_tr_b16 v[54:55], v244 offset:56320
  v_mfma_f32_32x32x16_bf16 v[64:79], v[56:59], v[180:183], v[64:79]
  ds_read_b64_tr_b16 v[56:57], v243 offset:53376
  ds_read_b64_tr_b16 v[58:59], v243 offset:56448
  v_mfma_f32_32x32x16_bf16 v[80:95], v[60:63], v[180:183], v[80:95]
  ds_read_b64_tr_b16 v[60:61], v244 offset:53376
  ds_read_b64_tr_b16 v[62:63], v244 offset:56448
  v_mfma_f32_32x32x16_bf16 v[96:111], v[32:35], v[180:183], v[96:111]
  ds_read_b64_tr_b16 v[32:33], v243 offset:53504
  ds_read_b64_tr_b16 v[34:35], v243 offset:56576
  v_mfma_f32_32x32x16_bf16 v[112:127], v[36:39], v[180:183], v[112:127]
  ds_read_b64_tr_b16 v[36:37], v244 offset:53504
  ds_read_b64_tr_b16 v[38:39], v244 offset:56576
  v_mfma_f32_32x32x16_bf16 v[192:207], v[40:43], v[180:183], v[192:207]
  ds_read_b64_tr_b16 v[40:41], v243 offset:59392
  ds_read_b64_tr_b16 v[42:43], v243 offset:62464
  v_mfma_f32_32x32x16_bf16 v[12:27], v[44:47], v[180:183], v[12:27]
  ds_read_b64_tr_b16 v[44:45], v244 offset:59392
  ds_read_b64_tr_b16 v[46:47], v244 offset:62464
  s_waitcnt lgkmcnt(14)
  v_mfma_f32_32x32x16_bf16 v[64:79], v[48:51], v[184:187], v[64:79]
  ds_read_b64_tr_b16 v[48:49], v243 offset:59520
  ds_read_b64_tr_b16 v[50:51], v243 offset:62592
  s_waitcnt lgkmcnt(14)
  v_mfma_f32_32x32x16_bf16 v[80:95], v[52:55], v[184:187], v[80:95]
  ds_read_b64_tr_b16 v[52:53], v244 offset:59520
  ds_read_b64_tr_b16 v[54:55], v244 offset:62592
  s_waitcnt lgkmcnt(14)
  v_mfma_f32_32x32x16_bf16 v[96:111], v[56:59], v[184:187], v[96:111]
  ds_read_b64_tr_b16 v[56:57], v243 offset:59648
  ds_read_b64_tr_b16 v[58:59], v243 offset:62720
  s_waitcnt lgkmcnt(14)
  v_mfma_f32_32x32x16_bf16 v[112:127], v[60:63], v[184:187], v[112:127]
  ds_read_b64_tr_b16 v[60:61], v244 offset:59648
  ds_read_b64_tr_b16 v[62:63], v244 offset:62720
  s_waitcnt lgkmcnt(14)
  v_mfma_f32_32x32x16_bf16 v[192:207], v[32:35], v[184:187], v[192:207]
  s_waitcnt lgkmcnt(12)
  v_mfma_f32_32x32x16_bf16 v[12:27], v[36:39], v[184:187], v[12:27]
  s_waitcnt lgkmcnt(0)
  s_barrier
  v_mfma_f32_32x32x16_bf16 v[64:79], v[40:43], v[188:191], v[64:79]
  v_mfma_f32_32x32x16_bf16 v[80:95], v[44:47], v[188:191], v[80:95]
  v_mfma_f32_32x32x16_bf16 v[96:111], v[48:51], v[188:191], v[96:111]
  v_mfma_f32_32x32x16_bf16 v[112:127], v[52:55], v[188:191], v[112:127]
  v_mfma_f32_32x32x16_bf16 v[192:207], v[56:59], v[188:191], v[192:207]
  v_mfma_f32_32x32x16_bf16 v[12:27], v[60:63], v[188:191], v[12:27]
  s_mov_b32 s55, 2
L_idle1:
  s_barrier
  s_sub_u32 s55, s55, 1
  s_cmp_lg_u32 s55, 0
  s_cbranch_scc1 L_idle1
  s_setprio 0
  s_add_u32 m0, s70, 49152
  s_add_u32 s60, s69, 384
  s_add_u32 s60, s60, s3
  buffer_load_dwordx4 v246, s[32:35], s60 offen offset:0 lds
  buffer_load_dwordx4 v247, s[32:35], s60 offen offset:1024 lds
  buffer_load_dwordx4 v248, s[32:35], s60 offen offset:2048 lds
  s_add_u32 m0, s70, 73728
  s_add_u32 s60, s69, 74112
  s_add_u32 s60, s60, s3
  buffer_load_dwordx4 v246, s[32:35], s60 offen offset:0 lds
  buffer_load_dwordx4 v247, s[32:35], s60 offen offset:1024 lds
  buffer_load_dwordx4 v248, s[32:35], s60 offen offset:2048 lds
  s_barrier
  ds_read_b128 v[32:35], v251 offset:24576
  ds_read_b128 v[36:39], v251 offset:25600
  ds_read_b128 v[40:43], v251 offset:26624
  ds_read_b128 v[44:47], v251 offset:27648
  ds_read_b128 v[48:51], v251 offset:28672
  ds_read_b128 v[52:55], v251 offset:29696
  ds_read_b128 v[56:59], v251 offset:30720
  ds_read_b128 v[60:63], v251 offset:31744
  ds_read_b64_tr_b16 v[0:1], v240 offset:0
  ds_read_b64_tr_b16 v[2:3], v240 offset:3072
  ds_read_b64_tr_b16 v[4:5], v241 offset:0
  ds_read_b64_tr_b16 v[6:7], v241 offset:3072
  ds_read_b64_tr_b16 v[8:9], v240 offset:128
  ds_read_b64_tr_b16 v[10:11], v240 offset:3200
  s_waitcnt lgkmcnt(6)
  s_waitcnt lgkmcnt(4)
  v_mfma_f32_32x32x16_bf16 v[64:79], v[0:3], v[32:35], v[64:79]
  ds_read_b64_tr_b16 v[0:1], v241 offset:128
  ds_read_b64_tr_b16 v[2:3], v241 offset:3200
  s_waitcnt lgkmcnt(4)
  v_mfma_f32_32x32x16_bf16 v[80:95], v[4:7], v[32:35], v[80:95]
  ds_read_b64_tr_b16 v[4:5], v240 offset:256
  ds_read_b64_tr_b16 v[6:7], v240 offset:3328
  s_waitcnt lgkmcnt(4)
  v_mfma_f32_32x32x16_bf16 v[96:111], v[8:11], v[32:35], v[96:111]
  ds_read_b64_tr_b16 v[8:9], v241 offset:256
  ds_read_b64_tr_b16 v[10:11], v241 offset:3328
  s_waitcnt lgkmcnt(4)
  v_mfma_f32_32x32x16_bf16 v[112:127], v[0:3], v[32:35], v[112:127]
  ds_read_b64_tr_b16 v[0:1], v240 offset:6144
  ds_read_b64_tr_b16 v[2:3], v240 offset:9216
  s_waitcnt lgkmcnt(4)
  v_mfma_f32_32x32x16_bf16 v[192:207], v[4:7], v[32:35], v[192:207]
  ds_read_b64_tr_b16 v[4:5], v241 offset:6144
  ds_read_b64_tr_b16 v[6:7], v241 offset:9216
  s_waitcnt lgkmcnt(4)
  v_mfma_f32_32x32x16_bf16 v[12:27], v[8:11], v[32:35], v[12:27]
  ds_read_b64_tr_b16 v[8:9], v240 offset:6272
  ds_read_b64_tr_b16 v[10:11], v240 offset:9344
  s_waitcnt lgkmcnt(4)
  v_mfma_f32_32x32x16_bf16 v[64:79], v[0:3], v[36:39], v[64:79]
  ds_read_b64_tr_b16 v[0:1], v241 offset:6272
  ds_read_b64_tr_b16 v[2:3], v241 offset:9344
  s_waitcnt lgkmcnt(4)
  v_mfma_f32_32x32x16_bf16 v[80:95], v[4:7], v[36:39], v[80:95]
  ds_read_b64_tr_b16 v[4:5], v240 offset:6400
  ds_read_b64_tr_b16 v[6:7], v240 offset:9472
  s_waitcnt lgkmcnt(4)
  v_mfma_f32_32x32x16_bf16 v[96:111], v[8:11], v[36:39], v[96:111]
  ds_read_b64_tr_b16 v[8:9], v241 offset:6400
  ds_read_b64_tr_b16 v[10:11], v241 offset:9472
  s_waitcnt lgkmcnt(4)
  v_mfma_f32_32x32x16_bf16 v[112:127], v[0:3], v[36:39], v[112:127]
  ds_read_b64_tr_b16 v[0:1], v240 offset:12288
  ds_read_b64_tr_b16 v[2:3], v240 offset:15360
  s_waitcnt lgkmcnt(4)
  v_mfma_f32_32x32x16_bf16 v[192:207], v[4:7], v[36:39], v[192:207]
  ds_read_b64_tr_b16 v[4:5], v241 offset:12288
  ds_read_b64_tr_b16 v[6:7], v241 offset:15360
  s_waitcnt lgkmcnt(4)
  v_mfma_f32_32x32x16_bf16 v[12:27], v[8:11], v[36:39], v[12:27]
  ds_read_b64_tr_b16 v[8:9], v240 offset:12416
  ds_read_b64_tr_b16 v[10:11], v240 offset:15488
  s_waitcnt lgkmcnt(4)
  v_mfma_f32_32x32x16_bf16 v[64:79], v[0:3], v[40:43], v[64:79]
  ds_read_b64_tr_b16 v[0:1], v241 offset:12416
  ds_read_b64_tr_b16 v[2:3], v241 offset:15488
  s_waitcnt lgkmcnt(4)
  v_mfma_f32_32x32x16_bf16 v[80:95], v[4:7], v[40:43], v[80:95]
  ds_read_b64_tr_b16 v[4:5], v240 offset:12544
  ds_read_b64_tr_b16 v[6:7], v240 offset:15616
  s_waitcnt lgkmcnt(4)
  v_mfma_f32_32x32x16_bf16 v[96:111], v[8:11], v[40:43], v[96:111]
  ds_read_b64_tr_b16 v[8:9], v241 offset:12544
  ds_read_b64_tr_b16 v[10:11], v241 offset:15616
  s_waitcnt lgkmcnt(4)
  v_mfma_f32_32x32x16_bf16 v[112:127], v[0:3], v[40:43], v[112:127]
  ds_read_b64_tr_b16 v[0:1], v240 offset:18432
  ds_read_b64_tr_b16 v[2:3], v240 offset:21504
  s_waitcnt lgkmcnt(4)
  v_mfma_f32_32x32x16_bf16 v[192:207], v[4:7], v[40:43], v[192:207]
  ds_read_b64_tr_b16 v[4:5], v241 offset:18432
  ds_read_b64_tr_b16 v[6:7], v241 offset:21504
  s_waitcnt lgkmcnt(4)
  v_mfma_f32_32x32x16_bf16 v[12:27], v[8:11], v[40:43], v[12:27]
  ds_read_b64_tr_b16 v[8:9], v240 offset:18560
  ds_read_b64_tr_b16 v[10:11], v240 offset:21632
  s_waitcnt lgkmcnt(4)
  v_mfma_f32_32x32x16_bf16 v[64:79], v[0:3], v[44:47], v[64:79]
  ds_read_b64_tr_b16 v[0:1], v241 offset:18560
  ds_read_b64_tr_b16 v[2:3], v241 offset:21632
  s_waitcnt lgkmcnt(4)
  v_mfma_f32_32x32x16_bf16 v[80:95], v[4:7], v[44:47], v[80:95]
  ds_read_b64_tr_b16 v[4:5], v240 offset:18688
  ds_read_b64_tr_b16 v[6:7], v240 offset:21760
  s_waitcnt lgkmcnt(4)
  v_mfma_f32_32x32x16_bf16 v[96:111], v[8:11], v[44:47], v[96:111]
  ds_read_b64_tr_b16 v[8:9], v241 offset:18688
  ds_read_b64_tr_b16 v[10:11], v241 offset:21760
  s_waitcnt lgkmcnt(4)
  v_mfma_f32_32x32x16_bf16 v[112:127], v[0:3], v[44:47], v[112:127]
  ds_read_b64_tr_b16 v[0:1], v240 offset:24576
  ds_read_b64_tr_b16 v[2:3], v240 offset:27648
  s_waitcnt lgkmcnt(4)
  v_mfma_f32_32x32x16_bf16 v[192:207], v[4:7], v[44:47], v[192:207]
  ds_read_b64_tr_b16 v[4:5], v241 offset:24576
  ds_read_b64_tr_b16 v[6:7], v241 offset:27648
  s_waitcnt lgkmcnt(4)
  v_mfma_f32_32x32x16_bf16 v[12:27], v[8:11], v[44:47], v[12:27]
  ds_read_b64_tr_b16 v[8:9], v240 offset:24704
  ds_read_b64_tr_b16 v[10:11], v240 offset:27776
  s_waitcnt vmcnt(3)
  s_barrier
  s_waitcnt lgkmcnt(4)
  v_mfma_f32_32x32x16_bf16 v[64:79], v[0:3], v[48:51], v[64:79]
  ds_read_b64_tr_b16 v[0:1], v241 offset:24704
  ds_read_b64_tr_b16 v[2:3], v241 offset:27776
  s_waitcnt lgkmcnt(4)
  v_mfma_f32_32x32x16_bf16 v[80:95], v[4:7], v[48:51], v[80:95]
  ds_read_b64_tr_b16 v[4:5], v240 offset:24832
  ds_read_b64_tr_b16 v[6:7], v240 offset:27904
  s_add_u32 m0, s70, 0
  s_add_u32 s60, s69, 384
  s_sub_u32 s60, s60, s3
  s_add_u32 s60, s60, 147456
  buffer_load_dwordx4 v246, s[32:35], s60 offen offset:0 lds
  buffer_load_dwordx4 v247, s[32:35], s60 offen offset:1024 lds
  buffer_load_dwordx4 v248, s[32:35], s60 offen offset:2048 lds
  s_waitcnt lgkmcnt(4)
  v_mfma_f32_32x32x16_bf16 v[96:111], v[8:11], v[48:51], v[96:111]
  ds_read_b64_tr_b16 v[8:9], v241 offset:24832
  ds_read_b64_tr_b16 v[10:11], v241 offset:27904
  s_waitcnt lgkmcnt(4)
  v_mfma_f32_32x32x16_bf16 v[112:127], v[0:3], v[48:51], v[112:127]
  ds_read_b64_tr_b16 v[0:1], v240 offset:30720
  ds_read_b64_tr_b16 v[2:3], v240 offset:33792
  s_waitcnt lgkmcnt(4)
  v_mfma_f32_32x32x16_bf16 v[192:207], v[4:7], v[48:51], v[192:207]
  ds_read_b64_tr_b16 v[4:5], v241 offset:30720
  ds_read_b64_tr_b16 v[6:7], v241 offset:33792
  s_waitcnt lgkmcnt(4)
  v_mfma_f32_32x32x16_bf16 v[12:27], v[8:11], v[48:51], v[12:27]
  ds_read_b64_tr_b16 v[8:9], v240 offset:30848
  ds_read_b64_tr_b16 v[10:11], v240 offset:33920
  s_waitcnt lgkmcnt(4)
  v_mfma_f32_32x32x16_bf16 v[64:79], v[0:3], v[52:55], v[64:79]
  ds_read_b64_tr_b16 v[0:1], v241 offset:30848
  ds_read_b64_tr_b16 v[2:3], v241 offset:33920
  s_waitcnt lgkmcnt(4)
  v_mfma_f32_32x32x16_bf16 v[80:95], v[4:7], v[52:55], v[80:95]
  ds_read_b64_tr_b16 v[4:5], v240 offset:30976
  ds_read_b64_tr_b16 v[6:7], v240 offset:34048
  s_waitcnt lgkmcnt(4)
  v_mfma_f32_32x32x16_bf16 v[96:111], v[8:11], v[52:55], v[96:111]
  ds_read_b64_tr_b16 v[8:9], v241 offset:30976
  ds_read_b64_tr_b16 v[10:11], v241 offset:34048
  s_waitcnt lgkmcnt(4)
  v_mfma_f32_32x32x16_bf16 v[112:127], v[0:3], v[52:55], v[112:127]
  ds_read_b64_tr_b16 v[0:1], v240 offset:36864
  ds_read_b64_tr_b16 v[2:3], v240 offset:39936
  s_waitcnt lgkmcnt(4)
  v_mfma_f32_32x32x16_bf16 v[192:207], v[4:7], v[52:55], v[192:207]
  ds_read_b64_tr_b16 v[4:5], v241 offset:36864
  ds_read_b64_tr_b16 v[6:7], v241 offset:39936
  s_waitcnt lgkmcnt(4)
  v_mfma_f32_32x32x16_bf16 v[12:27], v[8:11], v[52:55], v[12:27]
  ds_read_b64_tr_b16 v[8:9], v240 offset:36992
  ds_read_b64_tr_b16 v[10:11], v240 offset:40064
  s_waitcnt lgkmcnt(4)
  v_mfma_f32_32x32x16_bf16 v[64:79], v[0:3], v[56:59], v[64:79]
  ds_read_b64_tr_b16 v[0:1], v241 offset:36992
  ds_read_b64_tr_b16 v[2:3], v241 offset:40064
  s_waitcnt lgkmcnt(4)
  v_mfma_f32_32x32x16_bf16 v[80:95], v[4:7], v[56:59], v[80:95]
  ds_read_b64_tr_b16 v[4:5], v240 offset:37120
  ds_read_b64_tr_b16 v[6:7], v240 offset:40192
  s_waitcnt lgkmcnt(4)
  v_mfma_f32_32x32x16_bf16 v[96:111], v[8:11], v[56:59], v[96:111]
  ds_read_b64_tr_b16 v[8:9], v241 offset:37120
  ds_read_b64_tr_b16 v[10:11], v241 offset:40192
  s_waitcnt lgkmcnt(4)
  v_mfma_f32_32x32x16_bf16 v[112:127], v[0:3], v[56:59], v[112:127]
  ds_read_b64_tr_b16 v[0:1], v240 offset:43008
  ds_read_b64_tr_b16 v[2:3], v240 offset:46080
  s_waitcnt lgkmcnt(4)
  v_mfma_f32_32x32x16_bf16 v[192:207], v[4:7], v[56:59], v[192:207]
  ds_read_b64_tr_b16 v[4:5], v241 offset:43008
  ds_read_b64_tr_b16 v[6:7], v241 offset:46080
  s_waitcnt lgkmcnt(4)
  v_mfma_f32_32x32x16_bf16 v[12:27], v[8:11], v[56:59], v[12:27]
  ds_read_b64_tr_b16 v[8:9], v240 offset:43136
  ds_read_b64_tr_b16 v[10:11], v240 offset:46208
  s_waitcnt lgkmcnt(4)
  v_mfma_f32_32x32x16_bf16 v[64:79], v[0:3], v[60:63], v[64:79]
  ds_read_b64_tr_b16 v[0:1], v241 offset:43136
  ds_read_b64_tr_b16 v[2:3], v241 offset:46208
  s_waitcnt lgkmcnt(4)
  v_mfma_f32_32x32x16_bf16 v[80:95], v[4:7], v[60:63], v[80:95]
  ds_read_b64_tr_b16 v[4:5], v240 offset:43264
  ds_read_b64_tr_b16 v[6:7], v240 offset:46336
  s_waitcnt lgkmcnt(4)
  v_mfma_f32_32x32x16_bf16 v[96:111], v[8:11], v[60:63], v[96:111]
  ds_read_b64_tr_b16 v[8:9], v241 offset:43264
  ds_read_b64_tr_b16 v[10:11], v241 offset:46336
  s_waitcnt lgkmcnt(4)
  v_mfma_f32_32x32x16_bf16 v[112:127], v[0:3], v[60:63], v[112:127]
  s_waitcnt lgkmcnt(2)
  v_mfma_f32_32x32x16_bf16 v[192:207], v[4:7], v[60:63], v[192:207]
  s_waitcnt lgkmcnt(0)
  v_mfma_f32_32x32x16_bf16 v[12:27], v[8:11], v[60:63], v[12:27]
  s_nop 15
  s_nop 3
  v_cvt_pk_bf16_f32 v64, v64, v65
  v_cvt_pk_bf16_f32 v65, v66, v67
  v_cvt_pk_bf16_f32 v66, v68, v69
  v_cvt_pk_bf16_f32 v67, v70, v71
  v_cvt_pk_bf16_f32 v68, v72, v73
  v_cvt_pk_bf16_f32 v69, v74, v75
  v_cvt_pk_bf16_f32 v70, v76, v77
  v_cvt_pk_bf16_f32 v71, v78, v79
  s_add_u32 s60, s71, 0
  buffer_store_dwordx4 v[64:67], v249, s[36:39], s60 offen offset:0 sc1
  buffer_store_dwordx4 v[68:71], v249, s[36:39], s60 offen offset:1024 sc1
  v_cvt_pk_bf16_f32 v80, v80, v81
  v_cvt_pk_bf16_f32 v81, v82, v83
  v_cvt_pk_bf16_f32 v82, v84, v85
  v_cvt_pk_bf16_f32 v83, v86, v87
  v_cvt_pk_bf16_f32 v84, v88, v89
  v_cvt_pk_bf16_f32 v85, v90, v91
  v_cvt_pk_bf16_f32 v86, v92, v93
  v_cvt_pk_bf16_f32 v87, v94, v95
  s_add_u32 s60, s71, 6144
  buffer_store_dwordx4 v[80:83], v249, s[36:39], s60 offen offset:0 sc1
  buffer_store_dwordx4 v[84:87], v249, s[36:39], s60 offen offset:1024 sc1
  v_cvt_pk_bf16_f32 v96, v96, v97
  v_cvt_pk_bf16_f32 v97, v98, v99
  v_cvt_pk_bf16_f32 v98, v100, v101
  v_cvt_pk_bf16_f32 v99, v102, v103
  v_cvt_pk_bf16_f32 v100, v104, v105
  v_cvt_pk_bf16_f32 v101, v106, v107
  v_cvt_pk_bf16_f32 v102, v108, v109
  v_cvt_pk_bf16_f32 v103, v110, v111
  s_add_u32 s60, s71, 12288
  buffer_store_dwordx4 v[96:99], v249, s[36:39], s60 offen offset:0 sc1
  buffer_store_dwordx4 v[100:103], v249, s[36:39], s60 offen offset:1024 sc1
  v_cvt_pk_bf16_f32 v112, v112, v113
  v_cvt_pk_bf16_f32 v113, v114, v115
  v_cvt_pk_bf16_f32 v114, v116, v117
  v_cvt_pk_bf16_f32 v115, v118, v119
  v_cvt_pk_bf16_f32 v116, v120, v121
  v_cvt_pk_bf16_f32 v117, v122, v123
  v_cvt_pk_bf16_f32 v118, v124, v125
  v_cvt_pk_bf16_f32 v119, v126, v127
  s_add_u32 s60, s71, 18432
  buffer_store_dwordx4 v[112:115], v249, s[36:39], s60 offen offset:0 sc1
  buffer_store_dwordx4 v[116:119], v249, s[36:39], s60 offen offset:1024 sc1
  v_cvt_pk_bf16_f32 v192, v192, v193
  v_cvt_pk_bf16_f32 v193, v194, v195
  v_cvt_pk_bf16_f32 v194, v196, v197
  v_cvt_pk_bf16_f32 v195, v198, v199
  v_cvt_pk_bf16_f32 v196, v200, v201
  v_cvt_pk_bf16_f32 v197, v202, v203
  v_cvt_pk_bf16_f32 v198, v204, v205
  v_cvt_pk_bf16_f32 v199, v206, v207
  s_add_u32 s60, s71, 24576
  buffer_store_dwordx4 v[192:195], v249, s[36:39], s60 offen offset:0 sc1
  buffer_store_dwordx4 v[196:199], v249, s[36:39], s60 offen offset:1024 sc1
  v_cvt_pk_bf16_f32 v12, v12, v13
  v_cvt_pk_bf16_f32 v13, v14, v15
  v_cvt_pk_bf16_f32 v14, v16, v17
  v_cvt_pk_bf16_f32 v15, v18, v19
  v_cvt_pk_bf16_f32 v16, v20, v21
  v_cvt_pk_bf16_f32 v17, v22, v23
  v_cvt_pk_bf16_f32 v18, v24, v25
  v_cvt_pk_bf16_f32 v19, v26, v27
  s_add_u32 s60, s71, 30720
  buffer_store_dwordx4 v[12:15], v249, s[36:39], s60 offen offset:0 sc1
  buffer_store_dwordx4 v[16:19], v249, s[36:39], s60 offen offset:1024 sc1
  s_waitcnt vmcnt(15)
  s_branch L_op
L_y_end:
  s_lshl_b32 s60, s58, 13
  s_add_u32 s60, s60, 65536
  v_lshlrev_b32 v6, 4, v30
  v_add_u32 v6, s60, v6
  v_add_u32 v7, 49152, v6
  ds_write_b128 v7, v[32:35] offset:24576
  ds_write_b128 v7, v[36:39] offset:25600
  ds_write_b128 v7, v[40:43] offset:26624
  ds_write_b128 v7, v[44:47] offset:27648
  ds_write_b128 v7, v[48:51] offset:28672
  ds_write_b128 v7, v[52:55] offset:29696
  ds_write_b128 v7, v[56:59] offset:30720
  ds_write_b128 v7, v[60:63] offset:31744
  ds_read_b128 v[160:163], v7 offset:0
  ds_read_b128 v[164:167], v7 offset:1024
  ds_read_b128 v[168:171], v7 offset:2048
  ds_read_b128 v[172:175], v7 offset:3072
  ds_read_b128 v[176:179], v7 offset:4096
  ds_read_b128 v[180:183], v7 offset:5120
  ds_read_b128 v[184:187], v7 offset:6144
  ds_read_b128 v[188:191], v7 offset:7168
  v_lshrrev_b32 v100, 5, v30
  v_and_b32 v101, 31, v30
  v_bfe_u32 v102, v30, 4, 1
  v_bfe_u32 v103, v30, 2, 2
  v_and_b32 v104, 3, v30
  v_add_u32 v105, 0, v30
  v_mul_u32_u24 v106, 2731, v105
  v_lshrrev_b32 v106, 16, v106
  v_mul_u32_u24 v107, 24, v106
  v_sub_u32 v105, v105, v107
  v_bfe_u32 v107, v106, 1, 1
  v_lshlrev_b32 v107, 2, v107
  v_xor_b32 v105, v105, v107
  v_mul_u32_u24 v106, 1152, v106
  v_lshl_add_u32 v105, v105, 4, v106
  v_subrev_u32 v246, 0, v105
  v_add_u32 v105, 64, v30
  v_mul_u32_u24 v106, 2731, v105
  v_lshrrev_b32 v106, 16, v106
  v_mul_u32_u24 v107, 24, v106
  v_sub_u32 v105, v105, v107
  v_bfe_u32 v107, v106, 1, 1
  v_lshlrev_b32 v107, 2, v107
  v_xor_b32 v105, v105, v107
  v_mul_u32_u24 v106, 1152, v106
  v_lshl_add_u32 v105, v105, 4, v106
  v_subrev_u32 v247, 1024, v105
  v_add_u32 v105, 128, v30
  v_mul_u32_u24 v106, 2731, v105
  v_lshrrev_b32 v106, 16, v106
  v_mul_u32_u24 v107, 24, v106
  v_sub_u32 v105, v105, v107
  v_bfe_u32 v107, v106, 1, 1
  v_lshlrev_b32 v107, 2, v107
  v_xor_b32 v105, v105, v107
  v_mul_u32_u24 v106, 1152, v106
  v_lshl_add_u32 v105, v105, 4, v106
  v_subrev_u32 v248, 2048, v105
  s_mul_i32 s70, s51, 3072
  s_lshl_b32 s60, s8, 8
  s_lshl_b32 s61, s51, 3
  s_add_u32 s60, s60, s61
  s_mul_i32 s69, s60, 1152
  s_lshl_b32 s59, s57, 1
  s_mul_i32 s63, s57, 3
  s_cmp_eq_u32 s58, 2
  s_cselect_b32 s59, s63, s59
  v_lshl_add_u32 v105, v100, 2, v103
  v_mul_u32_u24 v105, 384, v105
  v_lshl_add_u32 v105, v102, 5, v105
  v_lshl_add_u32 v105, v104, 3, v105
  v_lshrrev_b32 v106, 1, v103
  s_add_u32 s63, s59, 0
  v_xor_b32 v107, s63, v106
  v_lshl_add_u32 v240, v107, 6, v105
  v_add_u32 v243, 49152, v240
  s_add_u32 s63, s59, 1
  v_xor_b32 v107, s63, v106
  v_lshl_add_u32 v241, v107, 6, v105
  v_add_u32 v244, 49152, v241
  s_add_u32 s63, s59, 2
  v_xor_b32 v107, s63, v106
  v_lshl_add_u32 v242, v107, 6, v105
  v_add_u32 v245, 49152, v242
  s_lshl_b32 s72, s48, 4
  s_add_u32 s72, s72, s49
  s_lshl_b32 s60, s72, 3
  v_mov_b32 v255, s60
  s_lshl_b32 s61, s72, 8
  s_add_u32 s61, s61, 0x2000000
  v_and_b32 v107, 7, v30
  v_lshlrev_b32 v107, 2, v107
  v_add_u32 v254, s61, v107
  s_add_u32 s60, s60, s50
  s_mul_i32 s75, s60, 49152
  s_lshl_b32 s61, s58, 13
  s_add_u32 s75, s75, s61
  s_add_u32 s75, s75, 0x2100000
  s_mul_i32 s71, s60, 110592
  s_mul_i32 s60, s59, 3
  s_add_u32 s60, s60, s58
  s_lshl_b32 s60, s60, 11
  s_add_u32 s71, s71, s60
  v_lshlrev_b32 v249, 4, v30
  s_lshl_b32 s60, s58, 13
  s_add_u32 s60, s60, 65536
  v_add_u32 v250, s60, v249
  v_add_u32 v251, 49152, v250
  s_waitcnt lgkmcnt(0)
  s_branch L_nonx
L_slow_t2:
  v_max3_f32 v0, v144, v145, v146
  v_max3_f32 v1, v147, v148, v149
  v_max3_f32 v8, v150, v151, v152
  v_max3_f32 v9, v153, v154, v155
  v_max3_f32 v31, v156, v157, v158
  v_max3_f32 v0, v0, v1, v159
  v_max3_f32 v8, v8, v9, v31
  v_max_f32 v0, v0, v8
  v_mov_b32 v1, v0
  s_nop 1
  v_permlane32_swap_b32 v0, v1
  v_max_f32 v0, v0, v1
  v_add_f32 v3, s53, v0
  v_max_f32 v3, 0, v3
  v_sub_f32 v2, 0, v3
  v_exp_f32 v2, v2
  v_sub_f32 v144, v144, v3
  v_sub_f32 v145, v145, v3
  v_sub_f32 v146, v146, v3
  v_sub_f32 v147, v147, v3
  v_sub_f32 v148, v148, v3
  v_sub_f32 v149, v149, v3
  v_sub_f32 v150, v150, v3
  v_sub_f32 v151, v151, v3
  v_sub_f32 v152, v152, v3
  v_sub_f32 v153, v153, v3
  v_sub_f32 v154, v154, v3
  v_sub_f32 v155, v155, v3
  v_sub_f32 v156, v156, v3
  v_sub_f32 v157, v157, v3
  v_sub_f32 v158, v158, v3
  v_sub_f32 v159, v159, v3
  v_exp_f32 v0, v144
  v_exp_f32 v1, v145
  v_exp_f32 v8, v146
  v_exp_f32 v9, v147
  v_cvt_pk_bf16_f32 v168, v0, v1
  v_add_f32 v5, v0, v1
  v_exp_f32 v0, v148
  v_exp_f32 v1, v149
  v_cvt_pk_bf16_f32 v169, v8, v9
  v_add_f32 v5, v5, v8
  v_add_f32 v5, v5, v9
  v_exp_f32 v8, v150
  v_exp_f32 v9, v151
  v_cvt_pk_bf16_f32 v170, v0, v1
  v_add_f32 v5, v5, v0
  v_add_f32 v5, v5, v1
  v_exp_f32 v0, v152
  v_exp_f32 v1, v153
  v_cvt_pk_bf16_f32 v171, v8, v9
  v_add_f32 v5, v5, v8
  v_add_f32 v5, v5, v9
  v_exp_f32 v8, v154
  v_exp_f32 v9, v155
  v_cvt_pk_bf16_f32 v172, v0, v1
  v_add_f32 v5, v5, v0
  v_add_f32 v5, v5, v1
  v_exp_f32 v0, v156
  v_exp_f32 v1, v157
  v_cvt_pk_bf16_f32 v173, v8, v9
  v_add_f32 v5, v5, v8
  v_add_f32 v5, v5, v9
  v_exp_f32 v8, v158
  v_exp_f32 v9, v159
  v_cvt_pk_bf16_f32 v174, v0, v1
  v_add_f32 v5, v5, v0
  v_add_f32 v5, v5, v1
  s_nop 0
  v_cvt_pk_bf16_f32 v175, v8, v9
  v_add_f32 v5, v5, v8
  v_add_f32 v5, v5, v9
  v_sub_f32 v240, v240, v3
  v_sub_f32 v241, v241, v3
  v_sub_f32 v242, v242, v3
  v_sub_f32 v243, v243, v3
  v_sub_f32 v244, v244, v3
  v_sub_f32 v245, v245, v3
  v_sub_f32 v246, v246, v3
  v_sub_f32 v247, v247, v3
  v_sub_f32 v248, v248, v3
  v_sub_f32 v249, v249, v3
  v_sub_f32 v250, v250, v3
  v_sub_f32 v251, v251, v3
  v_sub_f32 v252, v252, v3
  v_sub_f32 v253, v253, v3
  v_sub_f32 v254, v254, v3
  v_sub_f32 v255, v255, v3
  v_mul_f32 v4, v4, v2
  s_mov_b32 s54, 1
  s_branch L_slowret_t2
L_resc_l3:
  s_nop 15
  s_nop 7
  v_sub_f32 v128, v128, v3
  v_sub_f32 v129, v129, v3
  v_sub_f32 v130, v130, v3
  v_sub_f32 v131, v131, v3
  v_sub_f32 v132, v132, v3
  v_sub_f32 v133, v133, v3
  v_sub_f32 v134, v134, v3
  v_sub_f32 v135, v135, v3
  v_sub_f32 v136, v136, v3
  v_sub_f32 v137, v137, v3
  v_sub_f32 v138, v138, v3
  v_sub_f32 v139, v139, v3
  v_sub_f32 v140, v140, v3
  v_sub_f32 v141, v141, v3
  v_sub_f32 v142, v142, v3
  v_sub_f32 v143, v143, v3
  v_mul_f32 v64, v64, v2
  v_mul_f32 v65, v65, v2
  v_mul_f32 v66, v66, v2
  v_mul_f32 v67, v67, v2
  v_mul_f32 v68, v68, v2
  v_mul_f32 v69, v69, v2
  v_mul_f32 v70, v70, v2
  v_mul_f32 v71, v71, v2
  v_mul_f32 v72, v72, v2
  v_mul_f32 v73, v73, v2
  v_mul_f32 v74, v74, v2
  v_mul_f32 v75, v75, v2
  v_mul_f32 v76, v76, v2
  v_mul_f32 v77, v77, v2
  v_mul_f32 v78, v78, v2
  v_mul_f32 v79, v79, v2
  v_mul_f32 v80, v80, v2
  v_mul_f32 v81, v81, v2
  v_mul_f32 v82, v82, v2
  v_mul_f32 v83, v83, v2
  v_mul_f32 v84, v84, v2
  v_mul_f32 v85, v85, v2
  v_mul_f32 v86, v86, v2
  v_mul_f32 v87, v87, v2
  v_mul_f32 v88, v88, v2
  v_mul_f32 v89, v89, v2
  v_mul_f32 v90, v90, v2
  v_mul_f32 v91, v91, v2
  v_mul_f32 v92, v92, v2
  v_mul_f32 v93, v93, v2
  v_mul_f32 v94, v94, v2
  v_mul_f32 v95, v95, v2
  v_mul_f32 v96, v96, v2
  v_mul_f32 v97, v97, v2
  v_mul_f32 v98, v98, v2
  v_mul_f32 v99, v99, v2
  v_mul_f32 v100, v100, v2
  v_mul_f32 v101, v101, v2
  v_mul_f32 v102, v102, v2
  v_mul_f32 v103, v103, v2
  v_mul_f32 v104, v104, v2
  v_mul_f32 v105, v105, v2
  v_mul_f32 v106, v106, v2
  v_mul_f32 v107, v107, v2
  v_mul_f32 v108, v108, v2
  v_mul_f32 v109, v109, v2
  v_mul_f32 v110, v110, v2
  v_mul_f32 v111, v111, v2
  v_mul_f32 v112, v112, v2
  v_mul_f32 v113, v113, v2
  v_mul_f32 v114, v114, v2
  v_mul_f32 v115, v115, v2
  v_mul_f32 v116, v116, v2
  v_mul_f32 v117, v117, v2
  v_mul_f32 v118, v118, v2
  v_mul_f32 v119, v119, v2
  v_mul_f32 v120, v120, v2
  v_mul_f32 v121, v121, v2
  v_mul_f32 v122, v122, v2
  v_mul_f32 v123, v123, v2
  v_mul_f32 v124, v124, v2
  v_mul_f32 v125, v125, v2
  v_mul_f32 v126, v126, v2
  v_mul_f32 v127, v127, v2
  s_mov_b32 s54, 0
  s_nop 1
  s_branch L_rescret_l3
L_slow_l3:
  v_max3_f32 v0, v128, v129, v130
  v_max3_f32 v1, v131, v132, v133
  v_max3_f32 v8, v134, v135, v136
  v_max3_f32 v9, v137, v138, v139
  v_max3_f32 v31, v140, v141, v142
  v_max3_f32 v0, v0, v1, v143
  v_max3_f32 v8, v8, v9, v31
  v_max_f32 v0, v0, v8
  v_mov_b32 v1, v0
  s_nop 1
  v_permlane32_swap_b32 v0, v1
  v_max_f32 v0, v0, v1
  v_add_f32 v3, s53, v0
  v_max_f32 v3, 0, v3
  v_sub_f32 v2, 0, v3
  v_exp_f32 v2, v2
  v_sub_f32 v128, v128, v3
  v_sub_f32 v129, v129, v3
  v_sub_f32 v130, v130, v3
  v_sub_f32 v131, v131, v3
  v_sub_f32 v132, v132, v3
  v_sub_f32 v133, v133, v3
  v_sub_f32 v134, v134, v3
  v_sub_f32 v135, v135, v3
  v_sub_f32 v136, v136, v3
  v_sub_f32 v137, v137, v3
  v_sub_f32 v138, v138, v3
  v_sub_f32 v139, v139, v3
  v_sub_f32 v140, v140, v3
  v_sub_f32 v141, v141, v3
  v_sub_f32 v142, v142, v3
  v_sub_f32 v143, v143, v3
  v_exp_f32 v0, v128
  v_exp_f32 v1, v129
  v_exp_f32 v8, v130
  v_exp_f32 v9, v131
  v_cvt_pk_bf16_f32 v160, v0, v1
  v_add_f32 v5, v0, v1
  v_exp_f32 v0, v132
  v_exp_f32 v1, v133
  v_cvt_pk_bf16_f32 v161, v8, v9
  v_add_f32 v5, v5, v8
  v_add_f32 v5, v5, v9
  v_exp_f32 v8, v134
  v_exp_f32 v9, v135
  v_cvt_pk_bf16_f32 v162, v0, v1
  v_add_f32 v5, v5, v0
  v_add_f32 v5, v5, v1
  v_exp_f32 v0, v136
  v_exp_f32 v1, v137
  v_cvt_pk_bf16_f32 v163, v8, v9
  v_add_f32 v5, v5, v8
  v_add_f32 v5, v5, v9
  v_exp_f32 v8, v138
  v_exp_f32 v9, v139
  v_cvt_pk_bf16_f32 v164, v0, v1
  v_add_f32 v5, v5, v0
  v_add_f32 v5, v5, v1
  v_exp_f32 v0, v140
  v_exp_f32 v1, v141
  v_cvt_pk_bf16_f32 v165, v8, v9
  v_add_f32 v5, v5, v8
  v_add_f32 v5, v5, v9
  v_exp_f32 v8, v142
  v_exp_f32 v9, v143
  v_cvt_pk_bf16_f32 v166, v0, v1
  v_add_f32 v5, v5, v0
  v_add_f32 v5, v5, v1
  s_nop 0
  v_cvt_pk_bf16_f32 v167, v8, v9
  v_add_f32 v5, v5, v8
  v_add_f32 v5, v5, v9
  v_sub_f32 v240, v240, v3
  v_sub_f32 v241, v241, v3
  v_sub_f32 v242, v242, v3
  v_sub_f32 v243, v243, v3
  v_sub_f32 v244, v244, v3
  v_sub_f32 v245, v245, v3
  v_sub_f32 v246, v246, v3
  v_sub_f32 v247, v247, v3
  v_sub_f32 v248, v248, v3
  v_sub_f32 v249, v249, v3
  v_sub_f32 v250, v250, v3
  v_sub_f32 v251, v251, v3
  v_sub_f32 v252, v252, v3
  v_sub_f32 v253, v253, v3
  v_sub_f32 v254, v254, v3
  v_sub_f32 v255, v255, v3
  v_mul_f32 v4, v4, v2
  s_mov_b32 s54, 1
  s_branch L_slowret_l3
L_resc_l0:
  s_nop 15
  s_nop 7
  v_sub_f32 v144, v144, v3
  v_sub_f32 v145, v145, v3
  v_sub_f32 v146, v146, v3
  v_sub_f32 v147, v147, v3
  v_sub_f32 v148, v148, v3
  v_sub_f32 v149, v149, v3
  v_sub_f32 v150, v150, v3
  v_sub_f32 v151, v151, v3
  v_sub_f32 v152, v152, v3
  v_sub_f32 v153, v153, v3
  v_sub_f32 v154, v154, v3
  v_sub_f32 v155, v155, v3
  v_sub_f32 v156, v156, v3
  v_sub_f32 v157, v157, v3
  v_sub_f32 v158, v158, v3
  v_sub_f32 v159, v159, v3
  v_mul_f32 v64, v64, v2
  v_mul_f32 v65, v65, v2
  v_mul_f32 v66, v66, v2
  v_mul_f32 v67, v67, v2
  v_mul_f32 v68, v68, v2
  v_mul_f32 v69, v69, v2
  v_mul_f32 v70, v70, v2
  v_mul_f32 v71, v71, v2
  v_mul_f32 v72, v72, v2
  v_mul_f32 v73, v73, v2
  v_mul_f32 v74, v74, v2
  v_mul_f32 v75, v75, v2
  v_mul_f32 v76, v76, v2
  v_mul_f32 v77, v77, v2
  v_mul_f32 v78, v78, v2
  v_mul_f32 v79, v79, v2
  v_mul_f32 v80, v80, v2
  v_mul_f32 v81, v81, v2
  v_mul_f32 v82, v82, v2
  v_mul_f32 v83, v83, v2
  v_mul_f32 v84, v84, v2
  v_mul_f32 v85, v85, v2
  v_mul_f32 v86, v86, v2
  v_mul_f32 v87, v87, v2
  v_mul_f32 v88, v88, v2
  v_mul_f32 v89, v89, v2
  v_mul_f32 v90, v90, v2
  v_mul_f32 v91, v91, v2
  v_mul_f32 v92, v92, v2
  v_mul_f32 v93, v93, v2
  v_mul_f32 v94, v94, v2
  v_mul_f32 v95, v95, v2
  v_mul_f32 v96, v96, v2
  v_mul_f32 v97, v97, v2
  v_mul_f32 v98, v98, v2
  v_mul_f32 v99, v99, v2
  v_mul_f32 v100, v100, v2
  v_mul_f32 v101, v101, v2
  v_mul_f32 v102, v102, v2
  v_mul_f32 v103, v103, v2
  v_mul_f32 v104, v104, v2
  v_mul_f32 v105, v105, v2
  v_mul_f32 v106, v106, v2
  v_mul_f32 v107, v107, v2
  v_mul_f32 v108, v108, v2
  v_mul_f32 v109, v109, v2
  v_mul_f32 v110, v110, v2
  v_mul_f32 v111, v111, v2
  v_mul_f32 v112, v112, v2
  v_mul_f32 v113, v113, v2
  v_mul_f32 v114, v114, v2
  v_mul_f32 v115, v115, v2
  v_mul_f32 v116, v116, v2
  v_mul_f32 v117, v117, v2
  v_mul_f32 v118, v118, v2
  v_mul_f32 v119, v119, v2
  v_mul_f32 v120, v120, v2
  v_mul_f32 v121, v121, v2
  v_mul_f32 v122, v122, v2
  v_mul_f32 v123, v123, v2
  v_mul_f32 v124, v124, v2
  v_mul_f32 v125, v125, v2
  v_mul_f32 v126, v126, v2
  v_mul_f32 v127, v127, v2
  s_mov_b32 s54, 0
  s_nop 1
  s_branch L_rescret_l0
L_slow_l0:
  v_max3_f32 v0, v144, v145, v146
  v_max3_f32 v1, v147, v148, v149
  v_max3_f32 v8, v150, v151, v152
  v_max3_f32 v9, v153, v154, v155
  v_max3_f32 v31, v156, v157, v158
  v_max3_f32 v0, v0, v1, v159
  v_max3_f32 v8, v8, v9, v31
  v_max_f32 v0, v0, v8
  v_mov_b32 v1, v0
  s_nop 1
  v_permlane32_swap_b32 v0, v1
  v_max_f32 v0, v0, v1
  v_add_f32 v3, s53, v0
  v_max_f32 v3, 0, v3
  v_sub_f32 v2, 0, v3
  v_exp_f32 v2, v2
  v_sub_f32 v144, v144, v3
  v_sub_f32 v145, v145, v3
  v_sub_f32 v146, v146, v3
  v_sub_f32 v147, v147, v3
  v_sub_f32 v148, v148, v3
  v_sub_f32 v149, v149, v3
  v_sub_f32 v150, v150, v3
  v_sub_f32 v151, v151, v3
  v_sub_f32 v152, v152, v3
  v_sub_f32 v153, v153, v3
  v_sub_f32 v154, v154, v3
  v_sub_f32 v155, v155, v3
  v_sub_f32 v156, v156, v3
  v_sub_f32 v157, v157, v3
  v_sub_f32 v158, v158, v3
  v_sub_f32 v159, v159, v3
  v_exp_f32 v0, v144
  v_exp_f32 v1, v145
  v_exp_f32 v8, v146
  v_exp_f32 v9, v147
  v_cvt_pk_bf16_f32 v168, v0, v1
  v_add_f32 v5, v0, v1
  v_exp_f32 v0, v148
  v_exp_f32 v1, v149
  v_cvt_pk_bf16_f32 v169, v8, v9
  v_add_f32 v5, v5, v8
  v_add_f32 v5, v5, v9
  v_exp_f32 v8, v150
  v_exp_f32 v9, v151
  v_cvt_pk_bf16_f32 v170, v0, v1
  v_add_f32 v5, v5, v0
  v_add_f32 v5, v5, v1
  v_exp_f32 v0, v152
  v_exp_f32 v1, v153
  v_cvt_pk_bf16_f32 v171, v8, v9
  v_add_f32 v5, v5, v8
  v_add_f32 v5, v5, v9
  v_exp_f32 v8, v154
  v_exp_f32 v9, v155
  v_cvt_pk_bf16_f32 v172, v0, v1
  v_add_f32 v5, v5, v0
  v_add_f32 v5, v5, v1
  v_exp_f32 v0, v156
  v_exp_f32 v1, v157
  v_cvt_pk_bf16_f32 v173, v8, v9
  v_add_f32 v5, v5, v8
  v_add_f32 v5, v5, v9
  v_exp_f32 v8, v158
  v_exp_f32 v9, v159
  v_cvt_pk_bf16_f32 v174, v0, v1
  v_add_f32 v5, v5, v0
  v_add_f32 v5, v5, v1
  s_nop 0
  v_cvt_pk_bf16_f32 v175, v8, v9
  v_add_f32 v5, v5, v8
  v_add_f32 v5, v5, v9
  v_sub_f32 v240, v240, v3
  v_sub_f32 v241, v241, v3
  v_sub_f32 v242, v242, v3
  v_sub_f32 v243, v243, v3
  v_sub_f32 v244, v244, v3
  v_sub_f32 v245, v245, v3
  v_sub_f32 v246, v246, v3
  v_sub_f32 v247, v247, v3
  v_sub_f32 v248, v248, v3
  v_sub_f32 v249, v249, v3
  v_sub_f32 v250, v250, v3
  v_sub_f32 v251, v251, v3
  v_sub_f32 v252, v252, v3
  v_sub_f32 v253, v253, v3
  v_sub_f32 v254, v254, v3
  v_sub_f32 v255, v255, v3
  v_mul_f32 v4, v4, v2
  s_mov_b32 s54, 1
  s_branch L_slowret_l0
L_resc_l1:
  s_nop 15
  s_nop 7
  v_sub_f32 v128, v128, v3
  v_sub_f32 v129, v129, v3
  v_sub_f32 v130, v130, v3
  v_sub_f32 v131, v131, v3
  v_sub_f32 v132, v132, v3
  v_sub_f32 v133, v133, v3
  v_sub_f32 v134, v134, v3
  v_sub_f32 v135, v135, v3
  v_sub_f32 v136, v136, v3
  v_sub_f32 v137, v137, v3
  v_sub_f32 v138, v138, v3
  v_sub_f32 v139, v139, v3
  v_sub_f32 v140, v140, v3
  v_sub_f32 v141, v141, v3
  v_sub_f32 v142, v142, v3
  v_sub_f32 v143, v143, v3
  v_mul_f32 v64, v64, v2
  v_mul_f32 v65, v65, v2
  v_mul_f32 v66, v66, v2
  v_mul_f32 v67, v67, v2
  v_mul_f32 v68, v68, v2
  v_mul_f32 v69, v69, v2
  v_mul_f32 v70, v70, v2
  v_mul_f32 v71, v71, v2
  v_mul_f32 v72, v72, v2
  v_mul_f32 v73, v73, v2
  v_mul_f32 v74, v74, v2
  v_mul_f32 v75, v75, v2
  v_mul_f32 v76, v76, v2
  v_mul_f32 v77, v77, v2
  v_mul_f32 v78, v78, v2
  v_mul_f32 v79, v79, v2
  v_mul_f32 v80, v80, v2
  v_mul_f32 v81, v81, v2
  v_mul_f32 v82, v82, v2
  v_mul_f32 v83, v83, v2
  v_mul_f32 v84, v84, v2
  v_mul_f32 v85, v85, v2
  v_mul_f32 v86, v86, v2
  v_mul_f32 v87, v87, v2
  v_mul_f32 v88, v88, v2
  v_mul_f32 v89, v89, v2
  v_mul_f32 v90, v90, v2
  v_mul_f32 v91, v91, v2
  v_mul_f32 v92, v92, v2
  v_mul_f32 v93, v93, v2
  v_mul_f32 v94, v94, v2
  v_mul_f32 v95, v95, v2
  v_mul_f32 v96, v96, v2
  v_mul_f32 v97, v97, v2
  v_mul_f32 v98, v98, v2
  v_mul_f32 v99, v99, v2
  v_mul_f32 v100, v100, v2
  v_mul_f32 v101, v101, v2
  v_mul_f32 v102, v102, v2
  v_mul_f32 v103, v103, v2
  v_mul_f32 v104, v104, v2
  v_mul_f32 v105, v105, v2
  v_mul_f32 v106, v106, v2
  v_mul_f32 v107, v107, v2
  v_mul_f32 v108, v108, v2
  v_mul_f32 v109, v109, v2
  v_mul_f32 v110, v110, v2
  v_mul_f32 v111, v111, v2
  v_mul_f32 v112, v112, v2
  v_mul_f32 v113, v113, v2
  v_mul_f32 v114, v114, v2
  v_mul_f32 v115, v115, v2
  v_mul_f32 v116, v116, v2
  v_mul_f32 v117, v117, v2
  v_mul_f32 v118, v118, v2
  v_mul_f32 v119, v119, v2
  v_mul_f32 v120, v120, v2
  v_mul_f32 v121, v121, v2
  v_mul_f32 v122, v122, v2
  v_mul_f32 v123, v123, v2
  v_mul_f32 v124, v124, v2
  v_mul_f32 v125, v125, v2
  v_mul_f32 v126, v126, v2
  v_mul_f32 v127, v127, v2
  s_mov_b32 s54, 0
  s_nop 1
  s_branch L_rescret_l1
L_slow_l1:
  v_max3_f32 v0, v128, v129, v130
  v_max3_f32 v1, v131, v132, v133
  v_max3_f32 v8, v134, v135, v136
  v_max3_f32 v9, v137, v138, v139
  v_max3_f32 v31, v140, v141, v142
  v_max3_f32 v0, v0, v1, v143
  v_max3_f32 v8, v8, v9, v31
  v_max_f32 v0, v0, v8
  v_mov_b32 v1, v0
  s_nop 1
  v_permlane32_swap_b32 v0, v1
  v_max_f32 v0, v0, v1
  v_add_f32 v3, s53, v0
  v_max_f32 v3, 0, v3
  v_sub_f32 v2, 0, v3
  v_exp_f32 v2, v2
  v_sub_f32 v128, v128, v3
  v_sub_f32 v129, v129, v3
  v_sub_f32 v130, v130, v3
  v_sub_f32 v131, v131, v3
  v_sub_f32 v132, v132, v3
  v_sub_f32 v133, v133, v3
  v_sub_f32 v134, v134, v3
  v_sub_f32 v135, v135, v3
  v_sub_f32 v136, v136, v3
  v_sub_f32 v137, v137, v3
  v_sub_f32 v138, v138, v3
  v_sub_f32 v139, v139, v3
  v_sub_f32 v140, v140, v3
  v_sub_f32 v141, v141, v3
  v_sub_f32 v142, v142, v3
  v_sub_f32 v143, v143, v3
  v_exp_f32 v0, v128
  v_exp_f32 v1, v129
  v_exp_f32 v8, v130
  v_exp_f32 v9, v131
  v_cvt_pk_bf16_f32 v160, v0, v1
  v_add_f32 v5, v0, v1
  v_exp_f32 v0, v132
  v_exp_f32 v1, v133
  v_cvt_pk_bf16_f32 v161, v8, v9
  v_add_f32 v5, v5, v8
  v_add_f32 v5, v5, v9
  v_exp_f32 v8, v134
  v_exp_f32 v9, v135
  v_cvt_pk_bf16_f32 v162, v0, v1
  v_add_f32 v5, v5, v0
  v_add_f32 v5, v5, v1
  v_exp_f32 v0, v136
  v_exp_f32 v1, v137
  v_cvt_pk_bf16_f32 v163, v8, v9
  v_add_f32 v5, v5, v8
  v_add_f32 v5, v5, v9
  v_exp_f32 v8, v138
  v_exp_f32 v9, v139
  v_cvt_pk_bf16_f32 v164, v0, v1
  v_add_f32 v5, v5, v0
  v_add_f32 v5, v5, v1
  v_exp_f32 v0, v140
  v_exp_f32 v1, v141
  v_cvt_pk_bf16_f32 v165, v8, v9
  v_add_f32 v5, v5, v8
  v_add_f32 v5, v5, v9
  v_exp_f32 v8, v142
  v_exp_f32 v9, v143
  v_cvt_pk_bf16_f32 v166, v0, v1
  v_add_f32 v5, v5, v0
  v_add_f32 v5, v5, v1
  s_nop 0
  v_cvt_pk_bf16_f32 v167, v8, v9
  v_add_f32 v5, v5, v8
  v_add_f32 v5, v5, v9
  v_sub_f32 v240, v240, v3
  v_sub_f32 v241, v241, v3
  v_sub_f32 v242, v242, v3
  v_sub_f32 v243, v243, v3
  v_sub_f32 v244, v244, v3
  v_sub_f32 v245, v245, v3
  v_sub_f32 v246, v246, v3
  v_sub_f32 v247, v247, v3
  v_sub_f32 v248, v248, v3
  v_sub_f32 v249, v249, v3
  v_sub_f32 v250, v250, v3
  v_sub_f32 v251, v251, v3
  v_sub_f32 v252, v252, v3
  v_sub_f32 v253, v253, v3
  v_sub_f32 v254, v254, v3
  v_sub_f32 v255, v255, v3
  v_mul_f32 v4, v4, v2
  s_mov_b32 s54, 1
  s_branch L_slowret_l1
L_resc_l2:
  s_nop 15
  s_nop 7
  v_sub_f32 v144, v144, v3
  v_sub_f32 v145, v145, v3
  v_sub_f32 v146, v146, v3
  v_sub_f32 v147, v147, v3
  v_sub_f32 v148, v148, v3
  v_sub_f32 v149, v149, v3
  v_sub_f32 v150, v150, v3
  v_sub_f32 v151, v151, v3
  v_sub_f32 v152, v152, v3
  v_sub_f32 v153, v153, v3
  v_sub_f32 v154, v154, v3
  v_sub_f32 v155, v155, v3
  v_sub_f32 v156, v156, v3
  v_sub_f32 v157, v157, v3
  v_sub_f32 v158, v158, v3
  v_sub_f32 v159, v159, v3
  v_mul_f32 v64, v64, v2
  v_mul_f32 v65, v65, v2
  v_mul_f32 v66, v66, v2
  v_mul_f32 v67, v67, v2
  v_mul_f32 v68, v68, v2
  v_mul_f32 v69, v69, v2
  v_mul_f32 v70, v70, v2
  v_mul_f32 v71, v71, v2
  v_mul_f32 v72, v72, v2
  v_mul_f32 v73, v73, v2
  v_mul_f32 v74, v74, v2
  v_mul_f32 v75, v75, v2
  v_mul_f32 v76, v76, v2
  v_mul_f32 v77, v77, v2
  v_mul_f32 v78, v78, v2
  v_mul_f32 v79, v79, v2
  v_mul_f32 v80, v80, v2
  v_mul_f32 v81, v81, v2
  v_mul_f32 v82, v82, v2
  v_mul_f32 v83, v83, v2
  v_mul_f32 v84, v84, v2
  v_mul_f32 v85, v85, v2
  v_mul_f32 v86, v86, v2
  v_mul_f32 v87, v87, v2
  v_mul_f32 v88, v88, v2
  v_mul_f32 v89, v89, v2
  v_mul_f32 v90, v90, v2
  v_mul_f32 v91, v91, v2
  v_mul_f32 v92, v92, v2
  v_mul_f32 v93, v93, v2
  v_mul_f32 v94, v94, v2
  v_mul_f32 v95, v95, v2
  v_mul_f32 v96, v96, v2
  v_mul_f32 v97, v97, v2
  v_mul_f32 v98, v98, v2
  v_mul_f32 v99, v99, v2
  v_mul_f32 v100, v100, v2
  v_mul_f32 v101, v101, v2
  v_mul_f32 v102, v102, v2
  v_mul_f32 v103, v103, v2
  v_mul_f32 v104, v104, v2
  v_mul_f32 v105, v105, v2
  v_mul_f32 v106, v106, v2
  v_mul_f32 v107, v107, v2
  v_mul_f32 v108, v108, v2
  v_mul_f32 v109, v109, v2
  v_mul_f32 v110, v110, v2
  v_mul_f32 v111, v111, v2
  v_mul_f32 v112, v112, v2
  v_mul_f32 v113, v113, v2
  v_mul_f32 v114, v114, v2
  v_mul_f32 v115, v115, v2
  v_mul_f32 v116, v116, v2
  v_mul_f32 v117, v117, v2
  v_mul_f32 v118, v118, v2
  v_mul_f32 v119, v119, v2
  v_mul_f32 v120, v120, v2
  v_mul_f32 v121, v121, v2
  v_mul_f32 v122, v122, v2
  v_mul_f32 v123, v123, v2
  v_mul_f32 v124, v124, v2
  v_mul_f32 v125, v125, v2
  v_mul_f32 v126, v126, v2
  v_mul_f32 v127, v127, v2
  s_mov_b32 s54, 0
  s_nop 1
  s_branch L_rescret_l2
L_slow_l2:
  v_max3_f32 v0, v144, v145, v146
  v_max3_f32 v1, v147, v148, v149
  v_max3_f32 v8, v150, v151, v152
  v_max3_f32 v9, v153, v154, v155
  v_max3_f32 v31, v156, v157, v158
  v_max3_f32 v0, v0, v1, v159
  v_max3_f32 v8, v8, v9, v31
  v_max_f32 v0, v0, v8
  v_mov_b32 v1, v0
  s_nop 1
  v_permlane32_swap_b32 v0, v1
  v_max_f32 v0, v0, v1
  v_add_f32 v3, s53, v0
  v_max_f32 v3, 0, v3
  v_sub_f32 v2, 0, v3
  v_exp_f32 v2, v2
  v_sub_f32 v144, v144, v3
  v_sub_f32 v145, v145, v3
  v_sub_f32 v146, v146, v3
  v_sub_f32 v147, v147, v3
  v_sub_f32 v148, v148, v3
  v_sub_f32 v149, v149, v3
  v_sub_f32 v150, v150, v3
  v_sub_f32 v151, v151, v3
  v_sub_f32 v152, v152, v3
  v_sub_f32 v153, v153, v3
  v_sub_f32 v154, v154, v3
  v_sub_f32 v155, v155, v3
  v_sub_f32 v156, v156, v3
  v_sub_f32 v157, v157, v3
  v_sub_f32 v158, v158, v3
  v_sub_f32 v159, v159, v3
  v_exp_f32 v0, v144
  v_exp_f32 v1, v145
  v_exp_f32 v8, v146
  v_exp_f32 v9, v147
  v_cvt_pk_bf16_f32 v168, v0, v1
  v_add_f32 v5, v0, v1
  v_exp_f32 v0, v148
  v_exp_f32 v1, v149
  v_cvt_pk_bf16_f32 v169, v8, v9
  v_add_f32 v5, v5, v8
  v_add_f32 v5, v5, v9
  v_exp_f32 v8, v150
  v_exp_f32 v9, v151
  v_cvt_pk_bf16_f32 v170, v0, v1
  v_add_f32 v5, v5, v0
  v_add_f32 v5, v5, v1
  v_exp_f32 v0, v152
  v_exp_f32 v1, v153
  v_cvt_pk_bf16_f32 v171, v8, v9
  v_add_f32 v5, v5, v8
  v_add_f32 v5, v5, v9
  v_exp_f32 v8, v154
  v_exp_f32 v9, v155
  v_cvt_pk_bf16_f32 v172, v0, v1
  v_add_f32 v5, v5, v0
  v_add_f32 v5, v5, v1
  v_exp_f32 v0, v156
  v_exp_f32 v1, v157
  v_cvt_pk_bf16_f32 v173, v8, v9
  v_add_f32 v5, v5, v8
  v_add_f32 v5, v5, v9
  v_exp_f32 v8, v158
  v_exp_f32 v9, v159
  v_cvt_pk_bf16_f32 v174, v0, v1
  v_add_f32 v5, v5, v0
  v_add_f32 v5, v5, v1
  s_nop 0
  v_cvt_pk_bf16_f32 v175, v8, v9
  v_add_f32 v5, v5, v8
  v_add_f32 v5, v5, v9
  v_sub_f32 v240, v240, v3
  v_sub_f32 v241, v241, v3
  v_sub_f32 v242, v242, v3
  v_sub_f32 v243, v243, v3
  v_sub_f32 v244, v244, v3
  v_sub_f32 v245, v245, v3
  v_sub_f32 v246, v246, v3
  v_sub_f32 v247, v247, v3
  v_sub_f32 v248, v248, v3
  v_sub_f32 v249, v249, v3
  v_sub_f32 v250, v250, v3
  v_sub_f32 v251, v251, v3
  v_sub_f32 v252, v252, v3
  v_sub_f32 v253, v253, v3
  v_sub_f32 v254, v254, v3
  v_sub_f32 v255, v255, v3
  v_mul_f32 v4, v4, v2
  s_mov_b32 s54, 1
  s_branch L_slowret_l2
L_resc_t15:
  s_nop 15
  s_nop 7
  v_sub_f32 v128, v128, v3
  v_sub_f32 v129, v129, v3
  v_sub_f32 v130, v130, v3
  v_sub_f32 v131, v131, v3
  v_sub_f32 v132, v132, v3
  v_sub_f32 v133, v133, v3
  v_sub_f32 v134, v134, v3
  v_sub_f32 v135, v135, v3
  v_sub_f32 v136, v136, v3
  v_sub_f32 v137, v137, v3
  v_sub_f32 v138, v138, v3
  v_sub_f32 v139, v139, v3
  v_sub_f32 v140, v140, v3
  v_sub_f32 v141, v141, v3
  v_sub_f32 v142, v142, v3
  v_sub_f32 v143, v143, v3
  v_mul_f32 v64, v64, v2
  v_mul_f32 v65, v65, v2
  v_mul_f32 v66, v66, v2
  v_mul_f32 v67, v67, v2
  v_mul_f32 v68, v68, v2
  v_mul_f32 v69, v69, v2
  v_mul_f32 v70, v70, v2
  v_mul_f32 v71, v71, v2
  v_mul_f32 v72, v72, v2
  v_mul_f32 v73, v73, v2
  v_mul_f32 v74, v74, v2
  v_mul_f32 v75, v75, v2
  v_mul_f32 v76, v76, v2
  v_mul_f32 v77, v77, v2
  v_mul_f32 v78, v78, v2
  v_mul_f32 v79, v79, v2
  v_mul_f32 v80, v80, v2
  v_mul_f32 v81, v81, v2
  v_mul_f32 v82, v82, v2
  v_mul_f32 v83, v83, v2
  v_mul_f32 v84, v84, v2
  v_mul_f32 v85, v85, v2
  v_mul_f32 v86, v86, v2
  v_mul_f32 v87, v87, v2
  v_mul_f32 v88, v88, v2
  v_mul_f32 v89, v89, v2
  v_mul_f32 v90, v90, v2
  v_mul_f32 v91, v91, v2
  v_mul_f32 v92, v92, v2
  v_mul_f32 v93, v93, v2
  v_mul_f32 v94, v94, v2
  v_mul_f32 v95, v95, v2
  v_mul_f32 v96, v96, v2
  v_mul_f32 v97, v97, v2
  v_mul_f32 v98, v98, v2
  v_mul_f32 v99, v99, v2
  v_mul_f32 v100, v100, v2
  v_mul_f32 v101, v101, v2
  v_mul_f32 v102, v102, v2
  v_mul_f32 v103, v103, v2
  v_mul_f32 v104, v104, v2
  v_mul_f32 v105, v105, v2
  v_mul_f32 v106, v106, v2
  v_mul_f32 v107, v107, v2
  v_mul_f32 v108, v108, v2
  v_mul_f32 v109, v109, v2
  v_mul_f32 v110, v110, v2
  v_mul_f32 v111, v111, v2
  v_mul_f32 v112, v112, v2
  v_mul_f32 v113, v113, v2
  v_mul_f32 v114, v114, v2
  v_mul_f32 v115, v115, v2
  v_mul_f32 v116, v116, v2
  v_mul_f32 v117, v117, v2
  v_mul_f32 v118, v118, v2
  v_mul_f32 v119, v119, v2
  v_mul_f32 v120, v120, v2
  v_mul_f32 v121, v121, v2
  v_mul_f32 v122, v122, v2
  v_mul_f32 v123, v123, v2
  v_mul_f32 v124, v124, v2
  v_mul_f32 v125, v125, v2
  v_mul_f32 v126, v126, v2
  v_mul_f32 v127, v127, v2
  s_mov_b32 s54, 0
  s_nop 1
  s_branch L_rescret_t15
L_slow_t15:
  v_max3_f32 v0, v128, v129, v130
  v_max3_f32 v1, v131, v132, v133
  v_max3_f32 v8, v134, v135, v136
  v_max3_f32 v9, v137, v138, v139
  v_max3_f32 v31, v140, v141, v142
  v_max3_f32 v0, v0, v1, v143
  v_max3_f32 v8, v8, v9, v31
  v_max_f32 v0, v0, v8
  v_mov_b32 v1, v0
  s_nop 1
  v_permlane32_swap_b32 v0, v1
  v_max_f32 v0, v0, v1
  v_add_f32 v3, s53, v0
  v_max_f32 v3, 0, v3
  v_sub_f32 v2, 0, v3
  v_exp_f32 v2, v2
  v_sub_f32 v128, v128, v3
  v_sub_f32 v129, v129, v3
  v_sub_f32 v130, v130, v3
  v_sub_f32 v131, v131, v3
  v_sub_f32 v132, v132, v3
  v_sub_f32 v133, v133, v3
  v_sub_f32 v134, v134, v3
  v_sub_f32 v135, v135, v3
  v_sub_f32 v136, v136, v3
  v_sub_f32 v137, v137, v3
  v_sub_f32 v138, v138, v3
  v_sub_f32 v139, v139, v3
  v_sub_f32 v140, v140, v3
  v_sub_f32 v141, v141, v3
  v_sub_f32 v142, v142, v3
  v_sub_f32 v143, v143, v3
  v_exp_f32 v0, v128
  v_exp_f32 v1, v129
  v_exp_f32 v8, v130
  v_exp_f32 v9, v131
  v_cvt_pk_bf16_f32 v160, v0, v1
  v_add_f32 v5, v0, v1
  v_exp_f32 v0, v132
  v_exp_f32 v1, v133
  v_cvt_pk_bf16_f32 v161, v8, v9
  v_add_f32 v5, v5, v8
  v_add_f32 v5, v5, v9
  v_exp_f32 v8, v134
  v_exp_f32 v9, v135
  v_cvt_pk_bf16_f32 v162, v0, v1
  v_add_f32 v5, v5, v0
  v_add_f32 v5, v5, v1
  v_exp_f32 v0, v136
  v_exp_f32 v1, v137
  v_cvt_pk_bf16_f32 v163, v8, v9
  v_add_f32 v5, v5, v8
  v_add_f32 v5, v5, v9
  v_exp_f32 v8, v138
  v_exp_f32 v9, v139
  v_cvt_pk_bf16_f32 v164, v0, v1
  v_add_f32 v5, v5, v0
  v_add_f32 v5, v5, v1
  v_exp_f32 v0, v140
  v_exp_f32 v1, v141
  v_cvt_pk_bf16_f32 v165, v8, v9
  v_add_f32 v5, v5, v8
  v_add_f32 v5, v5, v9
  v_exp_f32 v8, v142
  v_exp_f32 v9, v143
  v_cvt_pk_bf16_f32 v166, v0, v1
  v_add_f32 v5, v5, v0
  v_add_f32 v5, v5, v1
  s_nop 0
  v_cvt_pk_bf16_f32 v167, v8, v9
  v_add_f32 v5, v5, v8
  v_add_f32 v5, v5, v9
  v_sub_f32 v240, v240, v3
  v_sub_f32 v241, v241, v3
  v_sub_f32 v242, v242, v3
  v_sub_f32 v243, v243, v3
  v_sub_f32 v244, v244, v3
  v_sub_f32 v245, v245, v3
  v_sub_f32 v246, v246, v3
  v_sub_f32 v247, v247, v3
  v_sub_f32 v248, v248, v3
  v_sub_f32 v249, v249, v3
  v_sub_f32 v250, v250, v3
  v_sub_f32 v251, v251, v3
  v_sub_f32 v252, v252, v3
  v_sub_f32 v253, v253, v3
  v_sub_f32 v254, v254, v3
  v_sub_f32 v255, v255, v3
  v_mul_f32 v4, v4, v2
  s_mov_b32 s54, 1
  s_branch L_slowret_t15
L_resc_t16:
  s_nop 15
  s_nop 7
  v_sub_f32 v144, v144, v3
  v_sub_f32 v145, v145, v3
  v_sub_f32 v146, v146, v3
  v_sub_f32 v147, v147, v3
  v_sub_f32 v148, v148, v3
  v_sub_f32 v149, v149, v3
  v_sub_f32 v150, v150, v3
  v_sub_f32 v151, v151, v3
  v_sub_f32 v152, v152, v3
  v_sub_f32 v153, v153, v3
  v_sub_f32 v154, v154, v3
  v_sub_f32 v155, v155, v3
  v_sub_f32 v156, v156, v3
  v_sub_f32 v157, v157, v3
  v_sub_f32 v158, v158, v3
  v_sub_f32 v159, v159, v3
  v_mul_f32 v64, v64, v2
  v_mul_f32 v65, v65, v2
  v_mul_f32 v66, v66, v2
  v_mul_f32 v67, v67, v2
  v_mul_f32 v68, v68, v2
  v_mul_f32 v69, v69, v2
  v_mul_f32 v70, v70, v2
  v_mul_f32 v71, v71, v2
  v_mul_f32 v72, v72, v2
  v_mul_f32 v73, v73, v2
  v_mul_f32 v74, v74, v2
  v_mul_f32 v75, v75, v2
  v_mul_f32 v76, v76, v2
  v_mul_f32 v77, v77, v2
  v_mul_f32 v78, v78, v2
  v_mul_f32 v79, v79, v2
  v_mul_f32 v80, v80, v2
  v_mul_f32 v81, v81, v2
  v_mul_f32 v82, v82, v2
  v_mul_f32 v83, v83, v2
  v_mul_f32 v84, v84, v2
  v_mul_f32 v85, v85, v2
  v_mul_f32 v86, v86, v2
  v_mul_f32 v87, v87, v2
  v_mul_f32 v88, v88, v2
  v_mul_f32 v89, v89, v2
  v_mul_f32 v90, v90, v2
  v_mul_f32 v91, v91, v2
  v_mul_f32 v92, v92, v2
  v_mul_f32 v93, v93, v2
  v_mul_f32 v94, v94, v2
  v_mul_f32 v95, v95, v2
  v_mul_f32 v96, v96, v2
  v_mul_f32 v97, v97, v2
  v_mul_f32 v98, v98, v2
  v_mul_f32 v99, v99, v2
  v_mul_f32 v100, v100, v2
  v_mul_f32 v101, v101, v2
  v_mul_f32 v102, v102, v2
  v_mul_f32 v103, v103, v2
  v_mul_f32 v104, v104, v2
  v_mul_f32 v105, v105, v2
  v_mul_f32 v106, v106, v2
  v_mul_f32 v107, v107, v2
  v_mul_f32 v108, v108, v2
  v_mul_f32 v109, v109, v2
  v_mul_f32 v110, v110, v2
  v_mul_f32 v111, v111, v2
  v_mul_f32 v112, v112, v2
  v_mul_f32 v113, v113, v2
  v_mul_f32 v114, v114, v2
  v_mul_f32 v115, v115, v2
  v_mul_f32 v116, v116, v2
  v_mul_f32 v117, v117, v2
  v_mul_f32 v118, v118, v2
  v_mul_f32 v119, v119, v2
  v_mul_f32 v120, v120, v2
  v_mul_f32 v121, v121, v2
  v_mul_f32 v122, v122, v2
  v_mul_f32 v123, v123, v2
  v_mul_f32 v124, v124, v2
  v_mul_f32 v125, v125, v2
  v_mul_f32 v126, v126, v2
  v_mul_f32 v127, v127, v2
  s_mov_b32 s54, 0
  s_nop 1
  s_branch L_rescret_t16
L_slow_t16:
  v_max3_f32 v0, v144, v145, v146
  v_max3_f32 v1, v147, v148, v149
  v_max3_f32 v8, v150, v151, v152
  v_max3_f32 v9, v153, v154, v155
  v_max3_f32 v31, v156, v157, v158
  v_max3_f32 v0, v0, v1, v159
  v_max3_f32 v8, v8, v9, v31
  v_max_f32 v0, v0, v8
  v_mov_b32 v1, v0
  s_nop 1
  v_permlane32_swap_b32 v0, v1
  v_max_f32 v0, v0, v1
  v_add_f32 v3, s53, v0
  v_max_f32 v3, 0, v3
  v_sub_f32 v2, 0, v3
  v_exp_f32 v2, v2
  v_sub_f32 v144, v144, v3
  v_sub_f32 v145, v145, v3
  v_sub_f32 v146, v146, v3
  v_sub_f32 v147, v147, v3
  v_sub_f32 v148, v148, v3
  v_sub_f32 v149, v149, v3
  v_sub_f32 v150, v150, v3
  v_sub_f32 v151, v151, v3
  v_sub_f32 v152, v152, v3
  v_sub_f32 v153, v153, v3
  v_sub_f32 v154, v154, v3
  v_sub_f32 v155, v155, v3
  v_sub_f32 v156, v156, v3
  v_sub_f32 v157, v157, v3
  v_sub_f32 v158, v158, v3
  v_sub_f32 v159, v159, v3
  v_exp_f32 v0, v144
  v_exp_f32 v1, v145
  v_exp_f32 v8, v146
  v_exp_f32 v9, v147
  v_cvt_pk_bf16_f32 v168, v0, v1
  v_add_f32 v5, v0, v1
  v_exp_f32 v0, v148
  v_exp_f32 v1, v149
  v_cvt_pk_bf16_f32 v169, v8, v9
  v_add_f32 v5, v5, v8
  v_add_f32 v5, v5, v9
  v_exp_f32 v8, v150
  v_exp_f32 v9, v151
  v_cvt_pk_bf16_f32 v170, v0, v1
  v_add_f32 v5, v5, v0
  v_add_f32 v5, v5, v1
  v_exp_f32 v0, v152
  v_exp_f32 v1, v153
  v_cvt_pk_bf16_f32 v171, v8, v9
  v_add_f32 v5, v5, v8
  v_add_f32 v5, v5, v9
  v_exp_f32 v8, v154
  v_exp_f32 v9, v155
  v_cvt_pk_bf16_f32 v172, v0, v1
  v_add_f32 v5, v5, v0
  v_add_f32 v5, v5, v1
  v_exp_f32 v0, v156
  v_exp_f32 v1, v157
  v_cvt_pk_bf16_f32 v173, v8, v9
  v_add_f32 v5, v5, v8
  v_add_f32 v5, v5, v9
  v_exp_f32 v8, v158
  v_exp_f32 v9, v159
  v_cvt_pk_bf16_f32 v174, v0, v1
  v_add_f32 v5, v5, v0
  v_add_f32 v5, v5, v1
  s_nop 0
  v_cvt_pk_bf16_f32 v175, v8, v9
  v_add_f32 v5, v5, v8
  v_add_f32 v5, v5, v9
  v_sub_f32 v240, v240, v3
  v_sub_f32 v241, v241, v3
  v_sub_f32 v242, v242, v3
  v_sub_f32 v243, v243, v3
  v_sub_f32 v244, v244, v3
  v_sub_f32 v245, v245, v3
  v_sub_f32 v246, v246, v3
  v_sub_f32 v247, v247, v3
  v_sub_f32 v248, v248, v3
  v_sub_f32 v249, v249, v3
  v_sub_f32 v250, v250, v3
  v_sub_f32 v251, v251, v3
  v_sub_f32 v252, v252, v3
  v_sub_f32 v253, v253, v3
  v_sub_f32 v254, v254, v3
  v_sub_f32 v255, v255, v3
  v_mul_f32 v4, v4, v2
  s_mov_b32 s54, 1
  s_branch L_slowret_t16
L_resc_t17:
  s_nop 15
  s_nop 7
  v_sub_f32 v128, v128, v3
  v_sub_f32 v129, v129, v3
  v_sub_f32 v130, v130, v3
  v_sub_f32 v131, v131, v3
  v_sub_f32 v132, v132, v3
  v_sub_f32 v133, v133, v3
  v_sub_f32 v134, v134, v3
  v_sub_f32 v135, v135, v3
  v_sub_f32 v136, v136, v3
  v_sub_f32 v137, v137, v3
  v_sub_f32 v138, v138, v3
  v_sub_f32 v139, v139, v3
  v_sub_f32 v140, v140, v3
  v_sub_f32 v141, v141, v3
  v_sub_f32 v142, v142, v3
  v_sub_f32 v143, v143, v3
  v_mul_f32 v64, v64, v2
  v_mul_f32 v65, v65, v2
  v_mul_f32 v66, v66, v2
  v_mul_f32 v67, v67, v2
  v_mul_f32 v68, v68, v2
  v_mul_f32 v69, v69, v2
  v_mul_f32 v70, v70, v2
  v_mul_f32 v71, v71, v2
  v_mul_f32 v72, v72, v2
  v_mul_f32 v73, v73, v2
  v_mul_f32 v74, v74, v2
  v_mul_f32 v75, v75, v2
  v_mul_f32 v76, v76, v2
  v_mul_f32 v77, v77, v2
  v_mul_f32 v78, v78, v2
  v_mul_f32 v79, v79, v2
  v_mul_f32 v80, v80, v2
  v_mul_f32 v81, v81, v2
  v_mul_f32 v82, v82, v2
  v_mul_f32 v83, v83, v2
  v_mul_f32 v84, v84, v2
  v_mul_f32 v85, v85, v2
  v_mul_f32 v86, v86, v2
  v_mul_f32 v87, v87, v2
  v_mul_f32 v88, v88, v2
  v_mul_f32 v89, v89, v2
  v_mul_f32 v90, v90, v2
  v_mul_f32 v91, v91, v2
  v_mul_f32 v92, v92, v2
  v_mul_f32 v93, v93, v2
  v_mul_f32 v94, v94, v2
  v_mul_f32 v95, v95, v2
  v_mul_f32 v96, v96, v2
  v_mul_f32 v97, v97, v2
  v_mul_f32 v98, v98, v2
  v_mul_f32 v99, v99, v2
  v_mul_f32 v100, v100, v2
  v_mul_f32 v101, v101, v2
  v_mul_f32 v102, v102, v2
  v_mul_f32 v103, v103, v2
  v_mul_f32 v104, v104, v2
  v_mul_f32 v105, v105, v2
  v_mul_f32 v106, v106, v2
  v_mul_f32 v107, v107, v2
  v_mul_f32 v108, v108, v2
  v_mul_f32 v109, v109, v2
  v_mul_f32 v110, v110, v2
  v_mul_f32 v111, v111, v2
  v_mul_f32 v112, v112, v2
  v_mul_f32 v113, v113, v2
  v_mul_f32 v114, v114, v2
  v_mul_f32 v115, v115, v2
  v_mul_f32 v116, v116, v2
  v_mul_f32 v117, v117, v2
  v_mul_f32 v118, v118, v2
  v_mul_f32 v119, v119, v2
  v_mul_f32 v120, v120, v2
  v_mul_f32 v121, v121, v2
  v_mul_f32 v122, v122, v2
  v_mul_f32 v123, v123, v2
  v_mul_f32 v124, v124, v2
  v_mul_f32 v125, v125, v2
  v_mul_f32 v126, v126, v2
  v_mul_f32 v127, v127, v2
  s_mov_b32 s54, 0
  s_nop 1
  s_branch L_rescret_t17
L_end:
  s_endpgm
.section .rodata,"a"
.p2align 6
.amdhsa_kernel concat_heads__mha_block_cached__mha_block_cached__near_ridge_kernel
  .amdhsa_next_free_vgpr 256
  .amdhsa_next_free_sgpr 102
  .amdhsa_accum_offset 256
  .amdhsa_group_segment_fixed_size 0
  .amdhsa_kernarg_size 104
  .amdhsa_user_sgpr_count 2
  .amdhsa_user_sgpr_kernarg_segment_ptr 1
  .amdhsa_system_sgpr_workgroup_id_x 1
.end_amdhsa_kernel
```
